```python
import torch

def _softmax(x, axis=-1):
    return torch.softmax(x, dim=axis)
def _gelu(x):
    return torch.nn.functional.gelu(x, approximate="tanh")
def _silu(x):
    return torch.nn.functional.silu(x)
def _sigmoid(x):
    return torch.sigmoid(x)
def _layernorm(x, axis=-1, eps=1e-5):
    m = x.mean(dim=axis, keepdim=True)
    v = x.var(dim=axis, keepdim=True, unbiased=False)
    return (x - m) / torch.sqrt(v + eps)
def _scatter_add(tgt, idx, src, axis=0):
    return tgt.clone().index_add_(axis, idx, src)
def _segment_sum(src, seg, n):
    out = torch.zeros((n,) + src.shape[1:], dtype=src.dtype)
    return out.index_add_(0, seg, src)
def _pad(x, pw):
    flat = tuple(v for pair in reversed(pw) for v in pair)
    return torch.nn.functional.pad(x, flat)

kernel_name = 'concat_heads__gqa_block_cached__gqa_block_cached__near_ridge'

def setup_inputs():

    _w = (lambda a: (lambda t: t.to(torch.bfloat16) if t.is_floating_point() else t)(torch.as_tensor(a)))
    def _A_setup():
        B, Sq, D = 8, 192, 640
        Hq, Hkv, Sk, Dh = 32, 32, 512, 192
        assert Hq % Hkv == 0, (Hq, Hkv)
        return {
            "x": _w((lambda *s: torch.randn(*s, dtype=torch.bfloat16) * 0.8)(B, Sq, D)),
            "k_cache": _w((lambda *s: torch.randn(*s, dtype=torch.bfloat16) * 0.8)(B, Hkv, Sk, Dh)),
            "v_cache": _w((lambda *s: torch.randn(*s, dtype=torch.bfloat16) * 0.05)(B, Hkv, Sk, Dh)),
            "wq": _w((lambda *s: torch.randn(*s, dtype=torch.bfloat16) * 0.8)(D, Hq * Dh) * (D ** -0.5)),
            "wo": _w((lambda *s: torch.randn(*s, dtype=torch.bfloat16) * 0.05)(Hq * Dh, D) * ((Hq * Dh) ** -0.5)),
        }
    _A_in = _A_setup()

    def _B_setup():
        B, Sq, D = 8, 192, 640
        Hq, Hkv, Sk, Dh = 32, 32, 512, 192
        assert Hq % Hkv == 0, (Hq, Hkv)
        return {
            "x": _w((lambda *s: torch.randn(*s, dtype=torch.bfloat16) * 0.8)(B, Sq, D)),
            "k_cache": _w((lambda *s: torch.randn(*s, dtype=torch.bfloat16) * 0.8)(B, Hkv, Sk, Dh)),
            "v_cache": _w((lambda *s: torch.randn(*s, dtype=torch.bfloat16) * 0.05)(B, Hkv, Sk, Dh)),
            "wq": _w((lambda *s: torch.randn(*s, dtype=torch.bfloat16) * 0.8)(D, Hq * Dh) * (D ** -0.5)),
            "wo": _w((lambda *s: torch.randn(*s, dtype=torch.bfloat16) * 0.05)(Hq * Dh, D) * ((Hq * Dh) ** -0.5)),
        }
    _B_in = _B_setup()

    return {
        "A_x": _A_in["x"],
        "A_k_cache": _A_in["k_cache"],
        "A_v_cache": _A_in["v_cache"],
        "A_wq": _A_in["wq"],
        "A_wo": _A_in["wo"],
        "B_x": _B_in["x"],
        "B_k_cache": _B_in["k_cache"],
        "B_v_cache": _B_in["v_cache"],
        "B_wq": _B_in["wq"],
        "B_wo": _B_in["wo"],
    }

def reference(A_x, A_k_cache, A_v_cache, A_wq, A_wo, B_x, B_k_cache, B_v_cache, B_wq, B_wo):
    def _A_ref(x, k_cache, v_cache, wq, wo):
        B, Sq, D = x.shape
        Hq, Dh = 32, 192
        Hkv = k_cache.shape[1]
        rep = Hq // Hkv
        q = (lambda x, *d: x.permute(*d))((x @ wq).reshape(B, Sq, Hq, Dh), 0, 2, 1, 3)
        k = (lambda x, n, axis: torch.repeat_interleave(x, n, dim=axis))(k_cache, rep, axis=1)
        v = (lambda x, n, axis: torch.repeat_interleave(x, n, dim=axis))(v_cache, rep, axis=1)
        scores = torch.einsum("bhqd,bhkd->bhqk", q, k) * (Dh ** -0.5)
        p = _softmax(scores, axis=-1)
        o = torch.einsum("bhqk,bhkd->bhqd", p, v)
        return (lambda x, *d: x.permute(*d))(o, 0, 2, 1, 3).reshape(B, Sq, Hq * Dh) @ wo

    def _B_ref(x, k_cache, v_cache, wq, wo):
        B, Sq, D = x.shape
        Hq, Dh = 32, 192
        Hkv = k_cache.shape[1]
        rep = Hq // Hkv
        q = (lambda x, *d: x.permute(*d))((x @ wq).reshape(B, Sq, Hq, Dh), 0, 2, 1, 3)
        k = (lambda x, n, axis: torch.repeat_interleave(x, n, dim=axis))(k_cache, rep, axis=1)
        v = (lambda x, n, axis: torch.repeat_interleave(x, n, dim=axis))(v_cache, rep, axis=1)
        scores = torch.einsum("bhqd,bhkd->bhqk", q, k) * (Dh ** -0.5)
        p = _softmax(scores, axis=-1)
        o = torch.einsum("bhqk,bhkd->bhqd", p, v)
        return (lambda x, *d: x.permute(*d))(o, 0, 2, 1, 3).reshape(B, Sq, Hq * Dh) @ wo

    a = _A_ref(A_x, A_k_cache, A_v_cache, A_wq, A_wo)
    b = _B_ref(B_x, B_k_cache, B_v_cache, B_wq, B_wo)
    return torch.concatenate([a, b], axis=-1)
```

```asm
; @launch kernel=k1_kernel grid=(256,1,1) block=(256,1,1) lds=147456
; @launch kernel=k2_kernel grid=(240,1,1) block=(256,1,1) lds=147456
; @launch kernel=k3_kernel grid=(1920,1,1) block=(256,1,1) lds=0
.amdgcn_target "amdgcn-amd-amdhsa--gfx950"
.text
.globl k1_kernel
.p2align 8
.type k1_kernel,@function
k1_kernel:
    s_cmp_ge_u32 s2, 256
    s_cbranch_scc1 L_k1_end
    s_load_dwordx16 s[16:31], s[0:1], 0
    s_load_dwordx4 s[32:35], s[0:1], 64
    s_load_dwordx2 s[36:37], s[0:1], 96
    s_and_b32 s3, s2, 7
    s_lshr_b32 s4, s2, 3
    s_and_b32 s73, s4, 7
    s_lshr_b32 s4, s4, 3
    s_lshl_b32 s4, s4, 1
    s_lshl_b32 s3, s3, 3
    s_add_u32 s3, s3, s4
    s_lshr_b32 s75, s3, 5
    s_and_b32 s74, s3, 31
    v_lshrrev_b32 v212, 6, v0
    s_nop 0
    v_readfirstlane_b32 s76, v212
    s_waitcnt lgkmcnt(0)
    s_cmp_eq_u32 s75, 0
    s_cselect_b32 s4, s16, s26
    s_cselect_b32 s5, s17, s27
    s_cselect_b32 s6, s18, s28
    s_cselect_b32 s7, s19, s29
    s_cselect_b32 s8, s20, s30
    s_cselect_b32 s9, s21, s31
    s_cselect_b32 s10, s22, s32
    s_cselect_b32 s11, s23, s33
    s_mul_i32 s3, s73, 245760
    s_add_u32 s40, s4, s3
    s_addc_u32 s41, s5, 0
    s_mov_b32 s42, 245760
    s_mov_b32 s43, 0x00020000
    s_mul_i32 s3, s74, 384
    s_add_u32 s44, s10, s3
    s_addc_u32 s45, s11, 0
    s_sub_u32 s46, 7864320, s3
    s_mov_b32 s47, 0x00020000
    s_lshl_b32 s3, s73, 5
    s_add_u32 s3, s3, s74
    s_mul_i32 s3, s3, 196608
    s_add_u32 s48, s6, s3
    s_addc_u32 s49, s7, 0
    s_mov_b32 s50, 196608
    s_mov_b32 s51, 0x00020000
    s_add_u32 s52, s8, s3
    s_addc_u32 s53, s9, 0
    s_mov_b32 s54, 196608
    s_mov_b32 s55, 0x00020000
    s_lshl_b32 s3, s75, 3
    s_add_u32 s3, s3, s73
    s_mul_i32 s3, s3, 2359296
    s_add_u32 s56, s36, s3
    s_addc_u32 s57, s37, 0
    s_mov_b32 s58, 2359296
    s_mov_b32 s59, 0x00020000
    s_mul_i32 s67, s76, 3072
    v_and_b32 v1, 63, v0
    v_lshrrev_b32 v2, 4, v1
    v_and_b32 v3, 15, v1
    v_bfe_u32 v4, v1, 2, 2
    v_and_b32 v5, 3, v1
    s_movk_i32 s3, 2731
    s_lshl_b32 s4, s76, 3
    v_add_u32 v212, 0, v1
    v_mul_lo_u32 v213, v212, s3
    v_lshrrev_b32 v213, 16, v213
    v_mul_u32_u24 v214, 24, v213
    v_sub_u32 v212, v212, v214
    v_add_u32 v213, s4, v213
    v_and_b32 v214, 6, v213
    v_xor_b32 v214, v212, v214
    v_lshlrev_b32 v214, 4, v214
    v_mul_u32_u24 v215, 384, v213
    v_add_u32 v197, v214, v215
    v_and_b32 v214, 2, v213
    v_bfe_u32 v215, v213, 3, 1
    v_lshlrev_b32 v215, 2, v215
    v_or_b32 v214, v214, v215
    v_xor_b32 v214, v212, v214
    v_lshlrev_b32 v214, 4, v214
    v_mul_u32_u24 v215, 12288, v213
    v_add_u32 v200, v214, v215
    v_add_u32 v212, 64, v1
    v_mul_lo_u32 v213, v212, s3
    v_lshrrev_b32 v213, 16, v213
    v_mul_u32_u24 v214, 24, v213
    v_sub_u32 v212, v212, v214
    v_add_u32 v213, s4, v213
    v_and_b32 v214, 6, v213
    v_xor_b32 v214, v212, v214
    v_lshlrev_b32 v214, 4, v214
    v_mul_u32_u24 v215, 384, v213
    v_add_u32 v198, v214, v215
    v_and_b32 v214, 2, v213
    v_bfe_u32 v215, v213, 3, 1
    v_lshlrev_b32 v215, 2, v215
    v_or_b32 v214, v214, v215
    v_xor_b32 v214, v212, v214
    v_lshlrev_b32 v214, 4, v214
    v_mul_u32_u24 v215, 12288, v213
    v_add_u32 v201, v214, v215
    v_add_u32 v212, 128, v1
    v_mul_lo_u32 v213, v212, s3
    v_lshrrev_b32 v213, 16, v213
    v_mul_u32_u24 v214, 24, v213
    v_sub_u32 v212, v212, v214
    v_add_u32 v213, s4, v213
    v_and_b32 v214, 6, v213
    v_xor_b32 v214, v212, v214
    v_lshlrev_b32 v214, 4, v214
    v_mul_u32_u24 v215, 384, v213
    v_add_u32 v199, v214, v215
    v_and_b32 v214, 2, v213
    v_bfe_u32 v215, v213, 3, 1
    v_lshlrev_b32 v215, 2, v215
    v_or_b32 v214, v214, v215
    v_xor_b32 v214, v212, v214
    v_lshlrev_b32 v214, 4, v214
    v_mul_u32_u24 v215, 12288, v213
    v_add_u32 v202, v214, v215
    v_lshrrev_b32 v212, 3, v1
    v_and_b32 v213, 6, v212
    v_and_b32 v214, 7, v1
    v_xor_b32 v213, v214, v213
    v_lshlrev_b32 v213, 4, v213
    v_mul_u32_u24 v212, 1280, v212
    s_mul_i32 s4, s76, 61440
    v_add3_u32 v203, v212, v213, s4
    v_and_b32 v214, 6, v3
    v_mul_u32_u24 v215, 384, v3
    v_add_u32 v212, 0, v2
    v_xor_b32 v212, v212, v214
    v_lshlrev_b32 v212, 4, v212
    v_add3_u32 v180, v212, v215, 0
    v_add_u32 v212, 4, v2
    v_xor_b32 v212, v212, v214
    v_lshlrev_b32 v212, 4, v212
    v_add3_u32 v181, v212, v215, 0
    v_lshlrev_b32 v216, 2, v2
    v_add_u32 v216, v216, v4
    v_and_b32 v214, 6, v216
    v_mul_u32_u24 v215, 384, v216
    v_and_b32 v213, 1, v5
    v_lshlrev_b32 v213, 3, v213
    v_add_u32 v215, v215, v213
    v_lshrrev_b32 v212, 1, v5
    v_add_u32 v212, 0, v212
    v_xor_b32 v212, v212, v214
    v_lshlrev_b32 v212, 4, v212
    v_add_u32 v182, v212, v215
    v_lshrrev_b32 v212, 1, v5
    v_add_u32 v212, 2, v212
    v_xor_b32 v212, v212, v214
    v_lshlrev_b32 v212, 4, v212
    v_add_u32 v183, v212, v215
    v_lshrrev_b32 v212, 1, v5
    v_add_u32 v212, 4, v212
    v_xor_b32 v212, v212, v214
    v_lshlrev_b32 v212, 4, v212
    v_add_u32 v184, v212, v215
    v_lshrrev_b32 v212, 1, v5
    v_add_u32 v212, 6, v212
    v_xor_b32 v212, v212, v214
    v_lshlrev_b32 v212, 4, v212
    v_add_u32 v185, v212, v215
    v_lshlrev_b32 v216, 3, v2
    v_add_u32 v216, v216, v4
    v_and_b32 v214, 2, v4
    v_and_b32 v212, 1, v2
    v_lshlrev_b32 v212, 2, v212
    v_or_b32 v214, v214, v212
    v_mul_u32_u24 v215, 384, v216
    v_add_u32 v215, v215, v213
    v_lshrrev_b32 v212, 1, v5
    v_add_u32 v212, 0, v212
    v_xor_b32 v212, v212, v214
    v_lshlrev_b32 v212, 4, v212
    v_add3_u32 v192, v212, v215, 0
    v_lshrrev_b32 v212, 1, v5
    v_add_u32 v212, 2, v212
    v_xor_b32 v212, v212, v214
    v_lshlrev_b32 v212, 4, v212
    v_add3_u32 v193, v212, v215, 0
    v_lshrrev_b32 v212, 1, v5
    v_add_u32 v212, 4, v212
    v_xor_b32 v212, v212, v214
    v_lshlrev_b32 v212, 4, v212
    v_add3_u32 v194, v212, v215, 0
    v_lshrrev_b32 v212, 1, v5
    v_add_u32 v212, 6, v212
    v_xor_b32 v212, v212, v214
    v_lshlrev_b32 v212, 4, v212
    v_add3_u32 v195, v212, v215, 0
    v_and_b32 v214, 6, v3
    v_lshlrev_b32 v213, 7, v3
    s_mul_i32 s4, s76, 6144
    v_add_u32 v212, 0, v2
    v_xor_b32 v212, v212, v214
    v_lshlrev_b32 v212, 4, v212
    v_add3_u32 v204, v212, v213, s4
    v_add_u32 v212, 4, v2
    v_xor_b32 v212, v212, v214
    v_lshlrev_b32 v212, 4, v212
    v_add3_u32 v205, v212, v213, s4
    s_mul_i32 s3, s76, 48
    s_mul_i32 s4, s74, 12288
    v_add3_u32 v212, v3, s3, 0
    v_lshrrev_b32 v213, 5, v212
    v_mul_u32_u24 v213, 0x60000, v213
    v_and_b32 v212, 31, v212
    v_and_b32 v214, 1, v2
    v_lshl_add_u32 v212, v214, 5, v212
    v_lshlrev_b32 v212, 4, v212
    v_lshrrev_b32 v214, 1, v2
    v_lshlrev_b32 v214, 10, v214
    v_add3_u32 v212, v212, v213, v214
    v_add_u32 v224, s4, v212
    v_add3_u32 v212, v3, s3, 16
    v_lshrrev_b32 v213, 5, v212
    v_mul_u32_u24 v213, 0x60000, v213
    v_and_b32 v212, 31, v212
    v_and_b32 v214, 1, v2
    v_lshl_add_u32 v212, v214, 5, v212
    v_lshlrev_b32 v212, 4, v212
    v_lshrrev_b32 v214, 1, v2
    v_lshlrev_b32 v214, 10, v214
    v_add3_u32 v212, v212, v213, v214
    v_add_u32 v225, s4, v212
    v_add3_u32 v212, v3, s3, 32
    v_lshrrev_b32 v213, 5, v212
    v_mul_u32_u24 v213, 0x60000, v213
    v_and_b32 v212, 31, v212
    v_and_b32 v214, 1, v2
    v_lshl_add_u32 v212, v214, 5, v212
    v_lshlrev_b32 v212, 4, v212
    v_lshrrev_b32 v214, 1, v2
    v_lshlrev_b32 v214, 10, v214
    v_add3_u32 v212, v212, v213, v214
    v_add_u32 v226, s4, v212
    s_mov_b32 s63, 0
    s_mov_b32 s64, 0
    s_mov_b32 s65, 0
    s_mov_b32 s66, 0
    s_mov_b32 s61, 0
    s_mov_b32 s62, 0
    s_mov_b32 s60, 0
    s_mov_b32 s72, 0
    s_mov_b32 s79, s67
    s_mov_b32 s70, 0x3dd53b95
    s_mov_b32 s71, 0x44800000
    s_mov_b32 s87, 0
    s_mul_i32 s78, s76, 6144
    s_add_u32 m0, s78, 0
    s_add_u32 s69, s63, 0
    buffer_load_dwordx4 v203, s[40:43], s69 offen lds
    s_add_u32 m0, s78, 1024
    s_add_u32 s69, s63, 10240
    buffer_load_dwordx4 v203, s[40:43], s69 offen lds
    s_add_u32 m0, s78, 2048
    s_add_u32 s69, s63, 20480
    buffer_load_dwordx4 v203, s[40:43], s69 offen lds
    s_add_u32 m0, s78, 3072
    s_add_u32 s69, s63, 30720
    buffer_load_dwordx4 v203, s[40:43], s69 offen lds
    s_add_u32 m0, s78, 4096
    s_add_u32 s69, s63, 40960
    buffer_load_dwordx4 v203, s[40:43], s69 offen lds
    s_add_u32 m0, s78, 5120
    s_add_u32 s69, s63, 51200
    buffer_load_dwordx4 v203, s[40:43], s69 offen lds
    s_add_u32 s69, s64, 0
    s_add_u32 m0, s67, 24576
    s_nop 0
    buffer_load_dwordx4 v200, s[44:47], s69 offen lds
    s_add_u32 m0, s67, 25600
    s_nop 0
    buffer_load_dwordx4 v201, s[44:47], s69 offen lds
    s_add_u32 m0, s67, 26624
    s_nop 0
    buffer_load_dwordx4 v202, s[44:47], s69 offen lds
    s_add_u32 s69, s64, 393216
    s_add_u32 m0, s67, 36864
    s_nop 0
    buffer_load_dwordx4 v200, s[44:47], s69 offen lds
    s_add_u32 m0, s67, 37888
    s_nop 0
    buffer_load_dwordx4 v201, s[44:47], s69 offen lds
    s_add_u32 m0, s67, 38912
    s_nop 0
    buffer_load_dwordx4 v202, s[44:47], s69 offen lds
    s_add_u32 s69, s64, 384
    s_add_u32 m0, s67, 49152
    s_nop 0
    buffer_load_dwordx4 v200, s[44:47], s69 offen lds
    s_add_u32 m0, s67, 50176
    s_nop 0
    buffer_load_dwordx4 v201, s[44:47], s69 offen lds
    s_add_u32 m0, s67, 51200
    s_nop 0
    buffer_load_dwordx4 v202, s[44:47], s69 offen lds
    s_add_u32 s69, s64, 393600
    s_add_u32 m0, s67, 61440
    s_nop 0
    buffer_load_dwordx4 v200, s[44:47], s69 offen lds
    s_add_u32 m0, s67, 62464
    s_nop 0
    buffer_load_dwordx4 v201, s[44:47], s69 offen lds
    s_add_u32 m0, s67, 63488
    s_nop 0
    buffer_load_dwordx4 v202, s[44:47], s69 offen lds
    s_add_u32 s63, s63, 128
    s_add_u32 s64, s64, 786432
    s_add_u32 m0, s78, 73728
    s_add_u32 s69, s63, 0
    buffer_load_dwordx4 v203, s[40:43], s69 offen lds
    s_add_u32 m0, s78, 74752
    s_add_u32 s69, s63, 10240
    buffer_load_dwordx4 v203, s[40:43], s69 offen lds
    s_add_u32 m0, s78, 75776
    s_add_u32 s69, s63, 20480
    buffer_load_dwordx4 v203, s[40:43], s69 offen lds
    s_add_u32 m0, s78, 76800
    s_add_u32 s69, s63, 30720
    buffer_load_dwordx4 v203, s[40:43], s69 offen lds
    s_add_u32 m0, s78, 77824
    s_add_u32 s69, s63, 40960
    buffer_load_dwordx4 v203, s[40:43], s69 offen lds
    s_add_u32 m0, s78, 78848
    s_add_u32 s69, s63, 51200
    buffer_load_dwordx4 v203, s[40:43], s69 offen lds
    s_add_u32 s69, s64, 0
    s_add_u32 m0, s67, 98304
    s_nop 0
    buffer_load_dwordx4 v200, s[44:47], s69 offen lds
    s_add_u32 m0, s67, 99328
    s_nop 0
    buffer_load_dwordx4 v201, s[44:47], s69 offen lds
    s_add_u32 m0, s67, 100352
    s_nop 0
    buffer_load_dwordx4 v202, s[44:47], s69 offen lds
    s_add_u32 s69, s64, 393216
    s_add_u32 m0, s67, 110592
    s_nop 0
    buffer_load_dwordx4 v200, s[44:47], s69 offen lds
    s_add_u32 m0, s67, 111616
    s_nop 0
    buffer_load_dwordx4 v201, s[44:47], s69 offen lds
    s_add_u32 m0, s67, 112640
    s_nop 0
    buffer_load_dwordx4 v202, s[44:47], s69 offen lds
    s_add_u32 s69, s64, 384
    s_add_u32 m0, s67, 122880
    s_nop 0
    buffer_load_dwordx4 v200, s[44:47], s69 offen lds
    s_add_u32 m0, s67, 123904
    s_nop 0
    buffer_load_dwordx4 v201, s[44:47], s69 offen lds
    s_add_u32 m0, s67, 124928
    s_nop 0
    buffer_load_dwordx4 v202, s[44:47], s69 offen lds
    s_add_u32 s69, s64, 393600
    s_add_u32 m0, s67, 135168
    s_nop 0
    buffer_load_dwordx4 v200, s[44:47], s69 offen lds
    s_add_u32 m0, s67, 136192
    s_nop 0
    buffer_load_dwordx4 v201, s[44:47], s69 offen lds
    s_add_u32 m0, s67, 137216
    s_nop 0
    buffer_load_dwordx4 v202, s[44:47], s69 offen lds
    s_add_u32 s63, s63, 128
    s_add_u32 s64, s64, 786432
    v_accvgpr_write_b32 a0, 0
    v_accvgpr_write_b32 a1, 0
    v_accvgpr_write_b32 a2, 0
    v_accvgpr_write_b32 a3, 0
    v_accvgpr_write_b32 a4, 0
    v_accvgpr_write_b32 a5, 0
    v_accvgpr_write_b32 a6, 0
    v_accvgpr_write_b32 a7, 0
    v_accvgpr_write_b32 a8, 0
    v_accvgpr_write_b32 a9, 0
    v_accvgpr_write_b32 a10, 0
    v_accvgpr_write_b32 a11, 0
    v_accvgpr_write_b32 a12, 0
    v_accvgpr_write_b32 a13, 0
    v_accvgpr_write_b32 a14, 0
    v_accvgpr_write_b32 a15, 0
    v_accvgpr_write_b32 a16, 0
    v_accvgpr_write_b32 a17, 0
    v_accvgpr_write_b32 a18, 0
    v_accvgpr_write_b32 a19, 0
    v_accvgpr_write_b32 a20, 0
    v_accvgpr_write_b32 a21, 0
    v_accvgpr_write_b32 a22, 0
    v_accvgpr_write_b32 a23, 0
    v_accvgpr_write_b32 a24, 0
    v_accvgpr_write_b32 a25, 0
    v_accvgpr_write_b32 a26, 0
    v_accvgpr_write_b32 a27, 0
    v_accvgpr_write_b32 a28, 0
    v_accvgpr_write_b32 a29, 0
    v_accvgpr_write_b32 a30, 0
    v_accvgpr_write_b32 a31, 0
    v_accvgpr_write_b32 a32, 0
    v_accvgpr_write_b32 a33, 0
    v_accvgpr_write_b32 a34, 0
    v_accvgpr_write_b32 a35, 0
    v_accvgpr_write_b32 a36, 0
    v_accvgpr_write_b32 a37, 0
    v_accvgpr_write_b32 a38, 0
    v_accvgpr_write_b32 a39, 0
    v_accvgpr_write_b32 a40, 0
    v_accvgpr_write_b32 a41, 0
    v_accvgpr_write_b32 a42, 0
    v_accvgpr_write_b32 a43, 0
    v_accvgpr_write_b32 a44, 0
    v_accvgpr_write_b32 a45, 0
    v_accvgpr_write_b32 a46, 0
    v_accvgpr_write_b32 a47, 0
    v_accvgpr_write_b32 a48, 0
    v_accvgpr_write_b32 a49, 0
    v_accvgpr_write_b32 a50, 0
    v_accvgpr_write_b32 a51, 0
    v_accvgpr_write_b32 a52, 0
    v_accvgpr_write_b32 a53, 0
    v_accvgpr_write_b32 a54, 0
    v_accvgpr_write_b32 a55, 0
    v_accvgpr_write_b32 a56, 0
    v_accvgpr_write_b32 a57, 0
    v_accvgpr_write_b32 a58, 0
    v_accvgpr_write_b32 a59, 0
    v_accvgpr_write_b32 a60, 0
    v_accvgpr_write_b32 a61, 0
    v_accvgpr_write_b32 a62, 0
    v_accvgpr_write_b32 a63, 0
    v_accvgpr_write_b32 a64, 0
    v_accvgpr_write_b32 a65, 0
    v_accvgpr_write_b32 a66, 0
    v_accvgpr_write_b32 a67, 0
    v_accvgpr_write_b32 a68, 0
    v_accvgpr_write_b32 a69, 0
    v_accvgpr_write_b32 a70, 0
    v_accvgpr_write_b32 a71, 0
    v_accvgpr_write_b32 a72, 0
    v_accvgpr_write_b32 a73, 0
    v_accvgpr_write_b32 a74, 0
    v_accvgpr_write_b32 a75, 0
    v_accvgpr_write_b32 a76, 0
    v_accvgpr_write_b32 a77, 0
    v_accvgpr_write_b32 a78, 0
    v_accvgpr_write_b32 a79, 0
    v_accvgpr_write_b32 a80, 0
    v_accvgpr_write_b32 a81, 0
    v_accvgpr_write_b32 a82, 0
    v_accvgpr_write_b32 a83, 0
    v_accvgpr_write_b32 a84, 0
    v_accvgpr_write_b32 a85, 0
    v_accvgpr_write_b32 a86, 0
    v_accvgpr_write_b32 a87, 0
    v_accvgpr_write_b32 a88, 0
    v_accvgpr_write_b32 a89, 0
    v_accvgpr_write_b32 a90, 0
    v_accvgpr_write_b32 a91, 0
    v_accvgpr_write_b32 a92, 0
    v_accvgpr_write_b32 a93, 0
    v_accvgpr_write_b32 a94, 0
    v_accvgpr_write_b32 a95, 0
    v_accvgpr_write_b32 a96, 0
    v_accvgpr_write_b32 a97, 0
    v_accvgpr_write_b32 a98, 0
    v_accvgpr_write_b32 a99, 0
    v_accvgpr_write_b32 a100, 0
    v_accvgpr_write_b32 a101, 0
    v_accvgpr_write_b32 a102, 0
    v_accvgpr_write_b32 a103, 0
    v_accvgpr_write_b32 a104, 0
    v_accvgpr_write_b32 a105, 0
    v_accvgpr_write_b32 a106, 0
    v_accvgpr_write_b32 a107, 0
    v_accvgpr_write_b32 a108, 0
    v_accvgpr_write_b32 a109, 0
    v_accvgpr_write_b32 a110, 0
    v_accvgpr_write_b32 a111, 0
    v_accvgpr_write_b32 a112, 0
    v_accvgpr_write_b32 a113, 0
    v_accvgpr_write_b32 a114, 0
    v_accvgpr_write_b32 a115, 0
    v_accvgpr_write_b32 a116, 0
    v_accvgpr_write_b32 a117, 0
    v_accvgpr_write_b32 a118, 0
    v_accvgpr_write_b32 a119, 0
    v_accvgpr_write_b32 a120, 0
    v_accvgpr_write_b32 a121, 0
    v_accvgpr_write_b32 a122, 0
    v_accvgpr_write_b32 a123, 0
    v_accvgpr_write_b32 a124, 0
    v_accvgpr_write_b32 a125, 0
    v_accvgpr_write_b32 a126, 0
    v_accvgpr_write_b32 a127, 0
    v_accvgpr_write_b32 a128, 0
    v_accvgpr_write_b32 a129, 0
    v_accvgpr_write_b32 a130, 0
    v_accvgpr_write_b32 a131, 0
    v_accvgpr_write_b32 a132, 0
    v_accvgpr_write_b32 a133, 0
    v_accvgpr_write_b32 a134, 0
    v_accvgpr_write_b32 a135, 0
    v_accvgpr_write_b32 a136, 0
    v_accvgpr_write_b32 a137, 0
    v_accvgpr_write_b32 a138, 0
    v_accvgpr_write_b32 a139, 0
    v_accvgpr_write_b32 a140, 0
    v_accvgpr_write_b32 a141, 0
    v_accvgpr_write_b32 a142, 0
    v_accvgpr_write_b32 a143, 0
    v_accvgpr_write_b32 a144, 0
    v_accvgpr_write_b32 a145, 0
    v_accvgpr_write_b32 a146, 0
    v_accvgpr_write_b32 a147, 0
    v_accvgpr_write_b32 a148, 0
    v_accvgpr_write_b32 a149, 0
    v_accvgpr_write_b32 a150, 0
    v_accvgpr_write_b32 a151, 0
    v_accvgpr_write_b32 a152, 0
    v_accvgpr_write_b32 a153, 0
    v_accvgpr_write_b32 a154, 0
    v_accvgpr_write_b32 a155, 0
    v_accvgpr_write_b32 a156, 0
    v_accvgpr_write_b32 a157, 0
    v_accvgpr_write_b32 a158, 0
    v_accvgpr_write_b32 a159, 0
    v_accvgpr_write_b32 a160, 0
    v_accvgpr_write_b32 a161, 0
    v_accvgpr_write_b32 a162, 0
    v_accvgpr_write_b32 a163, 0
    v_accvgpr_write_b32 a164, 0
    v_accvgpr_write_b32 a165, 0
    v_accvgpr_write_b32 a166, 0
    v_accvgpr_write_b32 a167, 0
    v_accvgpr_write_b32 a168, 0
    v_accvgpr_write_b32 a169, 0
    v_accvgpr_write_b32 a170, 0
    v_accvgpr_write_b32 a171, 0
    v_accvgpr_write_b32 a172, 0
    v_accvgpr_write_b32 a173, 0
    v_accvgpr_write_b32 a174, 0
    v_accvgpr_write_b32 a175, 0
    v_accvgpr_write_b32 a176, 0
    v_accvgpr_write_b32 a177, 0
    v_accvgpr_write_b32 a178, 0
    v_accvgpr_write_b32 a179, 0
    v_accvgpr_write_b32 a180, 0
    v_accvgpr_write_b32 a181, 0
    v_accvgpr_write_b32 a182, 0
    v_accvgpr_write_b32 a183, 0
    v_accvgpr_write_b32 a184, 0
    v_accvgpr_write_b32 a185, 0
    v_accvgpr_write_b32 a186, 0
    v_accvgpr_write_b32 a187, 0
    v_accvgpr_write_b32 a188, 0
    v_accvgpr_write_b32 a189, 0
    v_accvgpr_write_b32 a190, 0
    v_accvgpr_write_b32 a191, 0
    v_accvgpr_write_b32 a192, 0
    v_accvgpr_write_b32 a193, 0
    v_accvgpr_write_b32 a194, 0
    v_accvgpr_write_b32 a195, 0
    v_accvgpr_write_b32 a196, 0
    v_accvgpr_write_b32 a197, 0
    v_accvgpr_write_b32 a198, 0
    v_accvgpr_write_b32 a199, 0
    v_accvgpr_write_b32 a200, 0
    v_accvgpr_write_b32 a201, 0
    v_accvgpr_write_b32 a202, 0
    v_accvgpr_write_b32 a203, 0
    v_accvgpr_write_b32 a204, 0
    v_accvgpr_write_b32 a205, 0
    v_accvgpr_write_b32 a206, 0
    v_accvgpr_write_b32 a207, 0
    v_accvgpr_write_b32 a208, 0
    v_accvgpr_write_b32 a209, 0
    v_accvgpr_write_b32 a210, 0
    v_accvgpr_write_b32 a211, 0
    v_accvgpr_write_b32 a212, 0
    v_accvgpr_write_b32 a213, 0
    v_accvgpr_write_b32 a214, 0
    v_accvgpr_write_b32 a215, 0
    v_accvgpr_write_b32 a216, 0
    v_accvgpr_write_b32 a217, 0
    v_accvgpr_write_b32 a218, 0
    v_accvgpr_write_b32 a219, 0
    v_accvgpr_write_b32 a220, 0
    v_accvgpr_write_b32 a221, 0
    v_accvgpr_write_b32 a222, 0
    v_accvgpr_write_b32 a223, 0
    v_accvgpr_write_b32 a224, 0
    v_accvgpr_write_b32 a225, 0
    v_accvgpr_write_b32 a226, 0
    v_accvgpr_write_b32 a227, 0
    v_accvgpr_write_b32 a228, 0
    v_accvgpr_write_b32 a229, 0
    v_accvgpr_write_b32 a230, 0
    v_accvgpr_write_b32 a231, 0
    v_accvgpr_write_b32 a232, 0
    v_accvgpr_write_b32 a233, 0
    v_accvgpr_write_b32 a234, 0
    v_accvgpr_write_b32 a235, 0
    v_accvgpr_write_b32 a236, 0
    v_accvgpr_write_b32 a237, 0
    v_accvgpr_write_b32 a238, 0
    v_accvgpr_write_b32 a239, 0
    v_accvgpr_write_b32 a240, 0
    v_accvgpr_write_b32 a241, 0
    v_accvgpr_write_b32 a242, 0
    v_accvgpr_write_b32 a243, 0
    v_accvgpr_write_b32 a244, 0
    v_accvgpr_write_b32 a245, 0
    v_accvgpr_write_b32 a246, 0
    v_accvgpr_write_b32 a247, 0
    v_accvgpr_write_b32 a248, 0
    v_accvgpr_write_b32 a249, 0
    v_accvgpr_write_b32 a250, 0
    v_accvgpr_write_b32 a251, 0
    v_accvgpr_write_b32 a252, 0
    v_accvgpr_write_b32 a253, 0
    v_accvgpr_write_b32 a254, 0
    v_accvgpr_write_b32 a255, 0
    v_mov_b32 v72, 0
    v_mov_b32 v73, 0
    v_mov_b32 v74, 0
    v_mov_b32 v75, 0
    v_mov_b32 v76, 0
    v_mov_b32 v77, 0
    v_mov_b32 v78, 0
    v_mov_b32 v79, 0
    v_mov_b32 v80, 0
    v_mov_b32 v81, 0
    v_mov_b32 v82, 0
    v_mov_b32 v83, 0
    v_mov_b32 v84, 0
    v_mov_b32 v85, 0
    v_mov_b32 v86, 0
    v_mov_b32 v87, 0
    v_mov_b32 v88, 0
    v_mov_b32 v89, 0
    v_mov_b32 v90, 0
    v_mov_b32 v91, 0
    v_mov_b32 v92, 0
    v_mov_b32 v93, 0
    v_mov_b32 v94, 0
    v_mov_b32 v95, 0
    v_mov_b32 v96, 0
    v_mov_b32 v97, 0
    v_mov_b32 v98, 0
    v_mov_b32 v99, 0
    v_mov_b32 v100, 0
    v_mov_b32 v101, 0
    v_mov_b32 v102, 0
    v_mov_b32 v103, 0
    v_add_u32 v188, 0, v192
    v_add_u32 v189, 0, v193
    v_add_u32 v190, 0, v194
    v_add_u32 v191, 0, v195
    v_add_u32 v186, 0, v204
    v_add_u32 v187, 0, v205
    s_waitcnt vmcnt(18)
    s_barrier
    ds_read_b128 v[104:107], v204 offset:0
    ds_read_b128 v[108:111], v204 offset:2048
    ds_read_b128 v[112:115], v204 offset:4096
    ds_read_b128 v[116:119], v205 offset:0
    ds_read_b128 v[120:123], v205 offset:2048
    ds_read_b128 v[124:127], v205 offset:4096
    ds_read_b64_tr_b16 v[144:145], v188 offset:24576
    ds_read_b64_tr_b16 v[146:147], v188 offset:26112
    ds_read_b64_tr_b16 v[148:149], v189 offset:24576
    ds_read_b64_tr_b16 v[150:151], v189 offset:26112
    ds_read_b64_tr_b16 v[152:153], v190 offset:24576
    ds_read_b64_tr_b16 v[154:155], v190 offset:26112
    ds_read_b64_tr_b16 v[156:157], v191 offset:24576
    ds_read_b64_tr_b16 v[158:159], v191 offset:26112
    ds_read_b64_tr_b16 v[160:161], v188 offset:24704
    ds_read_b64_tr_b16 v[162:163], v188 offset:26240
    s_waitcnt lgkmcnt(8)
    v_mfma_f32_16x16x32_bf16 a[0:3], v[144:147], v[104:107], a[0:3]
    v_mfma_f32_16x16x32_bf16 a[4:7], v[144:147], v[108:111], a[4:7]
    v_mfma_f32_16x16x32_bf16 a[8:11], v[144:147], v[112:115], a[8:11]
    ds_read_b64_tr_b16 v[164:165], v189 offset:24704
    ds_read_b64_tr_b16 v[166:167], v189 offset:26240
    s_waitcnt lgkmcnt(8)
    v_mfma_f32_16x16x32_bf16 a[12:15], v[148:151], v[104:107], a[12:15]
    v_mfma_f32_16x16x32_bf16 a[16:19], v[148:151], v[108:111], a[16:19]
    v_mfma_f32_16x16x32_bf16 a[20:23], v[148:151], v[112:115], a[20:23]
    ds_read_b64_tr_b16 v[144:145], v190 offset:24704
    ds_read_b64_tr_b16 v[146:147], v190 offset:26240
    s_waitcnt lgkmcnt(8)
    v_mfma_f32_16x16x32_bf16 a[24:27], v[152:155], v[104:107], a[24:27]
    v_mfma_f32_16x16x32_bf16 a[28:31], v[152:155], v[108:111], a[28:31]
    v_mfma_f32_16x16x32_bf16 a[32:35], v[152:155], v[112:115], a[32:35]
    ds_read_b64_tr_b16 v[148:149], v191 offset:24704
    ds_read_b64_tr_b16 v[150:151], v191 offset:26240
    s_waitcnt lgkmcnt(8)
    v_mfma_f32_16x16x32_bf16 a[36:39], v[156:159], v[104:107], a[36:39]
    v_mfma_f32_16x16x32_bf16 a[40:43], v[156:159], v[108:111], a[40:43]
    v_mfma_f32_16x16x32_bf16 a[44:47], v[156:159], v[112:115], a[44:47]
    ds_read_b64_tr_b16 v[152:153], v188 offset:24832
    ds_read_b64_tr_b16 v[154:155], v188 offset:26368
    s_waitcnt lgkmcnt(8)
    v_mfma_f32_16x16x32_bf16 a[48:51], v[160:163], v[104:107], a[48:51]
    v_mfma_f32_16x16x32_bf16 a[52:55], v[160:163], v[108:111], a[52:55]
    v_mfma_f32_16x16x32_bf16 a[56:59], v[160:163], v[112:115], a[56:59]
    ds_read_b64_tr_b16 v[156:157], v189 offset:24832
    ds_read_b64_tr_b16 v[158:159], v189 offset:26368
    s_waitcnt lgkmcnt(8)
    v_mfma_f32_16x16x32_bf16 a[60:63], v[164:167], v[104:107], a[60:63]
    v_mfma_f32_16x16x32_bf16 a[64:67], v[164:167], v[108:111], a[64:67]
    v_mfma_f32_16x16x32_bf16 a[68:71], v[164:167], v[112:115], a[68:71]
    ds_read_b64_tr_b16 v[160:161], v190 offset:24832
    ds_read_b64_tr_b16 v[162:163], v190 offset:26368
    s_waitcnt lgkmcnt(8)
    v_mfma_f32_16x16x32_bf16 a[72:75], v[144:147], v[104:107], a[72:75]
    v_mfma_f32_16x16x32_bf16 a[76:79], v[144:147], v[108:111], a[76:79]
    v_mfma_f32_16x16x32_bf16 a[80:83], v[144:147], v[112:115], a[80:83]
    ds_read_b64_tr_b16 v[164:165], v191 offset:24832
    ds_read_b64_tr_b16 v[166:167], v191 offset:26368
    s_waitcnt lgkmcnt(8)
    v_mfma_f32_16x16x32_bf16 a[84:87], v[148:151], v[104:107], a[84:87]
    v_mfma_f32_16x16x32_bf16 a[88:91], v[148:151], v[108:111], a[88:91]
    v_mfma_f32_16x16x32_bf16 a[92:95], v[148:151], v[112:115], a[92:95]
    ds_read_b64_tr_b16 v[144:145], v188 offset:49152
    ds_read_b64_tr_b16 v[146:147], v188 offset:50688
    s_waitcnt lgkmcnt(8)
    v_mfma_f32_16x16x32_bf16 a[96:99], v[152:155], v[104:107], a[96:99]
    v_mfma_f32_16x16x32_bf16 a[100:103], v[152:155], v[108:111], a[100:103]
    v_mfma_f32_16x16x32_bf16 a[104:107], v[152:155], v[112:115], a[104:107]
    ds_read_b64_tr_b16 v[148:149], v189 offset:49152
    ds_read_b64_tr_b16 v[150:151], v189 offset:50688
    s_waitcnt lgkmcnt(8)
    v_mfma_f32_16x16x32_bf16 a[108:111], v[156:159], v[104:107], a[108:111]
    v_mfma_f32_16x16x32_bf16 a[112:115], v[156:159], v[108:111], a[112:115]
    v_mfma_f32_16x16x32_bf16 a[116:119], v[156:159], v[112:115], a[116:119]
    ds_read_b64_tr_b16 v[152:153], v190 offset:49152
    ds_read_b64_tr_b16 v[154:155], v190 offset:50688
    s_waitcnt lgkmcnt(8)
    v_mfma_f32_16x16x32_bf16 a[120:123], v[160:163], v[104:107], a[120:123]
    v_mfma_f32_16x16x32_bf16 a[124:127], v[160:163], v[108:111], a[124:127]
    v_mfma_f32_16x16x32_bf16 a[128:131], v[160:163], v[112:115], a[128:131]
    ds_read_b64_tr_b16 v[156:157], v191 offset:49152
    ds_read_b64_tr_b16 v[158:159], v191 offset:50688
    s_waitcnt lgkmcnt(8)
    v_mfma_f32_16x16x32_bf16 a[132:135], v[164:167], v[104:107], a[132:135]
    v_mfma_f32_16x16x32_bf16 a[136:139], v[164:167], v[108:111], a[136:139]
    v_mfma_f32_16x16x32_bf16 a[140:143], v[164:167], v[112:115], a[140:143]
    ds_read_b64_tr_b16 v[160:161], v188 offset:49280
    ds_read_b64_tr_b16 v[162:163], v188 offset:50816
    s_waitcnt lgkmcnt(8)
    v_mfma_f32_16x16x32_bf16 a[144:147], v[144:147], v[104:107], a[144:147]
    v_mfma_f32_16x16x32_bf16 a[148:151], v[144:147], v[108:111], a[148:151]
    v_mfma_f32_16x16x32_bf16 a[152:155], v[144:147], v[112:115], a[152:155]
    ds_read_b64_tr_b16 v[164:165], v189 offset:49280
    ds_read_b64_tr_b16 v[166:167], v189 offset:50816
    s_waitcnt lgkmcnt(8)
    v_mfma_f32_16x16x32_bf16 a[156:159], v[148:151], v[104:107], a[156:159]
    v_mfma_f32_16x16x32_bf16 a[160:163], v[148:151], v[108:111], a[160:163]
    v_mfma_f32_16x16x32_bf16 a[164:167], v[148:151], v[112:115], a[164:167]
    ds_read_b64_tr_b16 v[144:145], v190 offset:49280
    ds_read_b64_tr_b16 v[146:147], v190 offset:50816
    s_waitcnt lgkmcnt(8)
    v_mfma_f32_16x16x32_bf16 a[168:171], v[152:155], v[104:107], a[168:171]
    v_mfma_f32_16x16x32_bf16 a[172:175], v[152:155], v[108:111], a[172:175]
    v_mfma_f32_16x16x32_bf16 a[176:179], v[152:155], v[112:115], a[176:179]
    ds_read_b64_tr_b16 v[148:149], v191 offset:49280
    ds_read_b64_tr_b16 v[150:151], v191 offset:50816
    s_waitcnt lgkmcnt(8)
    v_mfma_f32_16x16x32_bf16 a[180:183], v[156:159], v[104:107], a[180:183]
    v_mfma_f32_16x16x32_bf16 a[184:187], v[156:159], v[108:111], a[184:187]
    v_mfma_f32_16x16x32_bf16 a[188:191], v[156:159], v[112:115], a[188:191]
    ds_read_b64_tr_b16 v[152:153], v188 offset:49408
    ds_read_b64_tr_b16 v[154:155], v188 offset:50944
    s_waitcnt lgkmcnt(8)
    v_mfma_f32_16x16x32_bf16 a[192:195], v[160:163], v[104:107], a[192:195]
    v_mfma_f32_16x16x32_bf16 a[196:199], v[160:163], v[108:111], a[196:199]
    v_mfma_f32_16x16x32_bf16 a[200:203], v[160:163], v[112:115], a[200:203]
    ds_read_b64_tr_b16 v[156:157], v189 offset:49408
    ds_read_b64_tr_b16 v[158:159], v189 offset:50944
    s_waitcnt lgkmcnt(8)
    v_mfma_f32_16x16x32_bf16 a[204:207], v[164:167], v[104:107], a[204:207]
    v_mfma_f32_16x16x32_bf16 a[208:211], v[164:167], v[108:111], a[208:211]
    v_mfma_f32_16x16x32_bf16 a[212:215], v[164:167], v[112:115], a[212:215]
    ds_read_b64_tr_b16 v[160:161], v190 offset:49408
    ds_read_b64_tr_b16 v[162:163], v190 offset:50944
    s_waitcnt lgkmcnt(8)
    v_mfma_f32_16x16x32_bf16 a[216:219], v[144:147], v[104:107], a[216:219]
    v_mfma_f32_16x16x32_bf16 a[220:223], v[144:147], v[108:111], a[220:223]
    v_mfma_f32_16x16x32_bf16 a[224:227], v[144:147], v[112:115], a[224:227]
    ds_read_b64_tr_b16 v[164:165], v191 offset:49408
    ds_read_b64_tr_b16 v[166:167], v191 offset:50944
    s_waitcnt lgkmcnt(8)
    v_mfma_f32_16x16x32_bf16 a[228:231], v[148:151], v[104:107], a[228:231]
    v_mfma_f32_16x16x32_bf16 a[232:235], v[148:151], v[108:111], a[232:235]
    v_mfma_f32_16x16x32_bf16 a[236:239], v[148:151], v[112:115], a[236:239]
    ds_read_b64_tr_b16 v[144:145], v188 offset:36864
    ds_read_b64_tr_b16 v[146:147], v188 offset:38400
    s_waitcnt lgkmcnt(8)
    v_mfma_f32_16x16x32_bf16 a[240:243], v[152:155], v[104:107], a[240:243]
    v_mfma_f32_16x16x32_bf16 a[244:247], v[152:155], v[108:111], a[244:247]
    v_mfma_f32_16x16x32_bf16 a[248:251], v[152:155], v[112:115], a[248:251]
    ds_read_b64_tr_b16 v[148:149], v189 offset:36864
    ds_read_b64_tr_b16 v[150:151], v189 offset:38400
    s_waitcnt lgkmcnt(8)
    v_mfma_f32_16x16x32_bf16 a[252:255], v[156:159], v[104:107], a[252:255]
    v_mfma_f32_16x16x32_bf16 v[72:75], v[156:159], v[108:111], v[72:75]
    v_mfma_f32_16x16x32_bf16 v[76:79], v[156:159], v[112:115], v[76:79]
    ds_read_b64_tr_b16 v[152:153], v190 offset:36864
    ds_read_b64_tr_b16 v[154:155], v190 offset:38400
    s_waitcnt lgkmcnt(8)
    v_mfma_f32_16x16x32_bf16 v[80:83], v[160:163], v[104:107], v[80:83]
    v_mfma_f32_16x16x32_bf16 v[84:87], v[160:163], v[108:111], v[84:87]
    v_mfma_f32_16x16x32_bf16 v[88:91], v[160:163], v[112:115], v[88:91]
    ds_read_b64_tr_b16 v[156:157], v191 offset:36864
    ds_read_b64_tr_b16 v[158:159], v191 offset:38400
    s_waitcnt lgkmcnt(8)
    v_mfma_f32_16x16x32_bf16 v[92:95], v[164:167], v[104:107], v[92:95]
    v_mfma_f32_16x16x32_bf16 v[96:99], v[164:167], v[108:111], v[96:99]
    v_mfma_f32_16x16x32_bf16 v[100:103], v[164:167], v[112:115], v[100:103]
    ds_read_b64_tr_b16 v[160:161], v188 offset:36992
    ds_read_b64_tr_b16 v[162:163], v188 offset:38528
    s_waitcnt lgkmcnt(8)
    v_mfma_f32_16x16x32_bf16 a[0:3], v[144:147], v[116:119], a[0:3]
    v_mfma_f32_16x16x32_bf16 a[4:7], v[144:147], v[120:123], a[4:7]
    v_mfma_f32_16x16x32_bf16 a[8:11], v[144:147], v[124:127], a[8:11]
    ds_read_b64_tr_b16 v[164:165], v189 offset:36992
    ds_read_b64_tr_b16 v[166:167], v189 offset:38528
    s_waitcnt lgkmcnt(8)
    v_mfma_f32_16x16x32_bf16 a[12:15], v[148:151], v[116:119], a[12:15]
    v_mfma_f32_16x16x32_bf16 a[16:19], v[148:151], v[120:123], a[16:19]
    v_mfma_f32_16x16x32_bf16 a[20:23], v[148:151], v[124:127], a[20:23]
    ds_read_b64_tr_b16 v[144:145], v190 offset:36992
    ds_read_b64_tr_b16 v[146:147], v190 offset:38528
    s_waitcnt lgkmcnt(8)
    v_mfma_f32_16x16x32_bf16 a[24:27], v[152:155], v[116:119], a[24:27]
    v_mfma_f32_16x16x32_bf16 a[28:31], v[152:155], v[120:123], a[28:31]
    v_mfma_f32_16x16x32_bf16 a[32:35], v[152:155], v[124:127], a[32:35]
    ds_read_b64_tr_b16 v[148:149], v191 offset:36992
    ds_read_b64_tr_b16 v[150:151], v191 offset:38528
    s_waitcnt lgkmcnt(8)
    v_mfma_f32_16x16x32_bf16 a[36:39], v[156:159], v[116:119], a[36:39]
    v_mfma_f32_16x16x32_bf16 a[40:43], v[156:159], v[120:123], a[40:43]
    v_mfma_f32_16x16x32_bf16 a[44:47], v[156:159], v[124:127], a[44:47]
    ds_read_b64_tr_b16 v[152:153], v188 offset:37120
    ds_read_b64_tr_b16 v[154:155], v188 offset:38656
    s_waitcnt lgkmcnt(8)
    v_mfma_f32_16x16x32_bf16 a[48:51], v[160:163], v[116:119], a[48:51]
    v_mfma_f32_16x16x32_bf16 a[52:55], v[160:163], v[120:123], a[52:55]
    v_mfma_f32_16x16x32_bf16 a[56:59], v[160:163], v[124:127], a[56:59]
    ds_read_b64_tr_b16 v[156:157], v189 offset:37120
    ds_read_b64_tr_b16 v[158:159], v189 offset:38656
    s_waitcnt lgkmcnt(8)
    v_mfma_f32_16x16x32_bf16 a[60:63], v[164:167], v[116:119], a[60:63]
    v_mfma_f32_16x16x32_bf16 a[64:67], v[164:167], v[120:123], a[64:67]
    v_mfma_f32_16x16x32_bf16 a[68:71], v[164:167], v[124:127], a[68:71]
    ds_read_b64_tr_b16 v[160:161], v190 offset:37120
    ds_read_b64_tr_b16 v[162:163], v190 offset:38656
    s_waitcnt lgkmcnt(8)
    v_mfma_f32_16x16x32_bf16 a[72:75], v[144:147], v[116:119], a[72:75]
    v_mfma_f32_16x16x32_bf16 a[76:79], v[144:147], v[120:123], a[76:79]
    v_mfma_f32_16x16x32_bf16 a[80:83], v[144:147], v[124:127], a[80:83]
    ds_read_b64_tr_b16 v[164:165], v191 offset:37120
    ds_read_b64_tr_b16 v[166:167], v191 offset:38656
    s_waitcnt lgkmcnt(8)
    v_mfma_f32_16x16x32_bf16 a[84:87], v[148:151], v[116:119], a[84:87]
    v_mfma_f32_16x16x32_bf16 a[88:91], v[148:151], v[120:123], a[88:91]
    v_mfma_f32_16x16x32_bf16 a[92:95], v[148:151], v[124:127], a[92:95]
    ds_read_b64_tr_b16 v[144:145], v188 offset:61440
    ds_read_b64_tr_b16 v[146:147], v188 offset:62976
    s_waitcnt lgkmcnt(8)
    v_mfma_f32_16x16x32_bf16 a[96:99], v[152:155], v[116:119], a[96:99]
    v_mfma_f32_16x16x32_bf16 a[100:103], v[152:155], v[120:123], a[100:103]
    v_mfma_f32_16x16x32_bf16 a[104:107], v[152:155], v[124:127], a[104:107]
    ds_read_b64_tr_b16 v[148:149], v189 offset:61440
    ds_read_b64_tr_b16 v[150:151], v189 offset:62976
    s_waitcnt lgkmcnt(8)
    v_mfma_f32_16x16x32_bf16 a[108:111], v[156:159], v[116:119], a[108:111]
    v_mfma_f32_16x16x32_bf16 a[112:115], v[156:159], v[120:123], a[112:115]
    v_mfma_f32_16x16x32_bf16 a[116:119], v[156:159], v[124:127], a[116:119]
    ds_read_b64_tr_b16 v[152:153], v190 offset:61440
    ds_read_b64_tr_b16 v[154:155], v190 offset:62976
    s_waitcnt lgkmcnt(8)
    v_mfma_f32_16x16x32_bf16 a[120:123], v[160:163], v[116:119], a[120:123]
    v_mfma_f32_16x16x32_bf16 a[124:127], v[160:163], v[120:123], a[124:127]
    v_mfma_f32_16x16x32_bf16 a[128:131], v[160:163], v[124:127], a[128:131]
    ds_read_b64_tr_b16 v[156:157], v191 offset:61440
    ds_read_b64_tr_b16 v[158:159], v191 offset:62976
    s_waitcnt lgkmcnt(8)
    v_mfma_f32_16x16x32_bf16 a[132:135], v[164:167], v[116:119], a[132:135]
    v_mfma_f32_16x16x32_bf16 a[136:139], v[164:167], v[120:123], a[136:139]
    v_mfma_f32_16x16x32_bf16 a[140:143], v[164:167], v[124:127], a[140:143]
    ds_read_b64_tr_b16 v[160:161], v188 offset:61568
    ds_read_b64_tr_b16 v[162:163], v188 offset:63104
    s_waitcnt lgkmcnt(8)
    v_mfma_f32_16x16x32_bf16 a[144:147], v[144:147], v[116:119], a[144:147]
    v_mfma_f32_16x16x32_bf16 a[148:151], v[144:147], v[120:123], a[148:151]
    v_mfma_f32_16x16x32_bf16 a[152:155], v[144:147], v[124:127], a[152:155]
    ds_read_b64_tr_b16 v[164:165], v189 offset:61568
    ds_read_b64_tr_b16 v[166:167], v189 offset:63104
    s_waitcnt lgkmcnt(8)
    v_mfma_f32_16x16x32_bf16 a[156:159], v[148:151], v[116:119], a[156:159]
    v_mfma_f32_16x16x32_bf16 a[160:163], v[148:151], v[120:123], a[160:163]
    v_mfma_f32_16x16x32_bf16 a[164:167], v[148:151], v[124:127], a[164:167]
    ds_read_b64_tr_b16 v[144:145], v190 offset:61568
    ds_read_b64_tr_b16 v[146:147], v190 offset:63104
    s_waitcnt lgkmcnt(8)
    v_mfma_f32_16x16x32_bf16 a[168:171], v[152:155], v[116:119], a[168:171]
    v_mfma_f32_16x16x32_bf16 a[172:175], v[152:155], v[120:123], a[172:175]
    v_mfma_f32_16x16x32_bf16 a[176:179], v[152:155], v[124:127], a[176:179]
    ds_read_b64_tr_b16 v[148:149], v191 offset:61568
    ds_read_b64_tr_b16 v[150:151], v191 offset:63104
    s_waitcnt lgkmcnt(8)
    v_mfma_f32_16x16x32_bf16 a[180:183], v[156:159], v[116:119], a[180:183]
    v_mfma_f32_16x16x32_bf16 a[184:187], v[156:159], v[120:123], a[184:187]
    v_mfma_f32_16x16x32_bf16 a[188:191], v[156:159], v[124:127], a[188:191]
    ds_read_b64_tr_b16 v[152:153], v188 offset:61696
    ds_read_b64_tr_b16 v[154:155], v188 offset:63232
    s_waitcnt lgkmcnt(8)
    v_mfma_f32_16x16x32_bf16 a[192:195], v[160:163], v[116:119], a[192:195]
    v_mfma_f32_16x16x32_bf16 a[196:199], v[160:163], v[120:123], a[196:199]
    v_mfma_f32_16x16x32_bf16 a[200:203], v[160:163], v[124:127], a[200:203]
    ds_read_b64_tr_b16 v[156:157], v189 offset:61696
    ds_read_b64_tr_b16 v[158:159], v189 offset:63232
    s_waitcnt lgkmcnt(8)
    v_mfma_f32_16x16x32_bf16 a[204:207], v[164:167], v[116:119], a[204:207]
    v_mfma_f32_16x16x32_bf16 a[208:211], v[164:167], v[120:123], a[208:211]
    v_mfma_f32_16x16x32_bf16 a[212:215], v[164:167], v[124:127], a[212:215]
    ds_read_b64_tr_b16 v[160:161], v190 offset:61696
    ds_read_b64_tr_b16 v[162:163], v190 offset:63232
    s_waitcnt lgkmcnt(8)
    v_mfma_f32_16x16x32_bf16 a[216:219], v[144:147], v[116:119], a[216:219]
    v_mfma_f32_16x16x32_bf16 a[220:223], v[144:147], v[120:123], a[220:223]
    v_mfma_f32_16x16x32_bf16 a[224:227], v[144:147], v[124:127], a[224:227]
    ds_read_b64_tr_b16 v[164:165], v191 offset:61696
    ds_read_b64_tr_b16 v[166:167], v191 offset:63232
    s_waitcnt lgkmcnt(8)
    v_mfma_f32_16x16x32_bf16 a[228:231], v[148:151], v[116:119], a[228:231]
    v_mfma_f32_16x16x32_bf16 a[232:235], v[148:151], v[120:123], a[232:235]
    v_mfma_f32_16x16x32_bf16 a[236:239], v[148:151], v[124:127], a[236:239]
    s_waitcnt lgkmcnt(6)
    v_mfma_f32_16x16x32_bf16 a[240:243], v[152:155], v[116:119], a[240:243]
    v_mfma_f32_16x16x32_bf16 a[244:247], v[152:155], v[120:123], a[244:247]
    v_mfma_f32_16x16x32_bf16 a[248:251], v[152:155], v[124:127], a[248:251]
    s_waitcnt lgkmcnt(4)
    v_mfma_f32_16x16x32_bf16 a[252:255], v[156:159], v[116:119], a[252:255]
    v_mfma_f32_16x16x32_bf16 v[72:75], v[156:159], v[120:123], v[72:75]
    v_mfma_f32_16x16x32_bf16 v[76:79], v[156:159], v[124:127], v[76:79]
    s_waitcnt lgkmcnt(2)
    v_mfma_f32_16x16x32_bf16 v[80:83], v[160:163], v[116:119], v[80:83]
    v_mfma_f32_16x16x32_bf16 v[84:87], v[160:163], v[120:123], v[84:87]
    v_mfma_f32_16x16x32_bf16 v[88:91], v[160:163], v[124:127], v[88:91]
    s_waitcnt lgkmcnt(0)
    v_mfma_f32_16x16x32_bf16 v[92:95], v[164:167], v[116:119], v[92:95]
    v_mfma_f32_16x16x32_bf16 v[96:99], v[164:167], v[120:123], v[96:99]
    v_mfma_f32_16x16x32_bf16 v[100:103], v[164:167], v[124:127], v[100:103]
    s_mov_b32 s60, 0
L_k1_q1:
    v_add_u32 v188, 73728, v192
    v_add_u32 v189, 73728, v193
    v_add_u32 v190, 73728, v194
    v_add_u32 v191, 73728, v195
    v_add_u32 v186, 73728, v204
    v_add_u32 v187, 73728, v205
    s_waitcnt vmcnt(0)
    s_barrier
    ds_read_b128 v[104:107], v186 offset:0
    ds_read_b128 v[108:111], v186 offset:2048
    ds_read_b128 v[112:115], v186 offset:4096
    ds_read_b128 v[116:119], v187 offset:0
    ds_read_b128 v[120:123], v187 offset:2048
    ds_read_b128 v[124:127], v187 offset:4096
    ds_read_b64_tr_b16 v[144:145], v188 offset:24576
    ds_read_b64_tr_b16 v[146:147], v188 offset:26112
    ds_read_b64_tr_b16 v[148:149], v189 offset:24576
    ds_read_b64_tr_b16 v[150:151], v189 offset:26112
    ds_read_b64_tr_b16 v[152:153], v190 offset:24576
    ds_read_b64_tr_b16 v[154:155], v190 offset:26112
    ds_read_b64_tr_b16 v[156:157], v191 offset:24576
    ds_read_b64_tr_b16 v[158:159], v191 offset:26112
    ds_read_b64_tr_b16 v[160:161], v188 offset:24704
    ds_read_b64_tr_b16 v[162:163], v188 offset:26240
    s_waitcnt lgkmcnt(8)
    v_mfma_f32_16x16x32_bf16 a[0:3], v[144:147], v[104:107], a[0:3]
    s_add_u32 m0, s78, 0
    v_mfma_f32_16x16x32_bf16 a[4:7], v[144:147], v[108:111], a[4:7]
    s_add_u32 s69, s63, 0
    v_mfma_f32_16x16x32_bf16 a[8:11], v[144:147], v[112:115], a[8:11]
    ds_read_b64_tr_b16 v[164:165], v189 offset:24704
    ds_read_b64_tr_b16 v[166:167], v189 offset:26240
    s_waitcnt lgkmcnt(8)
    v_mfma_f32_16x16x32_bf16 a[12:15], v[148:151], v[104:107], a[12:15]
    buffer_load_dwordx4 v203, s[40:43], s69 offen lds
    v_mfma_f32_16x16x32_bf16 a[16:19], v[148:151], v[108:111], a[16:19]
    v_mfma_f32_16x16x32_bf16 a[20:23], v[148:151], v[112:115], a[20:23]
    s_add_u32 m0, s78, 1024
    ds_read_b64_tr_b16 v[144:145], v190 offset:24704
    ds_read_b64_tr_b16 v[146:147], v190 offset:26240
    s_waitcnt lgkmcnt(8)
    v_mfma_f32_16x16x32_bf16 a[24:27], v[152:155], v[104:107], a[24:27]
    s_add_u32 s69, s63, 10240
    v_mfma_f32_16x16x32_bf16 a[28:31], v[152:155], v[108:111], a[28:31]
    v_mfma_f32_16x16x32_bf16 a[32:35], v[152:155], v[112:115], a[32:35]
    buffer_load_dwordx4 v203, s[40:43], s69 offen lds
    ds_read_b64_tr_b16 v[148:149], v191 offset:24704
    ds_read_b64_tr_b16 v[150:151], v191 offset:26240
    s_waitcnt lgkmcnt(8)
    v_mfma_f32_16x16x32_bf16 a[36:39], v[156:159], v[104:107], a[36:39]
    v_mfma_f32_16x16x32_bf16 a[40:43], v[156:159], v[108:111], a[40:43]
    s_add_u32 m0, s78, 2048
    v_mfma_f32_16x16x32_bf16 a[44:47], v[156:159], v[112:115], a[44:47]
    s_add_u32 s69, s63, 20480
    ds_read_b64_tr_b16 v[152:153], v188 offset:24832
    ds_read_b64_tr_b16 v[154:155], v188 offset:26368
    s_waitcnt lgkmcnt(8)
    v_mfma_f32_16x16x32_bf16 a[48:51], v[160:163], v[104:107], a[48:51]
    v_mfma_f32_16x16x32_bf16 a[52:55], v[160:163], v[108:111], a[52:55]
    buffer_load_dwordx4 v203, s[40:43], s69 offen lds
    v_mfma_f32_16x16x32_bf16 a[56:59], v[160:163], v[112:115], a[56:59]
    ds_read_b64_tr_b16 v[156:157], v189 offset:24832
    ds_read_b64_tr_b16 v[158:159], v189 offset:26368
    s_waitcnt lgkmcnt(8)
    v_mfma_f32_16x16x32_bf16 a[60:63], v[164:167], v[104:107], a[60:63]
    s_add_u32 m0, s78, 3072
    v_mfma_f32_16x16x32_bf16 a[64:67], v[164:167], v[108:111], a[64:67]
    s_add_u32 s69, s63, 30720
    v_mfma_f32_16x16x32_bf16 a[68:71], v[164:167], v[112:115], a[68:71]
    ds_read_b64_tr_b16 v[160:161], v190 offset:24832
    ds_read_b64_tr_b16 v[162:163], v190 offset:26368
    s_waitcnt lgkmcnt(8)
    v_mfma_f32_16x16x32_bf16 a[72:75], v[144:147], v[104:107], a[72:75]
    buffer_load_dwordx4 v203, s[40:43], s69 offen lds
    v_mfma_f32_16x16x32_bf16 a[76:79], v[144:147], v[108:111], a[76:79]
    v_mfma_f32_16x16x32_bf16 a[80:83], v[144:147], v[112:115], a[80:83]
    s_add_u32 m0, s78, 4096
    ds_read_b64_tr_b16 v[164:165], v191 offset:24832
    ds_read_b64_tr_b16 v[166:167], v191 offset:26368
    s_waitcnt lgkmcnt(8)
    v_mfma_f32_16x16x32_bf16 a[84:87], v[148:151], v[104:107], a[84:87]
    s_add_u32 s69, s63, 40960
    v_mfma_f32_16x16x32_bf16 a[88:91], v[148:151], v[108:111], a[88:91]
    v_mfma_f32_16x16x32_bf16 a[92:95], v[148:151], v[112:115], a[92:95]
    buffer_load_dwordx4 v203, s[40:43], s69 offen lds
    ds_read_b64_tr_b16 v[144:145], v188 offset:49152
    ds_read_b64_tr_b16 v[146:147], v188 offset:50688
    s_waitcnt lgkmcnt(8)
    v_mfma_f32_16x16x32_bf16 a[96:99], v[152:155], v[104:107], a[96:99]
    v_mfma_f32_16x16x32_bf16 a[100:103], v[152:155], v[108:111], a[100:103]
    s_add_u32 m0, s78, 5120
    v_mfma_f32_16x16x32_bf16 a[104:107], v[152:155], v[112:115], a[104:107]
    s_add_u32 s69, s63, 51200
    ds_read_b64_tr_b16 v[148:149], v189 offset:49152
    ds_read_b64_tr_b16 v[150:151], v189 offset:50688
    s_waitcnt lgkmcnt(8)
    v_mfma_f32_16x16x32_bf16 a[108:111], v[156:159], v[104:107], a[108:111]
    v_mfma_f32_16x16x32_bf16 a[112:115], v[156:159], v[108:111], a[112:115]
    buffer_load_dwordx4 v203, s[40:43], s69 offen lds
    v_mfma_f32_16x16x32_bf16 a[116:119], v[156:159], v[112:115], a[116:119]
    ds_read_b64_tr_b16 v[152:153], v190 offset:49152
    ds_read_b64_tr_b16 v[154:155], v190 offset:50688
    s_waitcnt lgkmcnt(8)
    v_mfma_f32_16x16x32_bf16 a[120:123], v[160:163], v[104:107], a[120:123]
    s_add_u32 s69, s64, 0
    v_mfma_f32_16x16x32_bf16 a[124:127], v[160:163], v[108:111], a[124:127]
    s_add_u32 m0, s67, 24576
    v_mfma_f32_16x16x32_bf16 a[128:131], v[160:163], v[112:115], a[128:131]
    ds_read_b64_tr_b16 v[156:157], v191 offset:49152
    ds_read_b64_tr_b16 v[158:159], v191 offset:50688
    s_waitcnt lgkmcnt(8)
    v_mfma_f32_16x16x32_bf16 a[132:135], v[164:167], v[104:107], a[132:135]
    s_nop 0
    v_mfma_f32_16x16x32_bf16 a[136:139], v[164:167], v[108:111], a[136:139]
    v_mfma_f32_16x16x32_bf16 a[140:143], v[164:167], v[112:115], a[140:143]
    buffer_load_dwordx4 v200, s[44:47], s69 offen lds
    ds_read_b64_tr_b16 v[160:161], v188 offset:49280
    ds_read_b64_tr_b16 v[162:163], v188 offset:50816
    s_waitcnt lgkmcnt(8)
    v_mfma_f32_16x16x32_bf16 a[144:147], v[144:147], v[104:107], a[144:147]
    s_add_u32 m0, s67, 25600
    v_mfma_f32_16x16x32_bf16 a[148:151], v[144:147], v[108:111], a[148:151]
    v_mfma_f32_16x16x32_bf16 a[152:155], v[144:147], v[112:115], a[152:155]
    s_nop 0
    ds_read_b64_tr_b16 v[164:165], v189 offset:49280
    ds_read_b64_tr_b16 v[166:167], v189 offset:50816
    s_waitcnt lgkmcnt(8)
    v_mfma_f32_16x16x32_bf16 a[156:159], v[148:151], v[104:107], a[156:159]
    v_mfma_f32_16x16x32_bf16 a[160:163], v[148:151], v[108:111], a[160:163]
    buffer_load_dwordx4 v201, s[44:47], s69 offen lds
    v_mfma_f32_16x16x32_bf16 a[164:167], v[148:151], v[112:115], a[164:167]
    s_add_u32 m0, s67, 26624
    ds_read_b64_tr_b16 v[144:145], v190 offset:49280
    ds_read_b64_tr_b16 v[146:147], v190 offset:50816
    s_waitcnt lgkmcnt(8)
    v_mfma_f32_16x16x32_bf16 a[168:171], v[152:155], v[104:107], a[168:171]
    v_mfma_f32_16x16x32_bf16 a[172:175], v[152:155], v[108:111], a[172:175]
    s_nop 0
    v_mfma_f32_16x16x32_bf16 a[176:179], v[152:155], v[112:115], a[176:179]
    ds_read_b64_tr_b16 v[148:149], v191 offset:49280
    ds_read_b64_tr_b16 v[150:151], v191 offset:50816
    s_waitcnt lgkmcnt(8)
    v_mfma_f32_16x16x32_bf16 a[180:183], v[156:159], v[104:107], a[180:183]
    buffer_load_dwordx4 v202, s[44:47], s69 offen lds
    v_mfma_f32_16x16x32_bf16 a[184:187], v[156:159], v[108:111], a[184:187]
    s_add_u32 s69, s64, 393216
    v_mfma_f32_16x16x32_bf16 a[188:191], v[156:159], v[112:115], a[188:191]
    ds_read_b64_tr_b16 v[152:153], v188 offset:49408
    ds_read_b64_tr_b16 v[154:155], v188 offset:50944
    s_waitcnt lgkmcnt(8)
    v_mfma_f32_16x16x32_bf16 a[192:195], v[160:163], v[104:107], a[192:195]
    s_add_u32 m0, s67, 36864
    v_mfma_f32_16x16x32_bf16 a[196:199], v[160:163], v[108:111], a[196:199]
    v_mfma_f32_16x16x32_bf16 a[200:203], v[160:163], v[112:115], a[200:203]
    s_nop 0
    ds_read_b64_tr_b16 v[156:157], v189 offset:49408
    ds_read_b64_tr_b16 v[158:159], v189 offset:50944
    s_waitcnt lgkmcnt(8)
    v_mfma_f32_16x16x32_bf16 a[204:207], v[164:167], v[104:107], a[204:207]
    buffer_load_dwordx4 v200, s[44:47], s69 offen lds
    v_mfma_f32_16x16x32_bf16 a[208:211], v[164:167], v[108:111], a[208:211]
    v_mfma_f32_16x16x32_bf16 a[212:215], v[164:167], v[112:115], a[212:215]
    s_add_u32 m0, s67, 37888
    ds_read_b64_tr_b16 v[160:161], v190 offset:49408
    ds_read_b64_tr_b16 v[162:163], v190 offset:50944
    s_waitcnt lgkmcnt(8)
    v_mfma_f32_16x16x32_bf16 a[216:219], v[144:147], v[104:107], a[216:219]
    v_mfma_f32_16x16x32_bf16 a[220:223], v[144:147], v[108:111], a[220:223]
    s_nop 0
    v_mfma_f32_16x16x32_bf16 a[224:227], v[144:147], v[112:115], a[224:227]
    buffer_load_dwordx4 v201, s[44:47], s69 offen lds
    ds_read_b64_tr_b16 v[164:165], v191 offset:49408
    ds_read_b64_tr_b16 v[166:167], v191 offset:50944
    s_waitcnt lgkmcnt(8)
    v_mfma_f32_16x16x32_bf16 a[228:231], v[148:151], v[104:107], a[228:231]
    v_mfma_f32_16x16x32_bf16 a[232:235], v[148:151], v[108:111], a[232:235]
    s_add_u32 m0, s67, 38912
    v_mfma_f32_16x16x32_bf16 a[236:239], v[148:151], v[112:115], a[236:239]
    ds_read_b64_tr_b16 v[144:145], v188 offset:36864
    ds_read_b64_tr_b16 v[146:147], v188 offset:38400
    s_waitcnt lgkmcnt(8)
    v_mfma_f32_16x16x32_bf16 a[240:243], v[152:155], v[104:107], a[240:243]
    s_nop 0
    v_mfma_f32_16x16x32_bf16 a[244:247], v[152:155], v[108:111], a[244:247]
    buffer_load_dwordx4 v202, s[44:47], s69 offen lds
    v_mfma_f32_16x16x32_bf16 a[248:251], v[152:155], v[112:115], a[248:251]
    ds_read_b64_tr_b16 v[148:149], v189 offset:36864
    ds_read_b64_tr_b16 v[150:151], v189 offset:38400
    s_waitcnt lgkmcnt(8)
    v_mfma_f32_16x16x32_bf16 a[252:255], v[156:159], v[104:107], a[252:255]
    s_add_u32 s69, s64, 384
    v_mfma_f32_16x16x32_bf16 v[72:75], v[156:159], v[108:111], v[72:75]
    v_mfma_f32_16x16x32_bf16 v[76:79], v[156:159], v[112:115], v[76:79]
    s_add_u32 m0, s67, 49152
    ds_read_b64_tr_b16 v[152:153], v190 offset:36864
    ds_read_b64_tr_b16 v[154:155], v190 offset:38400
    s_waitcnt lgkmcnt(8)
    v_mfma_f32_16x16x32_bf16 v[80:83], v[160:163], v[104:107], v[80:83]
    s_nop 0
    v_mfma_f32_16x16x32_bf16 v[84:87], v[160:163], v[108:111], v[84:87]
    v_mfma_f32_16x16x32_bf16 v[88:91], v[160:163], v[112:115], v[88:91]
    buffer_load_dwordx4 v200, s[44:47], s69 offen lds
    ds_read_b64_tr_b16 v[156:157], v191 offset:36864
    ds_read_b64_tr_b16 v[158:159], v191 offset:38400
    s_waitcnt lgkmcnt(8)
    v_mfma_f32_16x16x32_bf16 v[92:95], v[164:167], v[104:107], v[92:95]
    v_mfma_f32_16x16x32_bf16 v[96:99], v[164:167], v[108:111], v[96:99]
    s_add_u32 m0, s67, 50176
    v_mfma_f32_16x16x32_bf16 v[100:103], v[164:167], v[112:115], v[100:103]
    s_nop 0
    ds_read_b64_tr_b16 v[160:161], v188 offset:36992
    ds_read_b64_tr_b16 v[162:163], v188 offset:38528
    s_waitcnt lgkmcnt(8)
    v_mfma_f32_16x16x32_bf16 a[0:3], v[144:147], v[116:119], a[0:3]
    v_mfma_f32_16x16x32_bf16 a[4:7], v[144:147], v[120:123], a[4:7]
    buffer_load_dwordx4 v201, s[44:47], s69 offen lds
    v_mfma_f32_16x16x32_bf16 a[8:11], v[144:147], v[124:127], a[8:11]
    ds_read_b64_tr_b16 v[164:165], v189 offset:36992
    ds_read_b64_tr_b16 v[166:167], v189 offset:38528
    s_waitcnt lgkmcnt(8)
    v_mfma_f32_16x16x32_bf16 a[12:15], v[148:151], v[116:119], a[12:15]
    s_add_u32 m0, s67, 51200
    v_mfma_f32_16x16x32_bf16 a[16:19], v[148:151], v[120:123], a[16:19]
    s_nop 0
    v_mfma_f32_16x16x32_bf16 a[20:23], v[148:151], v[124:127], a[20:23]
    ds_read_b64_tr_b16 v[144:145], v190 offset:36992
    ds_read_b64_tr_b16 v[146:147], v190 offset:38528
    s_waitcnt lgkmcnt(8)
    v_mfma_f32_16x16x32_bf16 a[24:27], v[152:155], v[116:119], a[24:27]
    buffer_load_dwordx4 v202, s[44:47], s69 offen lds
    v_mfma_f32_16x16x32_bf16 a[28:31], v[152:155], v[120:123], a[28:31]
    v_mfma_f32_16x16x32_bf16 a[32:35], v[152:155], v[124:127], a[32:35]
    s_add_u32 s69, s64, 393600
    ds_read_b64_tr_b16 v[148:149], v191 offset:36992
    ds_read_b64_tr_b16 v[150:151], v191 offset:38528
    s_waitcnt lgkmcnt(8)
    v_mfma_f32_16x16x32_bf16 a[36:39], v[156:159], v[116:119], a[36:39]
    s_add_u32 m0, s67, 61440
    v_mfma_f32_16x16x32_bf16 a[40:43], v[156:159], v[120:123], a[40:43]
    v_mfma_f32_16x16x32_bf16 a[44:47], v[156:159], v[124:127], a[44:47]
    s_nop 0
    ds_read_b64_tr_b16 v[152:153], v188 offset:37120
    ds_read_b64_tr_b16 v[154:155], v188 offset:38656
    s_waitcnt lgkmcnt(8)
    v_mfma_f32_16x16x32_bf16 a[48:51], v[160:163], v[116:119], a[48:51]
    v_mfma_f32_16x16x32_bf16 a[52:55], v[160:163], v[120:123], a[52:55]
    buffer_load_dwordx4 v200, s[44:47], s69 offen lds
    v_mfma_f32_16x16x32_bf16 a[56:59], v[160:163], v[124:127], a[56:59]
    s_add_u32 m0, s67, 62464
    ds_read_b64_tr_b16 v[156:157], v189 offset:37120
    ds_read_b64_tr_b16 v[158:159], v189 offset:38656
    s_waitcnt lgkmcnt(8)
    v_mfma_f32_16x16x32_bf16 a[60:63], v[164:167], v[116:119], a[60:63]
    v_mfma_f32_16x16x32_bf16 a[64:67], v[164:167], v[120:123], a[64:67]
    s_nop 0
    v_mfma_f32_16x16x32_bf16 a[68:71], v[164:167], v[124:127], a[68:71]
    ds_read_b64_tr_b16 v[160:161], v190 offset:37120
    ds_read_b64_tr_b16 v[162:163], v190 offset:38656
    s_waitcnt lgkmcnt(8)
    v_mfma_f32_16x16x32_bf16 a[72:75], v[144:147], v[116:119], a[72:75]
    buffer_load_dwordx4 v201, s[44:47], s69 offen lds
    v_mfma_f32_16x16x32_bf16 a[76:79], v[144:147], v[120:123], a[76:79]
    s_add_u32 m0, s67, 63488
    v_mfma_f32_16x16x32_bf16 a[80:83], v[144:147], v[124:127], a[80:83]
    ds_read_b64_tr_b16 v[164:165], v191 offset:37120
    ds_read_b64_tr_b16 v[166:167], v191 offset:38656
    s_waitcnt lgkmcnt(8)
    v_mfma_f32_16x16x32_bf16 a[84:87], v[148:151], v[116:119], a[84:87]
    s_nop 0
    v_mfma_f32_16x16x32_bf16 a[88:91], v[148:151], v[120:123], a[88:91]
    v_mfma_f32_16x16x32_bf16 a[92:95], v[148:151], v[124:127], a[92:95]
    buffer_load_dwordx4 v202, s[44:47], s69 offen lds
    ds_read_b64_tr_b16 v[144:145], v188 offset:61440
    ds_read_b64_tr_b16 v[146:147], v188 offset:62976
    s_waitcnt lgkmcnt(8)
    v_mfma_f32_16x16x32_bf16 a[96:99], v[152:155], v[116:119], a[96:99]
    s_add_u32 s63, s63, 128
    v_mfma_f32_16x16x32_bf16 a[100:103], v[152:155], v[120:123], a[100:103]
    v_mfma_f32_16x16x32_bf16 a[104:107], v[152:155], v[124:127], a[104:107]
    s_add_u32 s64, s64, 786432
    ds_read_b64_tr_b16 v[148:149], v189 offset:61440
    ds_read_b64_tr_b16 v[150:151], v189 offset:62976
    s_waitcnt lgkmcnt(8)
    v_mfma_f32_16x16x32_bf16 a[108:111], v[156:159], v[116:119], a[108:111]
    v_mfma_f32_16x16x32_bf16 a[112:115], v[156:159], v[120:123], a[112:115]
    v_mfma_f32_16x16x32_bf16 a[116:119], v[156:159], v[124:127], a[116:119]
    ds_read_b64_tr_b16 v[152:153], v190 offset:61440
    ds_read_b64_tr_b16 v[154:155], v190 offset:62976
    s_waitcnt lgkmcnt(8)
    v_mfma_f32_16x16x32_bf16 a[120:123], v[160:163], v[116:119], a[120:123]
    v_mfma_f32_16x16x32_bf16 a[124:127], v[160:163], v[120:123], a[124:127]
    v_mfma_f32_16x16x32_bf16 a[128:131], v[160:163], v[124:127], a[128:131]
    ds_read_b64_tr_b16 v[156:157], v191 offset:61440
    ds_read_b64_tr_b16 v[158:159], v191 offset:62976
    s_waitcnt lgkmcnt(8)
    v_mfma_f32_16x16x32_bf16 a[132:135], v[164:167], v[116:119], a[132:135]
    v_mfma_f32_16x16x32_bf16 a[136:139], v[164:167], v[120:123], a[136:139]
    v_mfma_f32_16x16x32_bf16 a[140:143], v[164:167], v[124:127], a[140:143]
    ds_read_b64_tr_b16 v[160:161], v188 offset:61568
    ds_read_b64_tr_b16 v[162:163], v188 offset:63104
    s_waitcnt lgkmcnt(8)
    v_mfma_f32_16x16x32_bf16 a[144:147], v[144:147], v[116:119], a[144:147]
    v_mfma_f32_16x16x32_bf16 a[148:151], v[144:147], v[120:123], a[148:151]
    v_mfma_f32_16x16x32_bf16 a[152:155], v[144:147], v[124:127], a[152:155]
    ds_read_b64_tr_b16 v[164:165], v189 offset:61568
    ds_read_b64_tr_b16 v[166:167], v189 offset:63104
    s_waitcnt lgkmcnt(8)
    v_mfma_f32_16x16x32_bf16 a[156:159], v[148:151], v[116:119], a[156:159]
    v_mfma_f32_16x16x32_bf16 a[160:163], v[148:151], v[120:123], a[160:163]
    v_mfma_f32_16x16x32_bf16 a[164:167], v[148:151], v[124:127], a[164:167]
    ds_read_b64_tr_b16 v[144:145], v190 offset:61568
    ds_read_b64_tr_b16 v[146:147], v190 offset:63104
    s_waitcnt lgkmcnt(8)
    v_mfma_f32_16x16x32_bf16 a[168:171], v[152:155], v[116:119], a[168:171]
    v_mfma_f32_16x16x32_bf16 a[172:175], v[152:155], v[120:123], a[172:175]
    v_mfma_f32_16x16x32_bf16 a[176:179], v[152:155], v[124:127], a[176:179]
    ds_read_b64_tr_b16 v[148:149], v191 offset:61568
    ds_read_b64_tr_b16 v[150:151], v191 offset:63104
    s_waitcnt lgkmcnt(8)
    v_mfma_f32_16x16x32_bf16 a[180:183], v[156:159], v[116:119], a[180:183]
    v_mfma_f32_16x16x32_bf16 a[184:187], v[156:159], v[120:123], a[184:187]
    v_mfma_f32_16x16x32_bf16 a[188:191], v[156:159], v[124:127], a[188:191]
    ds_read_b64_tr_b16 v[152:153], v188 offset:61696
    ds_read_b64_tr_b16 v[154:155], v188 offset:63232
    s_waitcnt lgkmcnt(8)
    v_mfma_f32_16x16x32_bf16 a[192:195], v[160:163], v[116:119], a[192:195]
    v_mfma_f32_16x16x32_bf16 a[196:199], v[160:163], v[120:123], a[196:199]
    v_mfma_f32_16x16x32_bf16 a[200:203], v[160:163], v[124:127], a[200:203]
    ds_read_b64_tr_b16 v[156:157], v189 offset:61696
    ds_read_b64_tr_b16 v[158:159], v189 offset:63232
    s_waitcnt lgkmcnt(8)
    v_mfma_f32_16x16x32_bf16 a[204:207], v[164:167], v[116:119], a[204:207]
    v_mfma_f32_16x16x32_bf16 a[208:211], v[164:167], v[120:123], a[208:211]
    v_mfma_f32_16x16x32_bf16 a[212:215], v[164:167], v[124:127], a[212:215]
    ds_read_b64_tr_b16 v[160:161], v190 offset:61696
    ds_read_b64_tr_b16 v[162:163], v190 offset:63232
    s_waitcnt lgkmcnt(8)
    v_mfma_f32_16x16x32_bf16 a[216:219], v[144:147], v[116:119], a[216:219]
    v_mfma_f32_16x16x32_bf16 a[220:223], v[144:147], v[120:123], a[220:223]
    v_mfma_f32_16x16x32_bf16 a[224:227], v[144:147], v[124:127], a[224:227]
    ds_read_b64_tr_b16 v[164:165], v191 offset:61696
    ds_read_b64_tr_b16 v[166:167], v191 offset:63232
    s_waitcnt lgkmcnt(8)
    v_mfma_f32_16x16x32_bf16 a[228:231], v[148:151], v[116:119], a[228:231]
    v_mfma_f32_16x16x32_bf16 a[232:235], v[148:151], v[120:123], a[232:235]
    v_mfma_f32_16x16x32_bf16 a[236:239], v[148:151], v[124:127], a[236:239]
    s_waitcnt lgkmcnt(6)
    v_mfma_f32_16x16x32_bf16 a[240:243], v[152:155], v[116:119], a[240:243]
    v_mfma_f32_16x16x32_bf16 a[244:247], v[152:155], v[120:123], a[244:247]
    v_mfma_f32_16x16x32_bf16 a[248:251], v[152:155], v[124:127], a[248:251]
    s_waitcnt lgkmcnt(4)
    v_mfma_f32_16x16x32_bf16 a[252:255], v[156:159], v[116:119], a[252:255]
    v_mfma_f32_16x16x32_bf16 v[72:75], v[156:159], v[120:123], v[72:75]
    v_mfma_f32_16x16x32_bf16 v[76:79], v[156:159], v[124:127], v[76:79]
    s_waitcnt lgkmcnt(2)
    v_mfma_f32_16x16x32_bf16 v[80:83], v[160:163], v[116:119], v[80:83]
    v_mfma_f32_16x16x32_bf16 v[84:87], v[160:163], v[120:123], v[84:87]
    v_mfma_f32_16x16x32_bf16 v[88:91], v[160:163], v[124:127], v[88:91]
    s_waitcnt lgkmcnt(0)
    v_mfma_f32_16x16x32_bf16 v[92:95], v[164:167], v[116:119], v[92:95]
    v_mfma_f32_16x16x32_bf16 v[96:99], v[164:167], v[120:123], v[96:99]
    v_mfma_f32_16x16x32_bf16 v[100:103], v[164:167], v[124:127], v[100:103]
    v_add_u32 v188, 0, v192
    v_add_u32 v189, 0, v193
    v_add_u32 v190, 0, v194
    v_add_u32 v191, 0, v195
    v_add_u32 v186, 0, v204
    v_add_u32 v187, 0, v205
    s_waitcnt vmcnt(0)
    s_barrier
    ds_read_b128 v[104:107], v204 offset:0
    ds_read_b128 v[108:111], v204 offset:2048
    ds_read_b128 v[112:115], v204 offset:4096
    ds_read_b128 v[116:119], v205 offset:0
    ds_read_b128 v[120:123], v205 offset:2048
    ds_read_b128 v[124:127], v205 offset:4096
    ds_read_b64_tr_b16 v[144:145], v188 offset:24576
    ds_read_b64_tr_b16 v[146:147], v188 offset:26112
    ds_read_b64_tr_b16 v[148:149], v189 offset:24576
    ds_read_b64_tr_b16 v[150:151], v189 offset:26112
    ds_read_b64_tr_b16 v[152:153], v190 offset:24576
    ds_read_b64_tr_b16 v[154:155], v190 offset:26112
    ds_read_b64_tr_b16 v[156:157], v191 offset:24576
    ds_read_b64_tr_b16 v[158:159], v191 offset:26112
    ds_read_b64_tr_b16 v[160:161], v188 offset:24704
    ds_read_b64_tr_b16 v[162:163], v188 offset:26240
    s_waitcnt lgkmcnt(8)
    v_mfma_f32_16x16x32_bf16 a[0:3], v[144:147], v[104:107], a[0:3]
    s_add_u32 m0, s78, 73728
    v_mfma_f32_16x16x32_bf16 a[4:7], v[144:147], v[108:111], a[4:7]
    s_add_u32 s69, s63, 0
    v_mfma_f32_16x16x32_bf16 a[8:11], v[144:147], v[112:115], a[8:11]
    ds_read_b64_tr_b16 v[164:165], v189 offset:24704
    ds_read_b64_tr_b16 v[166:167], v189 offset:26240
    s_waitcnt lgkmcnt(8)
    v_mfma_f32_16x16x32_bf16 a[12:15], v[148:151], v[104:107], a[12:15]
    buffer_load_dwordx4 v203, s[40:43], s69 offen lds
    v_mfma_f32_16x16x32_bf16 a[16:19], v[148:151], v[108:111], a[16:19]
    v_mfma_f32_16x16x32_bf16 a[20:23], v[148:151], v[112:115], a[20:23]
    s_add_u32 m0, s78, 74752
    ds_read_b64_tr_b16 v[144:145], v190 offset:24704
    ds_read_b64_tr_b16 v[146:147], v190 offset:26240
    s_waitcnt lgkmcnt(8)
    v_mfma_f32_16x16x32_bf16 a[24:27], v[152:155], v[104:107], a[24:27]
    s_add_u32 s69, s63, 10240
    v_mfma_f32_16x16x32_bf16 a[28:31], v[152:155], v[108:111], a[28:31]
    v_mfma_f32_16x16x32_bf16 a[32:35], v[152:155], v[112:115], a[32:35]
    buffer_load_dwordx4 v203, s[40:43], s69 offen lds
    ds_read_b64_tr_b16 v[148:149], v191 offset:24704
    ds_read_b64_tr_b16 v[150:151], v191 offset:26240
    s_waitcnt lgkmcnt(8)
    v_mfma_f32_16x16x32_bf16 a[36:39], v[156:159], v[104:107], a[36:39]
    v_mfma_f32_16x16x32_bf16 a[40:43], v[156:159], v[108:111], a[40:43]
    s_add_u32 m0, s78, 75776
    v_mfma_f32_16x16x32_bf16 a[44:47], v[156:159], v[112:115], a[44:47]
    s_add_u32 s69, s63, 20480
    ds_read_b64_tr_b16 v[152:153], v188 offset:24832
    ds_read_b64_tr_b16 v[154:155], v188 offset:26368
    s_waitcnt lgkmcnt(8)
    v_mfma_f32_16x16x32_bf16 a[48:51], v[160:163], v[104:107], a[48:51]
    v_mfma_f32_16x16x32_bf16 a[52:55], v[160:163], v[108:111], a[52:55]
    buffer_load_dwordx4 v203, s[40:43], s69 offen lds
    v_mfma_f32_16x16x32_bf16 a[56:59], v[160:163], v[112:115], a[56:59]
    ds_read_b64_tr_b16 v[156:157], v189 offset:24832
    ds_read_b64_tr_b16 v[158:159], v189 offset:26368
    s_waitcnt lgkmcnt(8)
    v_mfma_f32_16x16x32_bf16 a[60:63], v[164:167], v[104:107], a[60:63]
    s_add_u32 m0, s78, 76800
    v_mfma_f32_16x16x32_bf16 a[64:67], v[164:167], v[108:111], a[64:67]
    s_add_u32 s69, s63, 30720
    v_mfma_f32_16x16x32_bf16 a[68:71], v[164:167], v[112:115], a[68:71]
    ds_read_b64_tr_b16 v[160:161], v190 offset:24832
    ds_read_b64_tr_b16 v[162:163], v190 offset:26368
    s_waitcnt lgkmcnt(8)
    v_mfma_f32_16x16x32_bf16 a[72:75], v[144:147], v[104:107], a[72:75]
    buffer_load_dwordx4 v203, s[40:43], s69 offen lds
    v_mfma_f32_16x16x32_bf16 a[76:79], v[144:147], v[108:111], a[76:79]
    v_mfma_f32_16x16x32_bf16 a[80:83], v[144:147], v[112:115], a[80:83]
    s_add_u32 m0, s78, 77824
    ds_read_b64_tr_b16 v[164:165], v191 offset:24832
    ds_read_b64_tr_b16 v[166:167], v191 offset:26368
    s_waitcnt lgkmcnt(8)
    v_mfma_f32_16x16x32_bf16 a[84:87], v[148:151], v[104:107], a[84:87]
    s_add_u32 s69, s63, 40960
    v_mfma_f32_16x16x32_bf16 a[88:91], v[148:151], v[108:111], a[88:91]
    v_mfma_f32_16x16x32_bf16 a[92:95], v[148:151], v[112:115], a[92:95]
    buffer_load_dwordx4 v203, s[40:43], s69 offen lds
    ds_read_b64_tr_b16 v[144:145], v188 offset:49152
    ds_read_b64_tr_b16 v[146:147], v188 offset:50688
    s_waitcnt lgkmcnt(8)
    v_mfma_f32_16x16x32_bf16 a[96:99], v[152:155], v[104:107], a[96:99]
    v_mfma_f32_16x16x32_bf16 a[100:103], v[152:155], v[108:111], a[100:103]
    s_add_u32 m0, s78, 78848
    v_mfma_f32_16x16x32_bf16 a[104:107], v[152:155], v[112:115], a[104:107]
    s_add_u32 s69, s63, 51200
    ds_read_b64_tr_b16 v[148:149], v189 offset:49152
    ds_read_b64_tr_b16 v[150:151], v189 offset:50688
    s_waitcnt lgkmcnt(8)
    v_mfma_f32_16x16x32_bf16 a[108:111], v[156:159], v[104:107], a[108:111]
    v_mfma_f32_16x16x32_bf16 a[112:115], v[156:159], v[108:111], a[112:115]
    buffer_load_dwordx4 v203, s[40:43], s69 offen lds
    v_mfma_f32_16x16x32_bf16 a[116:119], v[156:159], v[112:115], a[116:119]
    ds_read_b64_tr_b16 v[152:153], v190 offset:49152
    ds_read_b64_tr_b16 v[154:155], v190 offset:50688
    s_waitcnt lgkmcnt(8)
    v_mfma_f32_16x16x32_bf16 a[120:123], v[160:163], v[104:107], a[120:123]
    s_add_u32 s69, s64, 0
    v_mfma_f32_16x16x32_bf16 a[124:127], v[160:163], v[108:111], a[124:127]
    s_add_u32 m0, s67, 98304
    v_mfma_f32_16x16x32_bf16 a[128:131], v[160:163], v[112:115], a[128:131]
    ds_read_b64_tr_b16 v[156:157], v191 offset:49152
    ds_read_b64_tr_b16 v[158:159], v191 offset:50688
    s_waitcnt lgkmcnt(8)
    v_mfma_f32_16x16x32_bf16 a[132:135], v[164:167], v[104:107], a[132:135]
    s_nop 0
    v_mfma_f32_16x16x32_bf16 a[136:139], v[164:167], v[108:111], a[136:139]
    v_mfma_f32_16x16x32_bf16 a[140:143], v[164:167], v[112:115], a[140:143]
    buffer_load_dwordx4 v200, s[44:47], s69 offen lds
    ds_read_b64_tr_b16 v[160:161], v188 offset:49280
    ds_read_b64_tr_b16 v[162:163], v188 offset:50816
    s_waitcnt lgkmcnt(8)
    v_mfma_f32_16x16x32_bf16 a[144:147], v[144:147], v[104:107], a[144:147]
    s_add_u32 m0, s67, 99328
    v_mfma_f32_16x16x32_bf16 a[148:151], v[144:147], v[108:111], a[148:151]
    v_mfma_f32_16x16x32_bf16 a[152:155], v[144:147], v[112:115], a[152:155]
    s_nop 0
    ds_read_b64_tr_b16 v[164:165], v189 offset:49280
    ds_read_b64_tr_b16 v[166:167], v189 offset:50816
    s_waitcnt lgkmcnt(8)
    v_mfma_f32_16x16x32_bf16 a[156:159], v[148:151], v[104:107], a[156:159]
    v_mfma_f32_16x16x32_bf16 a[160:163], v[148:151], v[108:111], a[160:163]
    buffer_load_dwordx4 v201, s[44:47], s69 offen lds
    v_mfma_f32_16x16x32_bf16 a[164:167], v[148:151], v[112:115], a[164:167]
    s_add_u32 m0, s67, 100352
    ds_read_b64_tr_b16 v[144:145], v190 offset:49280
    ds_read_b64_tr_b16 v[146:147], v190 offset:50816
    s_waitcnt lgkmcnt(8)
    v_mfma_f32_16x16x32_bf16 a[168:171], v[152:155], v[104:107], a[168:171]
    v_mfma_f32_16x16x32_bf16 a[172:175], v[152:155], v[108:111], a[172:175]
    s_nop 0
    v_mfma_f32_16x16x32_bf16 a[176:179], v[152:155], v[112:115], a[176:179]
    ds_read_b64_tr_b16 v[148:149], v191 offset:49280
    ds_read_b64_tr_b16 v[150:151], v191 offset:50816
    s_waitcnt lgkmcnt(8)
    v_mfma_f32_16x16x32_bf16 a[180:183], v[156:159], v[104:107], a[180:183]
    buffer_load_dwordx4 v202, s[44:47], s69 offen lds
    v_mfma_f32_16x16x32_bf16 a[184:187], v[156:159], v[108:111], a[184:187]
    s_add_u32 s69, s64, 393216
    v_mfma_f32_16x16x32_bf16 a[188:191], v[156:159], v[112:115], a[188:191]
    ds_read_b64_tr_b16 v[152:153], v188 offset:49408
    ds_read_b64_tr_b16 v[154:155], v188 offset:50944
    s_waitcnt lgkmcnt(8)
    v_mfma_f32_16x16x32_bf16 a[192:195], v[160:163], v[104:107], a[192:195]
    s_add_u32 m0, s67, 110592
    v_mfma_f32_16x16x32_bf16 a[196:199], v[160:163], v[108:111], a[196:199]
    v_mfma_f32_16x16x32_bf16 a[200:203], v[160:163], v[112:115], a[200:203]
    s_nop 0
    ds_read_b64_tr_b16 v[156:157], v189 offset:49408
    ds_read_b64_tr_b16 v[158:159], v189 offset:50944
    s_waitcnt lgkmcnt(8)
    v_mfma_f32_16x16x32_bf16 a[204:207], v[164:167], v[104:107], a[204:207]
    buffer_load_dwordx4 v200, s[44:47], s69 offen lds
    v_mfma_f32_16x16x32_bf16 a[208:211], v[164:167], v[108:111], a[208:211]
    v_mfma_f32_16x16x32_bf16 a[212:215], v[164:167], v[112:115], a[212:215]
    s_add_u32 m0, s67, 111616
    ds_read_b64_tr_b16 v[160:161], v190 offset:49408
    ds_read_b64_tr_b16 v[162:163], v190 offset:50944
    s_waitcnt lgkmcnt(8)
    v_mfma_f32_16x16x32_bf16 a[216:219], v[144:147], v[104:107], a[216:219]
    v_mfma_f32_16x16x32_bf16 a[220:223], v[144:147], v[108:111], a[220:223]
    s_nop 0
    v_mfma_f32_16x16x32_bf16 a[224:227], v[144:147], v[112:115], a[224:227]
    buffer_load_dwordx4 v201, s[44:47], s69 offen lds
    ds_read_b64_tr_b16 v[164:165], v191 offset:49408
    ds_read_b64_tr_b16 v[166:167], v191 offset:50944
    s_waitcnt lgkmcnt(8)
    v_mfma_f32_16x16x32_bf16 a[228:231], v[148:151], v[104:107], a[228:231]
    v_mfma_f32_16x16x32_bf16 a[232:235], v[148:151], v[108:111], a[232:235]
    s_add_u32 m0, s67, 112640
    v_mfma_f32_16x16x32_bf16 a[236:239], v[148:151], v[112:115], a[236:239]
    ds_read_b64_tr_b16 v[144:145], v188 offset:36864
    ds_read_b64_tr_b16 v[146:147], v188 offset:38400
    s_waitcnt lgkmcnt(8)
    v_mfma_f32_16x16x32_bf16 a[240:243], v[152:155], v[104:107], a[240:243]
    s_nop 0
    v_mfma_f32_16x16x32_bf16 a[244:247], v[152:155], v[108:111], a[244:247]
    buffer_load_dwordx4 v202, s[44:47], s69 offen lds
    v_mfma_f32_16x16x32_bf16 a[248:251], v[152:155], v[112:115], a[248:251]
    ds_read_b64_tr_b16 v[148:149], v189 offset:36864
    ds_read_b64_tr_b16 v[150:151], v189 offset:38400
    s_waitcnt lgkmcnt(8)
    v_mfma_f32_16x16x32_bf16 a[252:255], v[156:159], v[104:107], a[252:255]
    s_add_u32 s69, s64, 384
    v_mfma_f32_16x16x32_bf16 v[72:75], v[156:159], v[108:111], v[72:75]
    v_mfma_f32_16x16x32_bf16 v[76:79], v[156:159], v[112:115], v[76:79]
    s_add_u32 m0, s67, 122880
    ds_read_b64_tr_b16 v[152:153], v190 offset:36864
    ds_read_b64_tr_b16 v[154:155], v190 offset:38400
    s_waitcnt lgkmcnt(8)
    v_mfma_f32_16x16x32_bf16 v[80:83], v[160:163], v[104:107], v[80:83]
    s_nop 0
    v_mfma_f32_16x16x32_bf16 v[84:87], v[160:163], v[108:111], v[84:87]
    v_mfma_f32_16x16x32_bf16 v[88:91], v[160:163], v[112:115], v[88:91]
    buffer_load_dwordx4 v200, s[44:47], s69 offen lds
    ds_read_b64_tr_b16 v[156:157], v191 offset:36864
    ds_read_b64_tr_b16 v[158:159], v191 offset:38400
    s_waitcnt lgkmcnt(8)
    v_mfma_f32_16x16x32_bf16 v[92:95], v[164:167], v[104:107], v[92:95]
    v_mfma_f32_16x16x32_bf16 v[96:99], v[164:167], v[108:111], v[96:99]
    s_add_u32 m0, s67, 123904
    v_mfma_f32_16x16x32_bf16 v[100:103], v[164:167], v[112:115], v[100:103]
    s_nop 0
    ds_read_b64_tr_b16 v[160:161], v188 offset:36992
    ds_read_b64_tr_b16 v[162:163], v188 offset:38528
    s_waitcnt lgkmcnt(8)
    v_mfma_f32_16x16x32_bf16 a[0:3], v[144:147], v[116:119], a[0:3]
    v_mfma_f32_16x16x32_bf16 a[4:7], v[144:147], v[120:123], a[4:7]
    buffer_load_dwordx4 v201, s[44:47], s69 offen lds
    v_mfma_f32_16x16x32_bf16 a[8:11], v[144:147], v[124:127], a[8:11]
    ds_read_b64_tr_b16 v[164:165], v189 offset:36992
    ds_read_b64_tr_b16 v[166:167], v189 offset:38528
    s_waitcnt lgkmcnt(8)
    v_mfma_f32_16x16x32_bf16 a[12:15], v[148:151], v[116:119], a[12:15]
    s_add_u32 m0, s67, 124928
    v_mfma_f32_16x16x32_bf16 a[16:19], v[148:151], v[120:123], a[16:19]
    s_nop 0
    v_mfma_f32_16x16x32_bf16 a[20:23], v[148:151], v[124:127], a[20:23]
    ds_read_b64_tr_b16 v[144:145], v190 offset:36992
    ds_read_b64_tr_b16 v[146:147], v190 offset:38528
    s_waitcnt lgkmcnt(8)
    v_mfma_f32_16x16x32_bf16 a[24:27], v[152:155], v[116:119], a[24:27]
    buffer_load_dwordx4 v202, s[44:47], s69 offen lds
    v_mfma_f32_16x16x32_bf16 a[28:31], v[152:155], v[120:123], a[28:31]
    v_mfma_f32_16x16x32_bf16 a[32:35], v[152:155], v[124:127], a[32:35]
    s_add_u32 s69, s64, 393600
    ds_read_b64_tr_b16 v[148:149], v191 offset:36992
    ds_read_b64_tr_b16 v[150:151], v191 offset:38528
    s_waitcnt lgkmcnt(8)
    v_mfma_f32_16x16x32_bf16 a[36:39], v[156:159], v[116:119], a[36:39]
    s_add_u32 m0, s67, 135168
    v_mfma_f32_16x16x32_bf16 a[40:43], v[156:159], v[120:123], a[40:43]
    v_mfma_f32_16x16x32_bf16 a[44:47], v[156:159], v[124:127], a[44:47]
    s_nop 0
    ds_read_b64_tr_b16 v[152:153], v188 offset:37120
    ds_read_b64_tr_b16 v[154:155], v188 offset:38656
    s_waitcnt lgkmcnt(8)
    v_mfma_f32_16x16x32_bf16 a[48:51], v[160:163], v[116:119], a[48:51]
    v_mfma_f32_16x16x32_bf16 a[52:55], v[160:163], v[120:123], a[52:55]
    buffer_load_dwordx4 v200, s[44:47], s69 offen lds
    v_mfma_f32_16x16x32_bf16 a[56:59], v[160:163], v[124:127], a[56:59]
    s_add_u32 m0, s67, 136192
    ds_read_b64_tr_b16 v[156:157], v189 offset:37120
    ds_read_b64_tr_b16 v[158:159], v189 offset:38656
    s_waitcnt lgkmcnt(8)
    v_mfma_f32_16x16x32_bf16 a[60:63], v[164:167], v[116:119], a[60:63]
    v_mfma_f32_16x16x32_bf16 a[64:67], v[164:167], v[120:123], a[64:67]
    s_nop 0
    v_mfma_f32_16x16x32_bf16 a[68:71], v[164:167], v[124:127], a[68:71]
    ds_read_b64_tr_b16 v[160:161], v190 offset:37120
    ds_read_b64_tr_b16 v[162:163], v190 offset:38656
    s_waitcnt lgkmcnt(8)
    v_mfma_f32_16x16x32_bf16 a[72:75], v[144:147], v[116:119], a[72:75]
    buffer_load_dwordx4 v201, s[44:47], s69 offen lds
    v_mfma_f32_16x16x32_bf16 a[76:79], v[144:147], v[120:123], a[76:79]
    s_add_u32 m0, s67, 137216
    v_mfma_f32_16x16x32_bf16 a[80:83], v[144:147], v[124:127], a[80:83]
    ds_read_b64_tr_b16 v[164:165], v191 offset:37120
    ds_read_b64_tr_b16 v[166:167], v191 offset:38656
    s_waitcnt lgkmcnt(8)
    v_mfma_f32_16x16x32_bf16 a[84:87], v[148:151], v[116:119], a[84:87]
    s_nop 0
    v_mfma_f32_16x16x32_bf16 a[88:91], v[148:151], v[120:123], a[88:91]
    v_mfma_f32_16x16x32_bf16 a[92:95], v[148:151], v[124:127], a[92:95]
    buffer_load_dwordx4 v202, s[44:47], s69 offen lds
    ds_read_b64_tr_b16 v[144:145], v188 offset:61440
    ds_read_b64_tr_b16 v[146:147], v188 offset:62976
    s_waitcnt lgkmcnt(8)
    v_mfma_f32_16x16x32_bf16 a[96:99], v[152:155], v[116:119], a[96:99]
    s_add_u32 s63, s63, 128
    v_mfma_f32_16x16x32_bf16 a[100:103], v[152:155], v[120:123], a[100:103]
    v_mfma_f32_16x16x32_bf16 a[104:107], v[152:155], v[124:127], a[104:107]
    s_add_u32 s64, s64, 786432
    ds_read_b64_tr_b16 v[148:149], v189 offset:61440
    ds_read_b64_tr_b16 v[150:151], v189 offset:62976
    s_waitcnt lgkmcnt(8)
    v_mfma_f32_16x16x32_bf16 a[108:111], v[156:159], v[116:119], a[108:111]
    v_mfma_f32_16x16x32_bf16 a[112:115], v[156:159], v[120:123], a[112:115]
    v_mfma_f32_16x16x32_bf16 a[116:119], v[156:159], v[124:127], a[116:119]
    ds_read_b64_tr_b16 v[152:153], v190 offset:61440
    ds_read_b64_tr_b16 v[154:155], v190 offset:62976
    s_waitcnt lgkmcnt(8)
    v_mfma_f32_16x16x32_bf16 a[120:123], v[160:163], v[116:119], a[120:123]
    v_mfma_f32_16x16x32_bf16 a[124:127], v[160:163], v[120:123], a[124:127]
    v_mfma_f32_16x16x32_bf16 a[128:131], v[160:163], v[124:127], a[128:131]
    ds_read_b64_tr_b16 v[156:157], v191 offset:61440
    ds_read_b64_tr_b16 v[158:159], v191 offset:62976
    s_waitcnt lgkmcnt(8)
    v_mfma_f32_16x16x32_bf16 a[132:135], v[164:167], v[116:119], a[132:135]
    v_mfma_f32_16x16x32_bf16 a[136:139], v[164:167], v[120:123], a[136:139]
    v_mfma_f32_16x16x32_bf16 a[140:143], v[164:167], v[124:127], a[140:143]
    ds_read_b64_tr_b16 v[160:161], v188 offset:61568
    ds_read_b64_tr_b16 v[162:163], v188 offset:63104
    s_waitcnt lgkmcnt(8)
    v_mfma_f32_16x16x32_bf16 a[144:147], v[144:147], v[116:119], a[144:147]
    v_mfma_f32_16x16x32_bf16 a[148:151], v[144:147], v[120:123], a[148:151]
    v_mfma_f32_16x16x32_bf16 a[152:155], v[144:147], v[124:127], a[152:155]
    ds_read_b64_tr_b16 v[164:165], v189 offset:61568
    ds_read_b64_tr_b16 v[166:167], v189 offset:63104
    s_waitcnt lgkmcnt(8)
    v_mfma_f32_16x16x32_bf16 a[156:159], v[148:151], v[116:119], a[156:159]
    v_mfma_f32_16x16x32_bf16 a[160:163], v[148:151], v[120:123], a[160:163]
    v_mfma_f32_16x16x32_bf16 a[164:167], v[148:151], v[124:127], a[164:167]
    ds_read_b64_tr_b16 v[144:145], v190 offset:61568
    ds_read_b64_tr_b16 v[146:147], v190 offset:63104
    s_waitcnt lgkmcnt(8)
    v_mfma_f32_16x16x32_bf16 a[168:171], v[152:155], v[116:119], a[168:171]
    v_mfma_f32_16x16x32_bf16 a[172:175], v[152:155], v[120:123], a[172:175]
    v_mfma_f32_16x16x32_bf16 a[176:179], v[152:155], v[124:127], a[176:179]
    ds_read_b64_tr_b16 v[148:149], v191 offset:61568
    ds_read_b64_tr_b16 v[150:151], v191 offset:63104
    s_waitcnt lgkmcnt(8)
    v_mfma_f32_16x16x32_bf16 a[180:183], v[156:159], v[116:119], a[180:183]
    v_mfma_f32_16x16x32_bf16 a[184:187], v[156:159], v[120:123], a[184:187]
    v_mfma_f32_16x16x32_bf16 a[188:191], v[156:159], v[124:127], a[188:191]
    ds_read_b64_tr_b16 v[152:153], v188 offset:61696
    ds_read_b64_tr_b16 v[154:155], v188 offset:63232
    s_waitcnt lgkmcnt(8)
    v_mfma_f32_16x16x32_bf16 a[192:195], v[160:163], v[116:119], a[192:195]
    v_mfma_f32_16x16x32_bf16 a[196:199], v[160:163], v[120:123], a[196:199]
    v_mfma_f32_16x16x32_bf16 a[200:203], v[160:163], v[124:127], a[200:203]
    ds_read_b64_tr_b16 v[156:157], v189 offset:61696
    ds_read_b64_tr_b16 v[158:159], v189 offset:63232
    s_waitcnt lgkmcnt(8)
    v_mfma_f32_16x16x32_bf16 a[204:207], v[164:167], v[116:119], a[204:207]
    v_mfma_f32_16x16x32_bf16 a[208:211], v[164:167], v[120:123], a[208:211]
    v_mfma_f32_16x16x32_bf16 a[212:215], v[164:167], v[124:127], a[212:215]
    ds_read_b64_tr_b16 v[160:161], v190 offset:61696
    ds_read_b64_tr_b16 v[162:163], v190 offset:63232
    s_waitcnt lgkmcnt(8)
    v_mfma_f32_16x16x32_bf16 a[216:219], v[144:147], v[116:119], a[216:219]
    v_mfma_f32_16x16x32_bf16 a[220:223], v[144:147], v[120:123], a[220:223]
    v_mfma_f32_16x16x32_bf16 a[224:227], v[144:147], v[124:127], a[224:227]
    ds_read_b64_tr_b16 v[164:165], v191 offset:61696
    ds_read_b64_tr_b16 v[166:167], v191 offset:63232
    s_waitcnt lgkmcnt(8)
    v_mfma_f32_16x16x32_bf16 a[228:231], v[148:151], v[116:119], a[228:231]
    v_mfma_f32_16x16x32_bf16 a[232:235], v[148:151], v[120:123], a[232:235]
    v_mfma_f32_16x16x32_bf16 a[236:239], v[148:151], v[124:127], a[236:239]
    s_waitcnt lgkmcnt(6)
    v_mfma_f32_16x16x32_bf16 a[240:243], v[152:155], v[116:119], a[240:243]
    v_mfma_f32_16x16x32_bf16 a[244:247], v[152:155], v[120:123], a[244:247]
    v_mfma_f32_16x16x32_bf16 a[248:251], v[152:155], v[124:127], a[248:251]
    s_waitcnt lgkmcnt(4)
    v_mfma_f32_16x16x32_bf16 a[252:255], v[156:159], v[116:119], a[252:255]
    v_mfma_f32_16x16x32_bf16 v[72:75], v[156:159], v[120:123], v[72:75]
    v_mfma_f32_16x16x32_bf16 v[76:79], v[156:159], v[124:127], v[76:79]
    s_waitcnt lgkmcnt(2)
    v_mfma_f32_16x16x32_bf16 v[80:83], v[160:163], v[116:119], v[80:83]
    v_mfma_f32_16x16x32_bf16 v[84:87], v[160:163], v[120:123], v[84:87]
    v_mfma_f32_16x16x32_bf16 v[88:91], v[160:163], v[124:127], v[88:91]
    s_waitcnt lgkmcnt(0)
    v_mfma_f32_16x16x32_bf16 v[92:95], v[164:167], v[116:119], v[92:95]
    v_mfma_f32_16x16x32_bf16 v[96:99], v[164:167], v[120:123], v[96:99]
    v_mfma_f32_16x16x32_bf16 v[100:103], v[164:167], v[124:127], v[100:103]
    s_add_u32 s60, s60, 1
    s_cmp_lt_u32 s60, 4
    s_cbranch_scc1 L_k1_q1
    v_add_u32 v188, 73728, v192
    v_add_u32 v189, 73728, v193
    v_add_u32 v190, 73728, v194
    v_add_u32 v191, 73728, v195
    v_add_u32 v186, 73728, v204
    v_add_u32 v187, 73728, v205
    s_waitcnt vmcnt(0)
    s_barrier
    ds_read_b128 v[104:107], v186 offset:0
    ds_read_b128 v[108:111], v186 offset:2048
    ds_read_b128 v[112:115], v186 offset:4096
    ds_read_b128 v[116:119], v187 offset:0
    ds_read_b128 v[120:123], v187 offset:2048
    ds_read_b128 v[124:127], v187 offset:4096
    ds_read_b64_tr_b16 v[144:145], v188 offset:24576
    ds_read_b64_tr_b16 v[146:147], v188 offset:26112
    ds_read_b64_tr_b16 v[148:149], v189 offset:24576
    ds_read_b64_tr_b16 v[150:151], v189 offset:26112
    ds_read_b64_tr_b16 v[152:153], v190 offset:24576
    ds_read_b64_tr_b16 v[154:155], v190 offset:26112
    ds_read_b64_tr_b16 v[156:157], v191 offset:24576
    ds_read_b64_tr_b16 v[158:159], v191 offset:26112
    ds_read_b64_tr_b16 v[160:161], v188 offset:24704
    ds_read_b64_tr_b16 v[162:163], v188 offset:26240
    s_waitcnt lgkmcnt(8)
    v_mfma_f32_16x16x32_bf16 a[0:3], v[144:147], v[104:107], a[0:3]
    s_add_u32 m0, s79, 0
    v_mfma_f32_16x16x32_bf16 a[4:7], v[144:147], v[108:111], a[4:7]
    s_nop 0
    v_mfma_f32_16x16x32_bf16 a[8:11], v[144:147], v[112:115], a[8:11]
    buffer_load_dwordx4 v197, s[48:51], s65 offen nt lds
    ds_read_b64_tr_b16 v[164:165], v189 offset:24704
    ds_read_b64_tr_b16 v[166:167], v189 offset:26240
    s_waitcnt lgkmcnt(8)
    v_mfma_f32_16x16x32_bf16 a[12:15], v[148:151], v[104:107], a[12:15]
    v_mfma_f32_16x16x32_bf16 a[16:19], v[148:151], v[108:111], a[16:19]
    s_add_u32 m0, s79, 1024
    v_mfma_f32_16x16x32_bf16 a[20:23], v[148:151], v[112:115], a[20:23]
    s_nop 0
    ds_read_b64_tr_b16 v[144:145], v190 offset:24704
    ds_read_b64_tr_b16 v[146:147], v190 offset:26240
    s_waitcnt lgkmcnt(8)
    v_mfma_f32_16x16x32_bf16 a[24:27], v[152:155], v[104:107], a[24:27]
    v_mfma_f32_16x16x32_bf16 a[28:31], v[152:155], v[108:111], a[28:31]
    buffer_load_dwordx4 v198, s[48:51], s65 offen nt lds
    v_mfma_f32_16x16x32_bf16 a[32:35], v[152:155], v[112:115], a[32:35]
    s_add_u32 m0, s79, 2048
    ds_read_b64_tr_b16 v[148:149], v191 offset:24704
    ds_read_b64_tr_b16 v[150:151], v191 offset:26240
    s_waitcnt lgkmcnt(8)
    v_mfma_f32_16x16x32_bf16 a[36:39], v[156:159], v[104:107], a[36:39]
    v_mfma_f32_16x16x32_bf16 a[40:43], v[156:159], v[108:111], a[40:43]
    s_nop 0
    v_mfma_f32_16x16x32_bf16 a[44:47], v[156:159], v[112:115], a[44:47]
    buffer_load_dwordx4 v199, s[48:51], s65 offen nt lds
    ds_read_b64_tr_b16 v[152:153], v188 offset:24832
    ds_read_b64_tr_b16 v[154:155], v188 offset:26368
    s_waitcnt lgkmcnt(8)
    v_mfma_f32_16x16x32_bf16 a[48:51], v[160:163], v[104:107], a[48:51]
    v_mfma_f32_16x16x32_bf16 a[52:55], v[160:163], v[108:111], a[52:55]
    s_add_u32 s65, s65, 12288
    v_mfma_f32_16x16x32_bf16 a[56:59], v[160:163], v[112:115], a[56:59]
    s_add_u32 m0, s79, 12288
    ds_read_b64_tr_b16 v[156:157], v189 offset:24832
    ds_read_b64_tr_b16 v[158:159], v189 offset:26368
    s_waitcnt lgkmcnt(8)
    v_mfma_f32_16x16x32_bf16 a[60:63], v[164:167], v[104:107], a[60:63]
    s_nop 0
    v_mfma_f32_16x16x32_bf16 a[64:67], v[164:167], v[108:111], a[64:67]
    v_mfma_f32_16x16x32_bf16 a[68:71], v[164:167], v[112:115], a[68:71]
    buffer_load_dwordx4 v197, s[48:51], s65 offen nt lds
    ds_read_b64_tr_b16 v[160:161], v190 offset:24832
    ds_read_b64_tr_b16 v[162:163], v190 offset:26368
    s_waitcnt lgkmcnt(8)
    v_mfma_f32_16x16x32_bf16 a[72:75], v[144:147], v[104:107], a[72:75]
    s_add_u32 m0, s79, 13312
    v_mfma_f32_16x16x32_bf16 a[76:79], v[144:147], v[108:111], a[76:79]
    v_mfma_f32_16x16x32_bf16 a[80:83], v[144:147], v[112:115], a[80:83]
    s_nop 0
    ds_read_b64_tr_b16 v[164:165], v191 offset:24832
    ds_read_b64_tr_b16 v[166:167], v191 offset:26368
    s_waitcnt lgkmcnt(8)
    v_mfma_f32_16x16x32_bf16 a[84:87], v[148:151], v[104:107], a[84:87]
    buffer_load_dwordx4 v198, s[48:51], s65 offen nt lds
    v_mfma_f32_16x16x32_bf16 a[88:91], v[148:151], v[108:111], a[88:91]
    v_mfma_f32_16x16x32_bf16 a[92:95], v[148:151], v[112:115], a[92:95]
    s_add_u32 m0, s79, 14336
    ds_read_b64_tr_b16 v[144:145], v188 offset:49152
    ds_read_b64_tr_b16 v[146:147], v188 offset:50688
    s_waitcnt lgkmcnt(8)
    v_mfma_f32_16x16x32_bf16 a[96:99], v[152:155], v[104:107], a[96:99]
    s_nop 0
    v_mfma_f32_16x16x32_bf16 a[100:103], v[152:155], v[108:111], a[100:103]
    v_mfma_f32_16x16x32_bf16 a[104:107], v[152:155], v[112:115], a[104:107]
    buffer_load_dwordx4 v199, s[48:51], s65 offen nt lds
    ds_read_b64_tr_b16 v[148:149], v189 offset:49152
    ds_read_b64_tr_b16 v[150:151], v189 offset:50688
    s_waitcnt lgkmcnt(8)
    v_mfma_f32_16x16x32_bf16 a[108:111], v[156:159], v[104:107], a[108:111]
    s_add_u32 s65, s65, 12288
    v_mfma_f32_16x16x32_bf16 a[112:115], v[156:159], v[108:111], a[112:115]
    s_add_u32 s79, s79, 24576
    v_mfma_f32_16x16x32_bf16 a[116:119], v[156:159], v[112:115], a[116:119]
    ds_read_b64_tr_b16 v[152:153], v190 offset:49152
    ds_read_b64_tr_b16 v[154:155], v190 offset:50688
    s_waitcnt lgkmcnt(8)
    v_mfma_f32_16x16x32_bf16 a[120:123], v[160:163], v[104:107], a[120:123]
    s_cmp_ge_u32 s79, 147456
    v_mfma_f32_16x16x32_bf16 a[124:127], v[160:163], v[108:111], a[124:127]
    s_cselect_b32 s79, s67, s79
    v_mfma_f32_16x16x32_bf16 a[128:131], v[160:163], v[112:115], a[128:131]
    ds_read_b64_tr_b16 v[156:157], v191 offset:49152
    ds_read_b64_tr_b16 v[158:159], v191 offset:50688
    s_waitcnt lgkmcnt(8)
    v_mfma_f32_16x16x32_bf16 a[132:135], v[164:167], v[104:107], a[132:135]
    s_add_u32 m0, s79, 0
    v_mfma_f32_16x16x32_bf16 a[136:139], v[164:167], v[108:111], a[136:139]
    s_nop 0
    v_mfma_f32_16x16x32_bf16 a[140:143], v[164:167], v[112:115], a[140:143]
    ds_read_b64_tr_b16 v[160:161], v188 offset:49280
    ds_read_b64_tr_b16 v[162:163], v188 offset:50816
    s_waitcnt lgkmcnt(8)
    v_mfma_f32_16x16x32_bf16 a[144:147], v[144:147], v[104:107], a[144:147]
    buffer_load_dwordx4 v197, s[52:55], s66 offen nt lds
    v_mfma_f32_16x16x32_bf16 a[148:151], v[144:147], v[108:111], a[148:151]
    s_add_u32 m0, s79, 1024
    v_mfma_f32_16x16x32_bf16 a[152:155], v[144:147], v[112:115], a[152:155]
    ds_read_b64_tr_b16 v[164:165], v189 offset:49280
    ds_read_b64_tr_b16 v[166:167], v189 offset:50816
    s_waitcnt lgkmcnt(8)
    v_mfma_f32_16x16x32_bf16 a[156:159], v[148:151], v[104:107], a[156:159]
    s_nop 0
    v_mfma_f32_16x16x32_bf16 a[160:163], v[148:151], v[108:111], a[160:163]
    buffer_load_dwordx4 v198, s[52:55], s66 offen nt lds
    v_mfma_f32_16x16x32_bf16 a[164:167], v[148:151], v[112:115], a[164:167]
    ds_read_b64_tr_b16 v[144:145], v190 offset:49280
    ds_read_b64_tr_b16 v[146:147], v190 offset:50816
    s_waitcnt lgkmcnt(8)
    v_mfma_f32_16x16x32_bf16 a[168:171], v[152:155], v[104:107], a[168:171]
    s_add_u32 m0, s79, 2048
    v_mfma_f32_16x16x32_bf16 a[172:175], v[152:155], v[108:111], a[172:175]
    s_nop 0
    v_mfma_f32_16x16x32_bf16 a[176:179], v[152:155], v[112:115], a[176:179]
    buffer_load_dwordx4 v199, s[52:55], s66 offen nt lds
    ds_read_b64_tr_b16 v[148:149], v191 offset:49280
    ds_read_b64_tr_b16 v[150:151], v191 offset:50816
    s_waitcnt lgkmcnt(8)
    v_mfma_f32_16x16x32_bf16 a[180:183], v[156:159], v[104:107], a[180:183]
    v_mfma_f32_16x16x32_bf16 a[184:187], v[156:159], v[108:111], a[184:187]
    s_add_u32 m0, s79, 12288
    v_mfma_f32_16x16x32_bf16 a[188:191], v[156:159], v[112:115], a[188:191]
    s_nop 0
    ds_read_b64_tr_b16 v[152:153], v188 offset:49408
    ds_read_b64_tr_b16 v[154:155], v188 offset:50944
    s_waitcnt lgkmcnt(8)
    v_mfma_f32_16x16x32_bf16 a[192:195], v[160:163], v[104:107], a[192:195]
    v_mfma_f32_16x16x32_bf16 a[196:199], v[160:163], v[108:111], a[196:199]
    buffer_load_dwordx4 v197, s[48:51], s65 offen nt lds
    v_mfma_f32_16x16x32_bf16 a[200:203], v[160:163], v[112:115], a[200:203]
    s_add_u32 m0, s79, 13312
    ds_read_b64_tr_b16 v[156:157], v189 offset:49408
    ds_read_b64_tr_b16 v[158:159], v189 offset:50944
    s_waitcnt lgkmcnt(8)
    v_mfma_f32_16x16x32_bf16 a[204:207], v[164:167], v[104:107], a[204:207]
    v_mfma_f32_16x16x32_bf16 a[208:211], v[164:167], v[108:111], a[208:211]
    s_nop 0
    v_mfma_f32_16x16x32_bf16 a[212:215], v[164:167], v[112:115], a[212:215]
    buffer_load_dwordx4 v198, s[48:51], s65 offen nt lds
    ds_read_b64_tr_b16 v[160:161], v190 offset:49408
    ds_read_b64_tr_b16 v[162:163], v190 offset:50944
    s_waitcnt lgkmcnt(8)
    v_mfma_f32_16x16x32_bf16 a[216:219], v[144:147], v[104:107], a[216:219]
    v_mfma_f32_16x16x32_bf16 a[220:223], v[144:147], v[108:111], a[220:223]
    s_add_u32 m0, s79, 14336
    v_mfma_f32_16x16x32_bf16 a[224:227], v[144:147], v[112:115], a[224:227]
    s_nop 0
    ds_read_b64_tr_b16 v[164:165], v191 offset:49408
    ds_read_b64_tr_b16 v[166:167], v191 offset:50944
    s_waitcnt lgkmcnt(8)
    v_mfma_f32_16x16x32_bf16 a[228:231], v[148:151], v[104:107], a[228:231]
    buffer_load_dwordx4 v199, s[48:51], s65 offen nt lds
    v_mfma_f32_16x16x32_bf16 a[232:235], v[148:151], v[108:111], a[232:235]
    v_mfma_f32_16x16x32_bf16 a[236:239], v[148:151], v[112:115], a[236:239]
    s_add_u32 s66, s66, 12288
    ds_read_b64_tr_b16 v[144:145], v188 offset:36864
    ds_read_b64_tr_b16 v[146:147], v188 offset:38400
    s_waitcnt lgkmcnt(8)
    v_mfma_f32_16x16x32_bf16 a[240:243], v[152:155], v[104:107], a[240:243]
    s_add_u32 s65, s65, 12288
    v_mfma_f32_16x16x32_bf16 a[244:247], v[152:155], v[108:111], a[244:247]
    v_mfma_f32_16x16x32_bf16 a[248:251], v[152:155], v[112:115], a[248:251]
    s_add_u32 s79, s79, 24576
    ds_read_b64_tr_b16 v[148:149], v189 offset:36864
    ds_read_b64_tr_b16 v[150:151], v189 offset:38400
    s_waitcnt lgkmcnt(8)
    v_mfma_f32_16x16x32_bf16 a[252:255], v[156:159], v[104:107], a[252:255]
    s_cmp_ge_u32 s79, 147456
    v_mfma_f32_16x16x32_bf16 v[72:75], v[156:159], v[108:111], v[72:75]
    v_mfma_f32_16x16x32_bf16 v[76:79], v[156:159], v[112:115], v[76:79]
    s_cselect_b32 s79, s67, s79
    ds_read_b64_tr_b16 v[152:153], v190 offset:36864
    ds_read_b64_tr_b16 v[154:155], v190 offset:38400
    s_waitcnt lgkmcnt(8)
    v_mfma_f32_16x16x32_bf16 v[80:83], v[160:163], v[104:107], v[80:83]
    s_add_u32 m0, s79, 0
    v_mfma_f32_16x16x32_bf16 v[84:87], v[160:163], v[108:111], v[84:87]
    v_mfma_f32_16x16x32_bf16 v[88:91], v[160:163], v[112:115], v[88:91]
    s_nop 0
    ds_read_b64_tr_b16 v[156:157], v191 offset:36864
    ds_read_b64_tr_b16 v[158:159], v191 offset:38400
    s_waitcnt lgkmcnt(8)
    v_mfma_f32_16x16x32_bf16 v[92:95], v[164:167], v[104:107], v[92:95]
    buffer_load_dwordx4 v197, s[52:55], s66 offen nt lds
    v_mfma_f32_16x16x32_bf16 v[96:99], v[164:167], v[108:111], v[96:99]
    v_mfma_f32_16x16x32_bf16 v[100:103], v[164:167], v[112:115], v[100:103]
    s_add_u32 m0, s79, 1024
    ds_read_b64_tr_b16 v[160:161], v188 offset:36992
    ds_read_b64_tr_b16 v[162:163], v188 offset:38528
    s_waitcnt lgkmcnt(8)
    v_mfma_f32_16x16x32_bf16 a[0:3], v[144:147], v[116:119], a[0:3]
    s_nop 0
    v_mfma_f32_16x16x32_bf16 a[4:7], v[144:147], v[120:123], a[4:7]
    buffer_load_dwordx4 v198, s[52:55], s66 offen nt lds
    v_mfma_f32_16x16x32_bf16 a[8:11], v[144:147], v[124:127], a[8:11]
    ds_read_b64_tr_b16 v[164:165], v189 offset:36992
    ds_read_b64_tr_b16 v[166:167], v189 offset:38528
    s_waitcnt lgkmcnt(8)
    v_mfma_f32_16x16x32_bf16 a[12:15], v[148:151], v[116:119], a[12:15]
    s_add_u32 m0, s79, 2048
    v_mfma_f32_16x16x32_bf16 a[16:19], v[148:151], v[120:123], a[16:19]
    s_nop 0
    v_mfma_f32_16x16x32_bf16 a[20:23], v[148:151], v[124:127], a[20:23]
    ds_read_b64_tr_b16 v[144:145], v190 offset:36992
    ds_read_b64_tr_b16 v[146:147], v190 offset:38528
    s_waitcnt lgkmcnt(8)
    v_mfma_f32_16x16x32_bf16 a[24:27], v[152:155], v[116:119], a[24:27]
    buffer_load_dwordx4 v199, s[52:55], s66 offen nt lds
    v_mfma_f32_16x16x32_bf16 a[28:31], v[152:155], v[120:123], a[28:31]
    s_add_u32 m0, s79, 12288
    v_mfma_f32_16x16x32_bf16 a[32:35], v[152:155], v[124:127], a[32:35]
    ds_read_b64_tr_b16 v[148:149], v191 offset:36992
    ds_read_b64_tr_b16 v[150:151], v191 offset:38528
    s_waitcnt lgkmcnt(8)
    v_mfma_f32_16x16x32_bf16 a[36:39], v[156:159], v[116:119], a[36:39]
    s_nop 0
    v_mfma_f32_16x16x32_bf16 a[40:43], v[156:159], v[120:123], a[40:43]
    buffer_load_dwordx4 v197, s[48:51], s65 offen nt lds
    v_mfma_f32_16x16x32_bf16 a[44:47], v[156:159], v[124:127], a[44:47]
    ds_read_b64_tr_b16 v[152:153], v188 offset:37120
    ds_read_b64_tr_b16 v[154:155], v188 offset:38656
    s_waitcnt lgkmcnt(8)
    v_mfma_f32_16x16x32_bf16 a[48:51], v[160:163], v[116:119], a[48:51]
    s_add_u32 m0, s79, 13312
    v_mfma_f32_16x16x32_bf16 a[52:55], v[160:163], v[120:123], a[52:55]
    s_nop 0
    v_mfma_f32_16x16x32_bf16 a[56:59], v[160:163], v[124:127], a[56:59]
    buffer_load_dwordx4 v198, s[48:51], s65 offen nt lds
    ds_read_b64_tr_b16 v[156:157], v189 offset:37120
    ds_read_b64_tr_b16 v[158:159], v189 offset:38656
    s_waitcnt lgkmcnt(8)
    v_mfma_f32_16x16x32_bf16 a[60:63], v[164:167], v[116:119], a[60:63]
    v_mfma_f32_16x16x32_bf16 a[64:67], v[164:167], v[120:123], a[64:67]
    s_add_u32 m0, s79, 14336
    v_mfma_f32_16x16x32_bf16 a[68:71], v[164:167], v[124:127], a[68:71]
    s_nop 0
    ds_read_b64_tr_b16 v[160:161], v190 offset:37120
    ds_read_b64_tr_b16 v[162:163], v190 offset:38656
    s_waitcnt lgkmcnt(8)
    v_mfma_f32_16x16x32_bf16 a[72:75], v[144:147], v[116:119], a[72:75]
    v_mfma_f32_16x16x32_bf16 a[76:79], v[144:147], v[120:123], a[76:79]
    buffer_load_dwordx4 v199, s[48:51], s65 offen nt lds
    v_mfma_f32_16x16x32_bf16 a[80:83], v[144:147], v[124:127], a[80:83]
    s_add_u32 s66, s66, 12288
    ds_read_b64_tr_b16 v[164:165], v191 offset:37120
    ds_read_b64_tr_b16 v[166:167], v191 offset:38656
    s_waitcnt lgkmcnt(8)
    v_mfma_f32_16x16x32_bf16 a[84:87], v[148:151], v[116:119], a[84:87]
    v_mfma_f32_16x16x32_bf16 a[88:91], v[148:151], v[120:123], a[88:91]
    s_add_u32 s65, s65, 12288
    v_mfma_f32_16x16x32_bf16 a[92:95], v[148:151], v[124:127], a[92:95]
    s_add_u32 s79, s79, 24576
    ds_read_b64_tr_b16 v[144:145], v188 offset:61440
    ds_read_b64_tr_b16 v[146:147], v188 offset:62976
    s_waitcnt lgkmcnt(8)
    v_mfma_f32_16x16x32_bf16 a[96:99], v[152:155], v[116:119], a[96:99]
    v_mfma_f32_16x16x32_bf16 a[100:103], v[152:155], v[120:123], a[100:103]
    s_cmp_ge_u32 s79, 147456
    v_mfma_f32_16x16x32_bf16 a[104:107], v[152:155], v[124:127], a[104:107]
    s_cselect_b32 s79, s67, s79
    ds_read_b64_tr_b16 v[148:149], v189 offset:61440
    ds_read_b64_tr_b16 v[150:151], v189 offset:62976
    s_waitcnt lgkmcnt(8)
    v_mfma_f32_16x16x32_bf16 a[108:111], v[156:159], v[116:119], a[108:111]
    v_mfma_f32_16x16x32_bf16 a[112:115], v[156:159], v[120:123], a[112:115]
    v_mfma_f32_16x16x32_bf16 a[116:119], v[156:159], v[124:127], a[116:119]
    ds_read_b64_tr_b16 v[152:153], v190 offset:61440
    ds_read_b64_tr_b16 v[154:155], v190 offset:62976
    s_waitcnt lgkmcnt(8)
    v_mfma_f32_16x16x32_bf16 a[120:123], v[160:163], v[116:119], a[120:123]
    v_mfma_f32_16x16x32_bf16 a[124:127], v[160:163], v[120:123], a[124:127]
    v_mfma_f32_16x16x32_bf16 a[128:131], v[160:163], v[124:127], a[128:131]
    ds_read_b64_tr_b16 v[156:157], v191 offset:61440
    ds_read_b64_tr_b16 v[158:159], v191 offset:62976
    s_waitcnt lgkmcnt(8)
    v_mfma_f32_16x16x32_bf16 a[132:135], v[164:167], v[116:119], a[132:135]
    v_mfma_f32_16x16x32_bf16 a[136:139], v[164:167], v[120:123], a[136:139]
    v_mfma_f32_16x16x32_bf16 a[140:143], v[164:167], v[124:127], a[140:143]
    ds_read_b64_tr_b16 v[160:161], v188 offset:61568
    ds_read_b64_tr_b16 v[162:163], v188 offset:63104
    s_waitcnt lgkmcnt(8)
    v_mfma_f32_16x16x32_bf16 a[144:147], v[144:147], v[116:119], a[144:147]
    v_mfma_f32_16x16x32_bf16 a[148:151], v[144:147], v[120:123], a[148:151]
    v_mfma_f32_16x16x32_bf16 a[152:155], v[144:147], v[124:127], a[152:155]
    ds_read_b64_tr_b16 v[164:165], v189 offset:61568
    ds_read_b64_tr_b16 v[166:167], v189 offset:63104
    s_waitcnt lgkmcnt(8)
    v_mfma_f32_16x16x32_bf16 a[156:159], v[148:151], v[116:119], a[156:159]
    v_mfma_f32_16x16x32_bf16 a[160:163], v[148:151], v[120:123], a[160:163]
    v_mfma_f32_16x16x32_bf16 a[164:167], v[148:151], v[124:127], a[164:167]
    ds_read_b64_tr_b16 v[144:145], v190 offset:61568
    ds_read_b64_tr_b16 v[146:147], v190 offset:63104
    s_waitcnt lgkmcnt(8)
    v_mfma_f32_16x16x32_bf16 a[168:171], v[152:155], v[116:119], a[168:171]
    v_mfma_f32_16x16x32_bf16 a[172:175], v[152:155], v[120:123], a[172:175]
    v_mfma_f32_16x16x32_bf16 a[176:179], v[152:155], v[124:127], a[176:179]
    ds_read_b64_tr_b16 v[148:149], v191 offset:61568
    ds_read_b64_tr_b16 v[150:151], v191 offset:63104
    s_waitcnt lgkmcnt(8)
    v_mfma_f32_16x16x32_bf16 a[180:183], v[156:159], v[116:119], a[180:183]
    v_mfma_f32_16x16x32_bf16 a[184:187], v[156:159], v[120:123], a[184:187]
    v_mfma_f32_16x16x32_bf16 a[188:191], v[156:159], v[124:127], a[188:191]
    ds_read_b64_tr_b16 v[152:153], v188 offset:61696
    ds_read_b64_tr_b16 v[154:155], v188 offset:63232
    s_waitcnt lgkmcnt(8)
    v_mfma_f32_16x16x32_bf16 a[192:195], v[160:163], v[116:119], a[192:195]
    v_mfma_f32_16x16x32_bf16 a[196:199], v[160:163], v[120:123], a[196:199]
    v_mfma_f32_16x16x32_bf16 a[200:203], v[160:163], v[124:127], a[200:203]
    ds_read_b64_tr_b16 v[156:157], v189 offset:61696
    ds_read_b64_tr_b16 v[158:159], v189 offset:63232
    s_waitcnt lgkmcnt(8)
    v_mfma_f32_16x16x32_bf16 a[204:207], v[164:167], v[116:119], a[204:207]
    v_mfma_f32_16x16x32_bf16 a[208:211], v[164:167], v[120:123], a[208:211]
    v_mfma_f32_16x16x32_bf16 a[212:215], v[164:167], v[124:127], a[212:215]
    ds_read_b64_tr_b16 v[160:161], v190 offset:61696
    ds_read_b64_tr_b16 v[162:163], v190 offset:63232
    s_waitcnt lgkmcnt(8)
    v_mfma_f32_16x16x32_bf16 a[216:219], v[144:147], v[116:119], a[216:219]
    v_mfma_f32_16x16x32_bf16 a[220:223], v[144:147], v[120:123], a[220:223]
    v_mfma_f32_16x16x32_bf16 a[224:227], v[144:147], v[124:127], a[224:227]
    ds_read_b64_tr_b16 v[164:165], v191 offset:61696
    ds_read_b64_tr_b16 v[166:167], v191 offset:63232
    s_waitcnt lgkmcnt(8)
    v_mfma_f32_16x16x32_bf16 a[228:231], v[148:151], v[116:119], a[228:231]
    v_mfma_f32_16x16x32_bf16 a[232:235], v[148:151], v[120:123], a[232:235]
    v_mfma_f32_16x16x32_bf16 a[236:239], v[148:151], v[124:127], a[236:239]
    s_waitcnt lgkmcnt(6)
    v_mfma_f32_16x16x32_bf16 a[240:243], v[152:155], v[116:119], a[240:243]
    v_mfma_f32_16x16x32_bf16 a[244:247], v[152:155], v[120:123], a[244:247]
    v_mfma_f32_16x16x32_bf16 a[248:251], v[152:155], v[124:127], a[248:251]
    s_waitcnt lgkmcnt(4)
    v_mfma_f32_16x16x32_bf16 a[252:255], v[156:159], v[116:119], a[252:255]
    v_mfma_f32_16x16x32_bf16 v[72:75], v[156:159], v[120:123], v[72:75]
    v_mfma_f32_16x16x32_bf16 v[76:79], v[156:159], v[124:127], v[76:79]
    s_waitcnt lgkmcnt(2)
    v_mfma_f32_16x16x32_bf16 v[80:83], v[160:163], v[116:119], v[80:83]
    v_mfma_f32_16x16x32_bf16 v[84:87], v[160:163], v[120:123], v[84:87]
    v_mfma_f32_16x16x32_bf16 v[88:91], v[160:163], v[124:127], v[88:91]
    s_waitcnt lgkmcnt(0)
    v_mfma_f32_16x16x32_bf16 v[92:95], v[164:167], v[116:119], v[92:95]
    v_mfma_f32_16x16x32_bf16 v[96:99], v[164:167], v[120:123], v[96:99]
    v_mfma_f32_16x16x32_bf16 v[100:103], v[164:167], v[124:127], v[100:103]
    s_nop 7
    v_accvgpr_read_b32 v212, a144
    v_accvgpr_read_b32 v213, a145
    v_accvgpr_read_b32 v214, a146
    v_accvgpr_read_b32 v215, a147
    v_accvgpr_read_b32 v216, a156
    v_accvgpr_read_b32 v217, a157
    v_accvgpr_read_b32 v218, a158
    v_accvgpr_read_b32 v219, a159
    v_mul_f32 v212, s70, v212
    v_mul_f32 v213, s70, v213
    v_mul_f32 v214, s70, v214
    v_mul_f32 v215, s70, v215
    v_mul_f32 v216, s70, v216
    v_mul_f32 v217, s70, v217
    v_mul_f32 v218, s70, v218
    v_mul_f32 v219, s70, v219
    v_cvt_pk_bf16_f32 v0, v212, v213
    v_cvt_pk_bf16_f32 v1, v214, v215
    v_cvt_pk_bf16_f32 v2, v216, v217
    v_cvt_pk_bf16_f32 v3, v218, v219
    s_nop 1
    v_permlane32_swap_b32 v0, v2
    v_permlane32_swap_b32 v1, v3
    s_nop 1
    v_permlane16_swap_b32 v0, v2
    v_permlane16_swap_b32 v1, v3
    v_accvgpr_read_b32 v212, a148
    v_accvgpr_read_b32 v213, a149
    v_accvgpr_read_b32 v214, a150
    v_accvgpr_read_b32 v215, a151
    v_accvgpr_read_b32 v216, a160
    v_accvgpr_read_b32 v217, a161
    v_accvgpr_read_b32 v218, a162
    v_accvgpr_read_b32 v219, a163
    v_mul_f32 v212, s70, v212
    v_mul_f32 v213, s70, v213
    v_mul_f32 v214, s70, v214
    v_mul_f32 v215, s70, v215
    v_mul_f32 v216, s70, v216
    v_mul_f32 v217, s70, v217
    v_mul_f32 v218, s70, v218
    v_mul_f32 v219, s70, v219
    v_cvt_pk_bf16_f32 v4, v212, v213
    v_cvt_pk_bf16_f32 v5, v214, v215
    v_cvt_pk_bf16_f32 v6, v216, v217
    v_cvt_pk_bf16_f32 v7, v218, v219
    s_nop 1
    v_permlane32_swap_b32 v4, v6
    v_permlane32_swap_b32 v5, v7
    s_nop 1
    v_permlane16_swap_b32 v4, v6
    v_permlane16_swap_b32 v5, v7
    v_accvgpr_read_b32 v212, a152
    v_accvgpr_read_b32 v213, a153
    v_accvgpr_read_b32 v214, a154
    v_accvgpr_read_b32 v215, a155
    v_accvgpr_read_b32 v216, a164
    v_accvgpr_read_b32 v217, a165
    v_accvgpr_read_b32 v218, a166
    v_accvgpr_read_b32 v219, a167
    v_mul_f32 v212, s70, v212
    v_mul_f32 v213, s70, v213
    v_mul_f32 v214, s70, v214
    v_mul_f32 v215, s70, v215
    v_mul_f32 v216, s70, v216
    v_mul_f32 v217, s70, v217
    v_mul_f32 v218, s70, v218
    v_mul_f32 v219, s70, v219
    v_cvt_pk_bf16_f32 v8, v212, v213
    v_cvt_pk_bf16_f32 v9, v214, v215
    v_cvt_pk_bf16_f32 v10, v216, v217
    v_cvt_pk_bf16_f32 v11, v218, v219
    s_nop 1
    v_permlane32_swap_b32 v8, v10
    v_permlane32_swap_b32 v9, v11
    s_nop 1
    v_permlane16_swap_b32 v8, v10
    v_permlane16_swap_b32 v9, v11
    v_accvgpr_read_b32 v212, a168
    v_accvgpr_read_b32 v213, a169
    v_accvgpr_read_b32 v214, a170
    v_accvgpr_read_b32 v215, a171
    v_accvgpr_read_b32 v216, a180
    v_accvgpr_read_b32 v217, a181
    v_accvgpr_read_b32 v218, a182
    v_accvgpr_read_b32 v219, a183
    v_mul_f32 v212, s70, v212
    v_mul_f32 v213, s70, v213
    v_mul_f32 v214, s70, v214
    v_mul_f32 v215, s70, v215
    v_mul_f32 v216, s70, v216
    v_mul_f32 v217, s70, v217
    v_mul_f32 v218, s70, v218
    v_mul_f32 v219, s70, v219
    v_cvt_pk_bf16_f32 v12, v212, v213
    v_cvt_pk_bf16_f32 v13, v214, v215
    v_cvt_pk_bf16_f32 v14, v216, v217
    v_cvt_pk_bf16_f32 v15, v218, v219
    s_nop 1
    v_permlane32_swap_b32 v12, v14
    v_permlane32_swap_b32 v13, v15
    s_nop 1
    v_permlane16_swap_b32 v12, v14
    v_permlane16_swap_b32 v13, v15
    v_accvgpr_read_b32 v212, a172
    v_accvgpr_read_b32 v213, a173
    v_accvgpr_read_b32 v214, a174
    v_accvgpr_read_b32 v215, a175
    v_accvgpr_read_b32 v216, a184
    v_accvgpr_read_b32 v217, a185
    v_accvgpr_read_b32 v218, a186
    v_accvgpr_read_b32 v219, a187
    v_mul_f32 v212, s70, v212
    v_mul_f32 v213, s70, v213
    v_mul_f32 v214, s70, v214
    v_mul_f32 v215, s70, v215
    v_mul_f32 v216, s70, v216
    v_mul_f32 v217, s70, v217
    v_mul_f32 v218, s70, v218
    v_mul_f32 v219, s70, v219
    v_cvt_pk_bf16_f32 v16, v212, v213
    v_cvt_pk_bf16_f32 v17, v214, v215
    v_cvt_pk_bf16_f32 v18, v216, v217
    v_cvt_pk_bf16_f32 v19, v218, v219
    s_nop 1
    v_permlane32_swap_b32 v16, v18
    v_permlane32_swap_b32 v17, v19
    s_nop 1
    v_permlane16_swap_b32 v16, v18
    v_permlane16_swap_b32 v17, v19
    v_accvgpr_read_b32 v212, a176
    v_accvgpr_read_b32 v213, a177
    v_accvgpr_read_b32 v214, a178
    v_accvgpr_read_b32 v215, a179
    v_accvgpr_read_b32 v216, a188
    v_accvgpr_read_b32 v217, a189
    v_accvgpr_read_b32 v218, a190
    v_accvgpr_read_b32 v219, a191
    v_mul_f32 v212, s70, v212
    v_mul_f32 v213, s70, v213
    v_mul_f32 v214, s70, v214
    v_mul_f32 v215, s70, v215
    v_mul_f32 v216, s70, v216
    v_mul_f32 v217, s70, v217
    v_mul_f32 v218, s70, v218
    v_mul_f32 v219, s70, v219
    v_cvt_pk_bf16_f32 v20, v212, v213
    v_cvt_pk_bf16_f32 v21, v214, v215
    v_cvt_pk_bf16_f32 v22, v216, v217
    v_cvt_pk_bf16_f32 v23, v218, v219
    s_nop 1
    v_permlane32_swap_b32 v20, v22
    v_permlane32_swap_b32 v21, v23
    s_nop 1
    v_permlane16_swap_b32 v20, v22
    v_permlane16_swap_b32 v21, v23
    v_accvgpr_read_b32 v212, a192
    v_accvgpr_read_b32 v213, a193
    v_accvgpr_read_b32 v214, a194
    v_accvgpr_read_b32 v215, a195
    v_accvgpr_read_b32 v216, a204
    v_accvgpr_read_b32 v217, a205
    v_accvgpr_read_b32 v218, a206
    v_accvgpr_read_b32 v219, a207
    v_mul_f32 v212, s70, v212
    v_mul_f32 v213, s70, v213
    v_mul_f32 v214, s70, v214
    v_mul_f32 v215, s70, v215
    v_mul_f32 v216, s70, v216
    v_mul_f32 v217, s70, v217
    v_mul_f32 v218, s70, v218
    v_mul_f32 v219, s70, v219
    v_cvt_pk_bf16_f32 v24, v212, v213
    v_cvt_pk_bf16_f32 v25, v214, v215
    v_cvt_pk_bf16_f32 v26, v216, v217
    v_cvt_pk_bf16_f32 v27, v218, v219
    s_nop 1
    v_permlane32_swap_b32 v24, v26
    v_permlane32_swap_b32 v25, v27
    s_nop 1
    v_permlane16_swap_b32 v24, v26
    v_permlane16_swap_b32 v25, v27
    v_accvgpr_read_b32 v212, a196
    v_accvgpr_read_b32 v213, a197
    v_accvgpr_read_b32 v214, a198
    v_accvgpr_read_b32 v215, a199
    v_accvgpr_read_b32 v216, a208
    v_accvgpr_read_b32 v217, a209
    v_accvgpr_read_b32 v218, a210
    v_accvgpr_read_b32 v219, a211
    v_mul_f32 v212, s70, v212
    v_mul_f32 v213, s70, v213
    v_mul_f32 v214, s70, v214
    v_mul_f32 v215, s70, v215
    v_mul_f32 v216, s70, v216
    v_mul_f32 v217, s70, v217
    v_mul_f32 v218, s70, v218
    v_mul_f32 v219, s70, v219
    v_cvt_pk_bf16_f32 v28, v212, v213
    v_cvt_pk_bf16_f32 v29, v214, v215
    v_cvt_pk_bf16_f32 v30, v216, v217
    v_cvt_pk_bf16_f32 v31, v218, v219
    s_nop 1
    v_permlane32_swap_b32 v28, v30
    v_permlane32_swap_b32 v29, v31
    s_nop 1
    v_permlane16_swap_b32 v28, v30
    v_permlane16_swap_b32 v29, v31
    v_accvgpr_read_b32 v212, a200
    v_accvgpr_read_b32 v213, a201
    v_accvgpr_read_b32 v214, a202
    v_accvgpr_read_b32 v215, a203
    v_accvgpr_read_b32 v216, a212
    v_accvgpr_read_b32 v217, a213
    v_accvgpr_read_b32 v218, a214
    v_accvgpr_read_b32 v219, a215
    v_mul_f32 v212, s70, v212
    v_mul_f32 v213, s70, v213
    v_mul_f32 v214, s70, v214
    v_mul_f32 v215, s70, v215
    v_mul_f32 v216, s70, v216
    v_mul_f32 v217, s70, v217
    v_mul_f32 v218, s70, v218
    v_mul_f32 v219, s70, v219
    v_cvt_pk_bf16_f32 v32, v212, v213
    v_cvt_pk_bf16_f32 v33, v214, v215
    v_cvt_pk_bf16_f32 v34, v216, v217
    v_cvt_pk_bf16_f32 v35, v218, v219
    s_nop 1
    v_permlane32_swap_b32 v32, v34
    v_permlane32_swap_b32 v33, v35
    s_nop 1
    v_permlane16_swap_b32 v32, v34
    v_permlane16_swap_b32 v33, v35
    v_accvgpr_read_b32 v212, a216
    v_accvgpr_read_b32 v213, a217
    v_accvgpr_read_b32 v214, a218
    v_accvgpr_read_b32 v215, a219
    v_accvgpr_read_b32 v216, a228
    v_accvgpr_read_b32 v217, a229
    v_accvgpr_read_b32 v218, a230
    v_accvgpr_read_b32 v219, a231
    v_mul_f32 v212, s70, v212
    v_mul_f32 v213, s70, v213
    v_mul_f32 v214, s70, v214
    v_mul_f32 v215, s70, v215
    v_mul_f32 v216, s70, v216
    v_mul_f32 v217, s70, v217
    v_mul_f32 v218, s70, v218
    v_mul_f32 v219, s70, v219
    v_cvt_pk_bf16_f32 v36, v212, v213
    v_cvt_pk_bf16_f32 v37, v214, v215
    v_cvt_pk_bf16_f32 v38, v216, v217
    v_cvt_pk_bf16_f32 v39, v218, v219
    s_nop 1
    v_permlane32_swap_b32 v36, v38
    v_permlane32_swap_b32 v37, v39
    s_nop 1
    v_permlane16_swap_b32 v36, v38
    v_permlane16_swap_b32 v37, v39
    v_accvgpr_read_b32 v212, a220
    v_accvgpr_read_b32 v213, a221
    v_accvgpr_read_b32 v214, a222
    v_accvgpr_read_b32 v215, a223
    v_accvgpr_read_b32 v216, a232
    v_accvgpr_read_b32 v217, a233
    v_accvgpr_read_b32 v218, a234
    v_accvgpr_read_b32 v219, a235
    v_mul_f32 v212, s70, v212
    v_mul_f32 v213, s70, v213
    v_mul_f32 v214, s70, v214
    v_mul_f32 v215, s70, v215
    v_mul_f32 v216, s70, v216
    v_mul_f32 v217, s70, v217
    v_mul_f32 v218, s70, v218
    v_mul_f32 v219, s70, v219
    v_cvt_pk_bf16_f32 v40, v212, v213
    v_cvt_pk_bf16_f32 v41, v214, v215
    v_cvt_pk_bf16_f32 v42, v216, v217
    v_cvt_pk_bf16_f32 v43, v218, v219
    s_nop 1
    v_permlane32_swap_b32 v40, v42
    v_permlane32_swap_b32 v41, v43
    s_nop 1
    v_permlane16_swap_b32 v40, v42
    v_permlane16_swap_b32 v41, v43
    v_accvgpr_read_b32 v212, a224
    v_accvgpr_read_b32 v213, a225
    v_accvgpr_read_b32 v214, a226
    v_accvgpr_read_b32 v215, a227
    v_accvgpr_read_b32 v216, a236
    v_accvgpr_read_b32 v217, a237
    v_accvgpr_read_b32 v218, a238
    v_accvgpr_read_b32 v219, a239
    v_mul_f32 v212, s70, v212
    v_mul_f32 v213, s70, v213
    v_mul_f32 v214, s70, v214
    v_mul_f32 v215, s70, v215
    v_mul_f32 v216, s70, v216
    v_mul_f32 v217, s70, v217
    v_mul_f32 v218, s70, v218
    v_mul_f32 v219, s70, v219
    v_cvt_pk_bf16_f32 v44, v212, v213
    v_cvt_pk_bf16_f32 v45, v214, v215
    v_cvt_pk_bf16_f32 v46, v216, v217
    v_cvt_pk_bf16_f32 v47, v218, v219
    s_nop 1
    v_permlane32_swap_b32 v44, v46
    v_permlane32_swap_b32 v45, v47
    s_nop 1
    v_permlane16_swap_b32 v44, v46
    v_permlane16_swap_b32 v45, v47
    v_accvgpr_read_b32 v212, a240
    v_accvgpr_read_b32 v213, a241
    v_accvgpr_read_b32 v214, a242
    v_accvgpr_read_b32 v215, a243
    v_accvgpr_read_b32 v216, a252
    v_accvgpr_read_b32 v217, a253
    v_accvgpr_read_b32 v218, a254
    v_accvgpr_read_b32 v219, a255
    v_mul_f32 v212, s70, v212
    v_mul_f32 v213, s70, v213
    v_mul_f32 v214, s70, v214
    v_mul_f32 v215, s70, v215
    v_mul_f32 v216, s70, v216
    v_mul_f32 v217, s70, v217
    v_mul_f32 v218, s70, v218
    v_mul_f32 v219, s70, v219
    v_cvt_pk_bf16_f32 v48, v212, v213
    v_cvt_pk_bf16_f32 v49, v214, v215
    v_cvt_pk_bf16_f32 v50, v216, v217
    v_cvt_pk_bf16_f32 v51, v218, v219
    s_nop 1
    v_permlane32_swap_b32 v48, v50
    v_permlane32_swap_b32 v49, v51
    s_nop 1
    v_permlane16_swap_b32 v48, v50
    v_permlane16_swap_b32 v49, v51
    v_accvgpr_read_b32 v212, a244
    v_accvgpr_read_b32 v213, a245
    v_accvgpr_read_b32 v214, a246
    v_accvgpr_read_b32 v215, a247
    v_mul_f32 v216, s70, v72
    v_mul_f32 v217, s70, v73
    v_mul_f32 v218, s70, v74
    v_mul_f32 v219, s70, v75
    v_mul_f32 v212, s70, v212
    v_mul_f32 v213, s70, v213
    v_mul_f32 v214, s70, v214
    v_mul_f32 v215, s70, v215
    v_cvt_pk_bf16_f32 v52, v212, v213
    v_cvt_pk_bf16_f32 v53, v214, v215
    v_cvt_pk_bf16_f32 v54, v216, v217
    v_cvt_pk_bf16_f32 v55, v218, v219
    s_nop 1
    v_permlane32_swap_b32 v52, v54
    v_permlane32_swap_b32 v53, v55
    s_nop 1
    v_permlane16_swap_b32 v52, v54
    v_permlane16_swap_b32 v53, v55
    v_accvgpr_read_b32 v212, a248
    v_accvgpr_read_b32 v213, a249
    v_accvgpr_read_b32 v214, a250
    v_accvgpr_read_b32 v215, a251
    v_mul_f32 v216, s70, v76
    v_mul_f32 v217, s70, v77
    v_mul_f32 v218, s70, v78
    v_mul_f32 v219, s70, v79
    v_mul_f32 v212, s70, v212
    v_mul_f32 v213, s70, v213
    v_mul_f32 v214, s70, v214
    v_mul_f32 v215, s70, v215
    v_cvt_pk_bf16_f32 v56, v212, v213
    v_cvt_pk_bf16_f32 v57, v214, v215
    v_cvt_pk_bf16_f32 v58, v216, v217
    v_cvt_pk_bf16_f32 v59, v218, v219
    s_nop 1
    v_permlane32_swap_b32 v56, v58
    v_permlane32_swap_b32 v57, v59
    s_nop 1
    v_permlane16_swap_b32 v56, v58
    v_permlane16_swap_b32 v57, v59
    v_mul_f32 v212, s70, v80
    v_mul_f32 v213, s70, v81
    v_mul_f32 v214, s70, v82
    v_mul_f32 v215, s70, v83
    v_mul_f32 v216, s70, v92
    v_mul_f32 v217, s70, v93
    v_mul_f32 v218, s70, v94
    v_mul_f32 v219, s70, v95
    v_cvt_pk_bf16_f32 v60, v212, v213
    v_cvt_pk_bf16_f32 v61, v214, v215
    v_cvt_pk_bf16_f32 v62, v216, v217
    v_cvt_pk_bf16_f32 v63, v218, v219
    s_nop 1
    v_permlane32_swap_b32 v60, v62
    v_permlane32_swap_b32 v61, v63
    s_nop 1
    v_permlane16_swap_b32 v60, v62
    v_permlane16_swap_b32 v61, v63
    v_mul_f32 v212, s70, v84
    v_mul_f32 v213, s70, v85
    v_mul_f32 v214, s70, v86
    v_mul_f32 v215, s70, v87
    v_mul_f32 v216, s70, v96
    v_mul_f32 v217, s70, v97
    v_mul_f32 v218, s70, v98
    v_mul_f32 v219, s70, v99
    v_cvt_pk_bf16_f32 v64, v212, v213
    v_cvt_pk_bf16_f32 v65, v214, v215
    v_cvt_pk_bf16_f32 v66, v216, v217
    v_cvt_pk_bf16_f32 v67, v218, v219
    s_nop 1
    v_permlane32_swap_b32 v64, v66
    v_permlane32_swap_b32 v65, v67
    s_nop 1
    v_permlane16_swap_b32 v64, v66
    v_permlane16_swap_b32 v65, v67
    v_mul_f32 v212, s70, v88
    v_mul_f32 v213, s70, v89
    v_mul_f32 v214, s70, v90
    v_mul_f32 v215, s70, v91
    v_mul_f32 v216, s70, v100
    v_mul_f32 v217, s70, v101
    v_mul_f32 v218, s70, v102
    v_mul_f32 v219, s70, v103
    v_cvt_pk_bf16_f32 v68, v212, v213
    v_cvt_pk_bf16_f32 v69, v214, v215
    v_cvt_pk_bf16_f32 v70, v216, v217
    v_cvt_pk_bf16_f32 v71, v218, v219
    s_nop 1
    v_permlane32_swap_b32 v68, v70
    v_permlane32_swap_b32 v69, v71
    s_nop 1
    v_permlane16_swap_b32 v68, v70
    v_permlane16_swap_b32 v69, v71
    v_accvgpr_write_b32 a144, v0
    v_accvgpr_write_b32 a145, v1
    v_accvgpr_write_b32 a146, v2
    v_accvgpr_write_b32 a147, v3
    v_accvgpr_write_b32 a148, v4
    v_accvgpr_write_b32 a149, v5
    v_accvgpr_write_b32 a150, v6
    v_accvgpr_write_b32 a151, v7
    v_accvgpr_write_b32 a152, v8
    v_accvgpr_write_b32 a153, v9
    v_accvgpr_write_b32 a154, v10
    v_accvgpr_write_b32 a155, v11
    v_accvgpr_write_b32 a156, v12
    v_accvgpr_write_b32 a157, v13
    v_accvgpr_write_b32 a158, v14
    v_accvgpr_write_b32 a159, v15
    v_accvgpr_write_b32 a160, v16
    v_accvgpr_write_b32 a161, v17
    v_accvgpr_write_b32 a162, v18
    v_accvgpr_write_b32 a163, v19
    v_accvgpr_write_b32 a164, v20
    v_accvgpr_write_b32 a165, v21
    v_accvgpr_write_b32 a166, v22
    v_accvgpr_write_b32 a167, v23
    v_accvgpr_write_b32 a168, v24
    v_accvgpr_write_b32 a169, v25
    v_accvgpr_write_b32 a170, v26
    v_accvgpr_write_b32 a171, v27
    v_accvgpr_write_b32 a172, v28
    v_accvgpr_write_b32 a173, v29
    v_accvgpr_write_b32 a174, v30
    v_accvgpr_write_b32 a175, v31
    v_accvgpr_write_b32 a176, v32
    v_accvgpr_write_b32 a177, v33
    v_accvgpr_write_b32 a178, v34
    v_accvgpr_write_b32 a179, v35
    v_accvgpr_write_b32 a180, v36
    v_accvgpr_write_b32 a181, v37
    v_accvgpr_write_b32 a182, v38
    v_accvgpr_write_b32 a183, v39
    v_accvgpr_write_b32 a184, v40
    v_accvgpr_write_b32 a185, v41
    v_accvgpr_write_b32 a186, v42
    v_accvgpr_write_b32 a187, v43
    v_accvgpr_write_b32 a188, v44
    v_accvgpr_write_b32 a189, v45
    v_accvgpr_write_b32 a190, v46
    v_accvgpr_write_b32 a191, v47
    v_accvgpr_write_b32 a192, v48
    v_accvgpr_write_b32 a193, v49
    v_accvgpr_write_b32 a194, v50
    v_accvgpr_write_b32 a195, v51
    v_accvgpr_write_b32 a196, v52
    v_accvgpr_write_b32 a197, v53
    v_accvgpr_write_b32 a198, v54
    v_accvgpr_write_b32 a199, v55
    v_accvgpr_write_b32 a200, v56
    v_accvgpr_write_b32 a201, v57
    v_accvgpr_write_b32 a202, v58
    v_accvgpr_write_b32 a203, v59
    v_accvgpr_write_b32 a204, v60
    v_accvgpr_write_b32 a205, v61
    v_accvgpr_write_b32 a206, v62
    v_accvgpr_write_b32 a207, v63
    v_accvgpr_write_b32 a208, v64
    v_accvgpr_write_b32 a209, v65
    v_accvgpr_write_b32 a210, v66
    v_accvgpr_write_b32 a211, v67
    v_accvgpr_write_b32 a212, v68
    v_accvgpr_write_b32 a213, v69
    v_accvgpr_write_b32 a214, v70
    v_accvgpr_write_b32 a215, v71
    v_accvgpr_read_b32 v212, a0
    v_accvgpr_read_b32 v213, a1
    v_accvgpr_read_b32 v214, a2
    v_accvgpr_read_b32 v215, a3
    v_accvgpr_read_b32 v216, a12
    v_accvgpr_read_b32 v217, a13
    v_accvgpr_read_b32 v218, a14
    v_accvgpr_read_b32 v219, a15
    v_mul_f32 v212, s70, v212
    v_mul_f32 v213, s70, v213
    v_mul_f32 v214, s70, v214
    v_mul_f32 v215, s70, v215
    v_mul_f32 v216, s70, v216
    v_mul_f32 v217, s70, v217
    v_mul_f32 v218, s70, v218
    v_mul_f32 v219, s70, v219
    v_cvt_pk_bf16_f32 v0, v212, v213
    v_cvt_pk_bf16_f32 v1, v214, v215
    v_cvt_pk_bf16_f32 v2, v216, v217
    v_cvt_pk_bf16_f32 v3, v218, v219
    s_nop 1
    v_permlane32_swap_b32 v0, v2
    v_permlane32_swap_b32 v1, v3
    s_nop 1
    v_permlane16_swap_b32 v0, v2
    v_permlane16_swap_b32 v1, v3
    v_accvgpr_read_b32 v212, a4
    v_accvgpr_read_b32 v213, a5
    v_accvgpr_read_b32 v214, a6
    v_accvgpr_read_b32 v215, a7
    v_accvgpr_read_b32 v216, a16
    v_accvgpr_read_b32 v217, a17
    v_accvgpr_read_b32 v218, a18
    v_accvgpr_read_b32 v219, a19
    v_mul_f32 v212, s70, v212
    v_mul_f32 v213, s70, v213
    v_mul_f32 v214, s70, v214
    v_mul_f32 v215, s70, v215
    v_mul_f32 v216, s70, v216
    v_mul_f32 v217, s70, v217
    v_mul_f32 v218, s70, v218
    v_mul_f32 v219, s70, v219
    v_cvt_pk_bf16_f32 v4, v212, v213
    v_cvt_pk_bf16_f32 v5, v214, v215
    v_cvt_pk_bf16_f32 v6, v216, v217
    v_cvt_pk_bf16_f32 v7, v218, v219
    s_nop 1
    v_permlane32_swap_b32 v4, v6
    v_permlane32_swap_b32 v5, v7
    s_nop 1
    v_permlane16_swap_b32 v4, v6
    v_permlane16_swap_b32 v5, v7
    v_accvgpr_read_b32 v212, a8
    v_accvgpr_read_b32 v213, a9
    v_accvgpr_read_b32 v214, a10
    v_accvgpr_read_b32 v215, a11
    v_accvgpr_read_b32 v216, a20
    v_accvgpr_read_b32 v217, a21
    v_accvgpr_read_b32 v218, a22
    v_accvgpr_read_b32 v219, a23
    v_mul_f32 v212, s70, v212
    v_mul_f32 v213, s70, v213
    v_mul_f32 v214, s70, v214
    v_mul_f32 v215, s70, v215
    v_mul_f32 v216, s70, v216
    v_mul_f32 v217, s70, v217
    v_mul_f32 v218, s70, v218
    v_mul_f32 v219, s70, v219
    v_cvt_pk_bf16_f32 v8, v212, v213
    v_cvt_pk_bf16_f32 v9, v214, v215
    v_cvt_pk_bf16_f32 v10, v216, v217
    v_cvt_pk_bf16_f32 v11, v218, v219
    s_nop 1
    v_permlane32_swap_b32 v8, v10
    v_permlane32_swap_b32 v9, v11
    s_nop 1
    v_permlane16_swap_b32 v8, v10
    v_permlane16_swap_b32 v9, v11
    v_accvgpr_read_b32 v212, a24
    v_accvgpr_read_b32 v213, a25
    v_accvgpr_read_b32 v214, a26
    v_accvgpr_read_b32 v215, a27
    v_accvgpr_read_b32 v216, a36
    v_accvgpr_read_b32 v217, a37
    v_accvgpr_read_b32 v218, a38
    v_accvgpr_read_b32 v219, a39
    v_mul_f32 v212, s70, v212
    v_mul_f32 v213, s70, v213
    v_mul_f32 v214, s70, v214
    v_mul_f32 v215, s70, v215
    v_mul_f32 v216, s70, v216
    v_mul_f32 v217, s70, v217
    v_mul_f32 v218, s70, v218
    v_mul_f32 v219, s70, v219
    v_cvt_pk_bf16_f32 v12, v212, v213
    v_cvt_pk_bf16_f32 v13, v214, v215
    v_cvt_pk_bf16_f32 v14, v216, v217
    v_cvt_pk_bf16_f32 v15, v218, v219
    s_nop 1
    v_permlane32_swap_b32 v12, v14
    v_permlane32_swap_b32 v13, v15
    s_nop 1
    v_permlane16_swap_b32 v12, v14
    v_permlane16_swap_b32 v13, v15
    v_accvgpr_read_b32 v212, a28
    v_accvgpr_read_b32 v213, a29
    v_accvgpr_read_b32 v214, a30
    v_accvgpr_read_b32 v215, a31
    v_accvgpr_read_b32 v216, a40
    v_accvgpr_read_b32 v217, a41
    v_accvgpr_read_b32 v218, a42
    v_accvgpr_read_b32 v219, a43
    v_mul_f32 v212, s70, v212
    v_mul_f32 v213, s70, v213
    v_mul_f32 v214, s70, v214
    v_mul_f32 v215, s70, v215
    v_mul_f32 v216, s70, v216
    v_mul_f32 v217, s70, v217
    v_mul_f32 v218, s70, v218
    v_mul_f32 v219, s70, v219
    v_cvt_pk_bf16_f32 v16, v212, v213
    v_cvt_pk_bf16_f32 v17, v214, v215
    v_cvt_pk_bf16_f32 v18, v216, v217
    v_cvt_pk_bf16_f32 v19, v218, v219
    s_nop 1
    v_permlane32_swap_b32 v16, v18
    v_permlane32_swap_b32 v17, v19
    s_nop 1
    v_permlane16_swap_b32 v16, v18
    v_permlane16_swap_b32 v17, v19
    v_accvgpr_read_b32 v212, a32
    v_accvgpr_read_b32 v213, a33
    v_accvgpr_read_b32 v214, a34
    v_accvgpr_read_b32 v215, a35
    v_accvgpr_read_b32 v216, a44
    v_accvgpr_read_b32 v217, a45
    v_accvgpr_read_b32 v218, a46
    v_accvgpr_read_b32 v219, a47
    v_mul_f32 v212, s70, v212
    v_mul_f32 v213, s70, v213
    v_mul_f32 v214, s70, v214
    v_mul_f32 v215, s70, v215
    v_mul_f32 v216, s70, v216
    v_mul_f32 v217, s70, v217
    v_mul_f32 v218, s70, v218
    v_mul_f32 v219, s70, v219
    v_cvt_pk_bf16_f32 v20, v212, v213
    v_cvt_pk_bf16_f32 v21, v214, v215
    v_cvt_pk_bf16_f32 v22, v216, v217
    v_cvt_pk_bf16_f32 v23, v218, v219
    s_nop 1
    v_permlane32_swap_b32 v20, v22
    v_permlane32_swap_b32 v21, v23
    s_nop 1
    v_permlane16_swap_b32 v20, v22
    v_permlane16_swap_b32 v21, v23
    v_accvgpr_read_b32 v212, a48
    v_accvgpr_read_b32 v213, a49
    v_accvgpr_read_b32 v214, a50
    v_accvgpr_read_b32 v215, a51
    v_accvgpr_read_b32 v216, a60
    v_accvgpr_read_b32 v217, a61
    v_accvgpr_read_b32 v218, a62
    v_accvgpr_read_b32 v219, a63
    v_mul_f32 v212, s70, v212
    v_mul_f32 v213, s70, v213
    v_mul_f32 v214, s70, v214
    v_mul_f32 v215, s70, v215
    v_mul_f32 v216, s70, v216
    v_mul_f32 v217, s70, v217
    v_mul_f32 v218, s70, v218
    v_mul_f32 v219, s70, v219
    v_cvt_pk_bf16_f32 v24, v212, v213
    v_cvt_pk_bf16_f32 v25, v214, v215
    v_cvt_pk_bf16_f32 v26, v216, v217
    v_cvt_pk_bf16_f32 v27, v218, v219
    s_nop 1
    v_permlane32_swap_b32 v24, v26
    v_permlane32_swap_b32 v25, v27
    s_nop 1
    v_permlane16_swap_b32 v24, v26
    v_permlane16_swap_b32 v25, v27
    v_accvgpr_read_b32 v212, a52
    v_accvgpr_read_b32 v213, a53
    v_accvgpr_read_b32 v214, a54
    v_accvgpr_read_b32 v215, a55
    v_accvgpr_read_b32 v216, a64
    v_accvgpr_read_b32 v217, a65
    v_accvgpr_read_b32 v218, a66
    v_accvgpr_read_b32 v219, a67
    v_mul_f32 v212, s70, v212
    v_mul_f32 v213, s70, v213
    v_mul_f32 v214, s70, v214
    v_mul_f32 v215, s70, v215
    v_mul_f32 v216, s70, v216
    v_mul_f32 v217, s70, v217
    v_mul_f32 v218, s70, v218
    v_mul_f32 v219, s70, v219
    v_cvt_pk_bf16_f32 v28, v212, v213
    v_cvt_pk_bf16_f32 v29, v214, v215
    v_cvt_pk_bf16_f32 v30, v216, v217
    v_cvt_pk_bf16_f32 v31, v218, v219
    s_nop 1
    v_permlane32_swap_b32 v28, v30
    v_permlane32_swap_b32 v29, v31
    s_nop 1
    v_permlane16_swap_b32 v28, v30
    v_permlane16_swap_b32 v29, v31
    v_accvgpr_read_b32 v212, a56
    v_accvgpr_read_b32 v213, a57
    v_accvgpr_read_b32 v214, a58
    v_accvgpr_read_b32 v215, a59
    v_accvgpr_read_b32 v216, a68
    v_accvgpr_read_b32 v217, a69
    v_accvgpr_read_b32 v218, a70
    v_accvgpr_read_b32 v219, a71
    v_mul_f32 v212, s70, v212
    v_mul_f32 v213, s70, v213
    v_mul_f32 v214, s70, v214
    v_mul_f32 v215, s70, v215
    v_mul_f32 v216, s70, v216
    v_mul_f32 v217, s70, v217
    v_mul_f32 v218, s70, v218
    v_mul_f32 v219, s70, v219
    v_cvt_pk_bf16_f32 v32, v212, v213
    v_cvt_pk_bf16_f32 v33, v214, v215
    v_cvt_pk_bf16_f32 v34, v216, v217
    v_cvt_pk_bf16_f32 v35, v218, v219
    s_nop 1
    v_permlane32_swap_b32 v32, v34
    v_permlane32_swap_b32 v33, v35
    s_nop 1
    v_permlane16_swap_b32 v32, v34
    v_permlane16_swap_b32 v33, v35
    v_accvgpr_read_b32 v212, a72
    v_accvgpr_read_b32 v213, a73
    v_accvgpr_read_b32 v214, a74
    v_accvgpr_read_b32 v215, a75
    v_accvgpr_read_b32 v216, a84
    v_accvgpr_read_b32 v217, a85
    v_accvgpr_read_b32 v218, a86
    v_accvgpr_read_b32 v219, a87
    v_mul_f32 v212, s70, v212
    v_mul_f32 v213, s70, v213
    v_mul_f32 v214, s70, v214
    v_mul_f32 v215, s70, v215
    v_mul_f32 v216, s70, v216
    v_mul_f32 v217, s70, v217
    v_mul_f32 v218, s70, v218
    v_mul_f32 v219, s70, v219
    v_cvt_pk_bf16_f32 v36, v212, v213
    v_cvt_pk_bf16_f32 v37, v214, v215
    v_cvt_pk_bf16_f32 v38, v216, v217
    v_cvt_pk_bf16_f32 v39, v218, v219
    s_nop 1
    v_permlane32_swap_b32 v36, v38
    v_permlane32_swap_b32 v37, v39
    s_nop 1
    v_permlane16_swap_b32 v36, v38
    v_permlane16_swap_b32 v37, v39
    v_accvgpr_read_b32 v212, a76
    v_accvgpr_read_b32 v213, a77
    v_accvgpr_read_b32 v214, a78
    v_accvgpr_read_b32 v215, a79
    v_accvgpr_read_b32 v216, a88
    v_accvgpr_read_b32 v217, a89
    v_accvgpr_read_b32 v218, a90
    v_accvgpr_read_b32 v219, a91
    v_mul_f32 v212, s70, v212
    v_mul_f32 v213, s70, v213
    v_mul_f32 v214, s70, v214
    v_mul_f32 v215, s70, v215
    v_mul_f32 v216, s70, v216
    v_mul_f32 v217, s70, v217
    v_mul_f32 v218, s70, v218
    v_mul_f32 v219, s70, v219
    v_cvt_pk_bf16_f32 v40, v212, v213
    v_cvt_pk_bf16_f32 v41, v214, v215
    v_cvt_pk_bf16_f32 v42, v216, v217
    v_cvt_pk_bf16_f32 v43, v218, v219
    s_nop 1
    v_permlane32_swap_b32 v40, v42
    v_permlane32_swap_b32 v41, v43
    s_nop 1
    v_permlane16_swap_b32 v40, v42
    v_permlane16_swap_b32 v41, v43
    v_accvgpr_read_b32 v212, a80
    v_accvgpr_read_b32 v213, a81
    v_accvgpr_read_b32 v214, a82
    v_accvgpr_read_b32 v215, a83
    v_accvgpr_read_b32 v216, a92
    v_accvgpr_read_b32 v217, a93
    v_accvgpr_read_b32 v218, a94
    v_accvgpr_read_b32 v219, a95
    v_mul_f32 v212, s70, v212
    v_mul_f32 v213, s70, v213
    v_mul_f32 v214, s70, v214
    v_mul_f32 v215, s70, v215
    v_mul_f32 v216, s70, v216
    v_mul_f32 v217, s70, v217
    v_mul_f32 v218, s70, v218
    v_mul_f32 v219, s70, v219
    v_cvt_pk_bf16_f32 v44, v212, v213
    v_cvt_pk_bf16_f32 v45, v214, v215
    v_cvt_pk_bf16_f32 v46, v216, v217
    v_cvt_pk_bf16_f32 v47, v218, v219
    s_nop 1
    v_permlane32_swap_b32 v44, v46
    v_permlane32_swap_b32 v45, v47
    s_nop 1
    v_permlane16_swap_b32 v44, v46
    v_permlane16_swap_b32 v45, v47
    v_accvgpr_read_b32 v212, a96
    v_accvgpr_read_b32 v213, a97
    v_accvgpr_read_b32 v214, a98
    v_accvgpr_read_b32 v215, a99
    v_accvgpr_read_b32 v216, a108
    v_accvgpr_read_b32 v217, a109
    v_accvgpr_read_b32 v218, a110
    v_accvgpr_read_b32 v219, a111
    v_mul_f32 v212, s70, v212
    v_mul_f32 v213, s70, v213
    v_mul_f32 v214, s70, v214
    v_mul_f32 v215, s70, v215
    v_mul_f32 v216, s70, v216
    v_mul_f32 v217, s70, v217
    v_mul_f32 v218, s70, v218
    v_mul_f32 v219, s70, v219
    v_cvt_pk_bf16_f32 v48, v212, v213
    v_cvt_pk_bf16_f32 v49, v214, v215
    v_cvt_pk_bf16_f32 v50, v216, v217
    v_cvt_pk_bf16_f32 v51, v218, v219
    s_nop 1
    v_permlane32_swap_b32 v48, v50
    v_permlane32_swap_b32 v49, v51
    s_nop 1
    v_permlane16_swap_b32 v48, v50
    v_permlane16_swap_b32 v49, v51
    v_accvgpr_read_b32 v212, a100
    v_accvgpr_read_b32 v213, a101
    v_accvgpr_read_b32 v214, a102
    v_accvgpr_read_b32 v215, a103
    v_accvgpr_read_b32 v216, a112
    v_accvgpr_read_b32 v217, a113
    v_accvgpr_read_b32 v218, a114
    v_accvgpr_read_b32 v219, a115
    v_mul_f32 v212, s70, v212
    v_mul_f32 v213, s70, v213
    v_mul_f32 v214, s70, v214
    v_mul_f32 v215, s70, v215
    v_mul_f32 v216, s70, v216
    v_mul_f32 v217, s70, v217
    v_mul_f32 v218, s70, v218
    v_mul_f32 v219, s70, v219
    v_cvt_pk_bf16_f32 v52, v212, v213
    v_cvt_pk_bf16_f32 v53, v214, v215
    v_cvt_pk_bf16_f32 v54, v216, v217
    v_cvt_pk_bf16_f32 v55, v218, v219
    s_nop 1
    v_permlane32_swap_b32 v52, v54
    v_permlane32_swap_b32 v53, v55
    s_nop 1
    v_permlane16_swap_b32 v52, v54
    v_permlane16_swap_b32 v53, v55
    v_accvgpr_read_b32 v212, a104
    v_accvgpr_read_b32 v213, a105
    v_accvgpr_read_b32 v214, a106
    v_accvgpr_read_b32 v215, a107
    v_accvgpr_read_b32 v216, a116
    v_accvgpr_read_b32 v217, a117
    v_accvgpr_read_b32 v218, a118
    v_accvgpr_read_b32 v219, a119
    v_mul_f32 v212, s70, v212
    v_mul_f32 v213, s70, v213
    v_mul_f32 v214, s70, v214
    v_mul_f32 v215, s70, v215
    v_mul_f32 v216, s70, v216
    v_mul_f32 v217, s70, v217
    v_mul_f32 v218, s70, v218
    v_mul_f32 v219, s70, v219
    v_cvt_pk_bf16_f32 v56, v212, v213
    v_cvt_pk_bf16_f32 v57, v214, v215
    v_cvt_pk_bf16_f32 v58, v216, v217
    v_cvt_pk_bf16_f32 v59, v218, v219
    s_nop 1
    v_permlane32_swap_b32 v56, v58
    v_permlane32_swap_b32 v57, v59
    s_nop 1
    v_permlane16_swap_b32 v56, v58
    v_permlane16_swap_b32 v57, v59
    v_accvgpr_read_b32 v212, a120
    v_accvgpr_read_b32 v213, a121
    v_accvgpr_read_b32 v214, a122
    v_accvgpr_read_b32 v215, a123
    v_accvgpr_read_b32 v216, a132
    v_accvgpr_read_b32 v217, a133
    v_accvgpr_read_b32 v218, a134
    v_accvgpr_read_b32 v219, a135
    v_mul_f32 v212, s70, v212
    v_mul_f32 v213, s70, v213
    v_mul_f32 v214, s70, v214
    v_mul_f32 v215, s70, v215
    v_mul_f32 v216, s70, v216
    v_mul_f32 v217, s70, v217
    v_mul_f32 v218, s70, v218
    v_mul_f32 v219, s70, v219
    v_cvt_pk_bf16_f32 v60, v212, v213
    v_cvt_pk_bf16_f32 v61, v214, v215
    v_cvt_pk_bf16_f32 v62, v216, v217
    v_cvt_pk_bf16_f32 v63, v218, v219
    s_nop 1
    v_permlane32_swap_b32 v60, v62
    v_permlane32_swap_b32 v61, v63
    s_nop 1
    v_permlane16_swap_b32 v60, v62
    v_permlane16_swap_b32 v61, v63
    v_accvgpr_read_b32 v212, a124
    v_accvgpr_read_b32 v213, a125
    v_accvgpr_read_b32 v214, a126
    v_accvgpr_read_b32 v215, a127
    v_accvgpr_read_b32 v216, a136
    v_accvgpr_read_b32 v217, a137
    v_accvgpr_read_b32 v218, a138
    v_accvgpr_read_b32 v219, a139
    v_mul_f32 v212, s70, v212
    v_mul_f32 v213, s70, v213
    v_mul_f32 v214, s70, v214
    v_mul_f32 v215, s70, v215
    v_mul_f32 v216, s70, v216
    v_mul_f32 v217, s70, v217
    v_mul_f32 v218, s70, v218
    v_mul_f32 v219, s70, v219
    v_cvt_pk_bf16_f32 v64, v212, v213
    v_cvt_pk_bf16_f32 v65, v214, v215
    v_cvt_pk_bf16_f32 v66, v216, v217
    v_cvt_pk_bf16_f32 v67, v218, v219
    s_nop 1
    v_permlane32_swap_b32 v64, v66
    v_permlane32_swap_b32 v65, v67
    s_nop 1
    v_permlane16_swap_b32 v64, v66
    v_permlane16_swap_b32 v65, v67
    v_accvgpr_read_b32 v212, a128
    v_accvgpr_read_b32 v213, a129
    v_accvgpr_read_b32 v214, a130
    v_accvgpr_read_b32 v215, a131
    v_accvgpr_read_b32 v216, a140
    v_accvgpr_read_b32 v217, a141
    v_accvgpr_read_b32 v218, a142
    v_accvgpr_read_b32 v219, a143
    v_mul_f32 v212, s70, v212
    v_mul_f32 v213, s70, v213
    v_mul_f32 v214, s70, v214
    v_mul_f32 v215, s70, v215
    v_mul_f32 v216, s70, v216
    v_mul_f32 v217, s70, v217
    v_mul_f32 v218, s70, v218
    v_mul_f32 v219, s70, v219
    v_cvt_pk_bf16_f32 v68, v212, v213
    v_cvt_pk_bf16_f32 v69, v214, v215
    v_cvt_pk_bf16_f32 v70, v216, v217
    v_cvt_pk_bf16_f32 v71, v218, v219
    s_nop 1
    v_permlane32_swap_b32 v68, v70
    v_permlane32_swap_b32 v69, v71
    s_nop 1
    v_permlane16_swap_b32 v68, v70
    v_permlane16_swap_b32 v69, v71
    s_mov_b32 s61, 0
L_k1_head:
    v_accvgpr_write_b32 a0, 0
    v_accvgpr_write_b32 a1, 0
    v_accvgpr_write_b32 a2, 0
    v_accvgpr_write_b32 a3, 0
    v_accvgpr_write_b32 a4, 0
    v_accvgpr_write_b32 a5, 0
    v_accvgpr_write_b32 a6, 0
    v_accvgpr_write_b32 a7, 0
    v_accvgpr_write_b32 a8, 0
    v_accvgpr_write_b32 a9, 0
    v_accvgpr_write_b32 a10, 0
    v_accvgpr_write_b32 a11, 0
    v_accvgpr_write_b32 a12, 0
    v_accvgpr_write_b32 a13, 0
    v_accvgpr_write_b32 a14, 0
    v_accvgpr_write_b32 a15, 0
    v_accvgpr_write_b32 a16, 0
    v_accvgpr_write_b32 a17, 0
    v_accvgpr_write_b32 a18, 0
    v_accvgpr_write_b32 a19, 0
    v_accvgpr_write_b32 a20, 0
    v_accvgpr_write_b32 a21, 0
    v_accvgpr_write_b32 a22, 0
    v_accvgpr_write_b32 a23, 0
    v_accvgpr_write_b32 a24, 0
    v_accvgpr_write_b32 a25, 0
    v_accvgpr_write_b32 a26, 0
    v_accvgpr_write_b32 a27, 0
    v_accvgpr_write_b32 a28, 0
    v_accvgpr_write_b32 a29, 0
    v_accvgpr_write_b32 a30, 0
    v_accvgpr_write_b32 a31, 0
    v_accvgpr_write_b32 a32, 0
    v_accvgpr_write_b32 a33, 0
    v_accvgpr_write_b32 a34, 0
    v_accvgpr_write_b32 a35, 0
    v_accvgpr_write_b32 a36, 0
    v_accvgpr_write_b32 a37, 0
    v_accvgpr_write_b32 a38, 0
    v_accvgpr_write_b32 a39, 0
    v_accvgpr_write_b32 a40, 0
    v_accvgpr_write_b32 a41, 0
    v_accvgpr_write_b32 a42, 0
    v_accvgpr_write_b32 a43, 0
    v_accvgpr_write_b32 a44, 0
    v_accvgpr_write_b32 a45, 0
    v_accvgpr_write_b32 a46, 0
    v_accvgpr_write_b32 a47, 0
    v_accvgpr_write_b32 a48, 0
    v_accvgpr_write_b32 a49, 0
    v_accvgpr_write_b32 a50, 0
    v_accvgpr_write_b32 a51, 0
    v_accvgpr_write_b32 a52, 0
    v_accvgpr_write_b32 a53, 0
    v_accvgpr_write_b32 a54, 0
    v_accvgpr_write_b32 a55, 0
    v_accvgpr_write_b32 a56, 0
    v_accvgpr_write_b32 a57, 0
    v_accvgpr_write_b32 a58, 0
    v_accvgpr_write_b32 a59, 0
    v_accvgpr_write_b32 a60, 0
    v_accvgpr_write_b32 a61, 0
    v_accvgpr_write_b32 a62, 0
    v_accvgpr_write_b32 a63, 0
    v_accvgpr_write_b32 a64, 0
    v_accvgpr_write_b32 a65, 0
    v_accvgpr_write_b32 a66, 0
    v_accvgpr_write_b32 a67, 0
    v_accvgpr_write_b32 a68, 0
    v_accvgpr_write_b32 a69, 0
    v_accvgpr_write_b32 a70, 0
    v_accvgpr_write_b32 a71, 0
    v_accvgpr_write_b32 a72, 0
    v_accvgpr_write_b32 a73, 0
    v_accvgpr_write_b32 a74, 0
    v_accvgpr_write_b32 a75, 0
    v_accvgpr_write_b32 a76, 0
    v_accvgpr_write_b32 a77, 0
    v_accvgpr_write_b32 a78, 0
    v_accvgpr_write_b32 a79, 0
    v_accvgpr_write_b32 a80, 0
    v_accvgpr_write_b32 a81, 0
    v_accvgpr_write_b32 a82, 0
    v_accvgpr_write_b32 a83, 0
    v_accvgpr_write_b32 a84, 0
    v_accvgpr_write_b32 a85, 0
    v_accvgpr_write_b32 a86, 0
    v_accvgpr_write_b32 a87, 0
    v_accvgpr_write_b32 a88, 0
    v_accvgpr_write_b32 a89, 0
    v_accvgpr_write_b32 a90, 0
    v_accvgpr_write_b32 a91, 0
    v_accvgpr_write_b32 a92, 0
    v_accvgpr_write_b32 a93, 0
    v_accvgpr_write_b32 a94, 0
    v_accvgpr_write_b32 a95, 0
    v_accvgpr_write_b32 a96, 0
    v_accvgpr_write_b32 a97, 0
    v_accvgpr_write_b32 a98, 0
    v_accvgpr_write_b32 a99, 0
    v_accvgpr_write_b32 a100, 0
    v_accvgpr_write_b32 a101, 0
    v_accvgpr_write_b32 a102, 0
    v_accvgpr_write_b32 a103, 0
    v_accvgpr_write_b32 a104, 0
    v_accvgpr_write_b32 a105, 0
    v_accvgpr_write_b32 a106, 0
    v_accvgpr_write_b32 a107, 0
    v_accvgpr_write_b32 a108, 0
    v_accvgpr_write_b32 a109, 0
    v_accvgpr_write_b32 a110, 0
    v_accvgpr_write_b32 a111, 0
    v_accvgpr_write_b32 a112, 0
    v_accvgpr_write_b32 a113, 0
    v_accvgpr_write_b32 a114, 0
    v_accvgpr_write_b32 a115, 0
    v_accvgpr_write_b32 a116, 0
    v_accvgpr_write_b32 a117, 0
    v_accvgpr_write_b32 a118, 0
    v_accvgpr_write_b32 a119, 0
    v_accvgpr_write_b32 a120, 0
    v_accvgpr_write_b32 a121, 0
    v_accvgpr_write_b32 a122, 0
    v_accvgpr_write_b32 a123, 0
    v_accvgpr_write_b32 a124, 0
    v_accvgpr_write_b32 a125, 0
    v_accvgpr_write_b32 a126, 0
    v_accvgpr_write_b32 a127, 0
    v_accvgpr_write_b32 a128, 0
    v_accvgpr_write_b32 a129, 0
    v_accvgpr_write_b32 a130, 0
    v_accvgpr_write_b32 a131, 0
    v_accvgpr_write_b32 a132, 0
    v_accvgpr_write_b32 a133, 0
    v_accvgpr_write_b32 a134, 0
    v_accvgpr_write_b32 a135, 0
    v_accvgpr_write_b32 a136, 0
    v_accvgpr_write_b32 a137, 0
    v_accvgpr_write_b32 a138, 0
    v_accvgpr_write_b32 a139, 0
    v_accvgpr_write_b32 a140, 0
    v_accvgpr_write_b32 a141, 0
    v_accvgpr_write_b32 a142, 0
    v_accvgpr_write_b32 a143, 0
    v_mov_b32 v168, 0
    v_mov_b32 v169, 0
    v_mov_b32 v170, 0
    v_mov_b32 v171, 0
    v_mov_b32 v206, 0
    v_mov_b32 v209, 1.0
    v_mov_b32 v172, 0
    v_mov_b32 v173, 0
    v_mov_b32 v174, 0
    v_mov_b32 v175, 0
    v_mov_b32 v207, 0
    v_mov_b32 v210, 1.0
    v_mov_b32 v176, 0
    v_mov_b32 v177, 0
    v_mov_b32 v178, 0
    v_mov_b32 v179, 0
    v_mov_b32 v208, 0
    v_mov_b32 v211, 1.0
    s_mov_b32 s86, 0xff800000
    s_cmp_eq_u32 s87, 0
    s_cbranch_scc0 L_k1_ap1
    s_waitcnt vmcnt(6)
    s_barrier
    s_add_u32 m0, s79, 0
    s_nop 0
    buffer_load_dwordx4 v197, s[52:55], s66 offen nt lds
    s_add_u32 m0, s79, 1024
    s_nop 0
    buffer_load_dwordx4 v198, s[52:55], s66 offen nt lds
    s_add_u32 m0, s79, 2048
    s_nop 0
    buffer_load_dwordx4 v199, s[52:55], s66 offen nt lds
    s_add_u32 m0, s79, 12288
    s_nop 0
    buffer_load_dwordx4 v197, s[48:51], s65 offen nt lds
    s_add_u32 m0, s79, 13312
    s_nop 0
    buffer_load_dwordx4 v198, s[48:51], s65 offen nt lds
    s_add_u32 m0, s79, 14336
    s_nop 0
    buffer_load_dwordx4 v199, s[48:51], s65 offen nt lds
    s_add_u32 s66, s66, 12288
    s_add_u32 s65, s65, 12288
    s_add_u32 s79, s79, 24576
    s_cmp_ge_u32 s79, 147456
    s_cselect_b32 s79, s67, s79
    s_add_u32 m0, s79, 0
    s_nop 0
    buffer_load_dwordx4 v197, s[52:55], s66 offen nt lds
    s_add_u32 m0, s79, 1024
    s_nop 0
    buffer_load_dwordx4 v198, s[52:55], s66 offen nt lds
    s_add_u32 m0, s79, 2048
    s_nop 0
    buffer_load_dwordx4 v199, s[52:55], s66 offen nt lds
    s_add_u32 m0, s79, 12288
    s_nop 0
    buffer_load_dwordx4 v197, s[48:51], s65 offen nt lds
    s_add_u32 m0, s79, 13312
    s_nop 0
    buffer_load_dwordx4 v198, s[48:51], s65 offen nt lds
    s_add_u32 m0, s79, 14336
    s_nop 0
    buffer_load_dwordx4 v199, s[48:51], s65 offen nt lds
    s_add_u32 s66, s66, 12288
    s_add_u32 s65, s65, 12288
    s_add_u32 s79, s79, 24576
    s_cmp_ge_u32 s79, 147456
    s_cselect_b32 s79, s67, s79
    s_branch L_k1_ap2
L_k1_ap1:
    s_waitcnt vmcnt(18)
    s_barrier
L_k1_ap2:
    s_add_u32 s77, s61, 24576
    s_cmp_eq_u32 s77, 147456
    s_cselect_b32 s77, 0, s77
    v_add_u32 v186, s61, v180
    v_add_u32 v187, s61, v181
    ds_read_b128 v[144:147], v186 offset:0
    ds_read_b128 v[148:151], v187 offset:0
    ds_read_b128 v[152:155], v186 offset:128
    ds_read_b128 v[156:159], v187 offset:128
    ds_read_b128 v[160:163], v186 offset:256
    s_waitcnt lgkmcnt(4)
    v_mfma_f32_16x16x32_bf16 v[72:75], v[144:147], v[0:3], v[168:171]
    s_add_u32 m0, s79, 0
    s_nop 0
    v_mfma_f32_16x16x32_bf16 v[76:79], v[144:147], v[4:7], v[172:175]
    buffer_load_dwordx4 v197, s[52:55], s66 offen nt lds
    v_mfma_f32_16x16x32_bf16 v[80:83], v[144:147], v[8:11], v[176:179]
    s_add_u32 m0, s79, 1024
    ds_read_b128 v[164:167], v187 offset:256
    s_waitcnt lgkmcnt(4)
    v_mfma_f32_16x16x32_bf16 v[72:75], v[148:151], v[12:15], v[72:75]
    s_nop 0
    v_mfma_f32_16x16x32_bf16 v[76:79], v[148:151], v[16:19], v[76:79]
    buffer_load_dwordx4 v198, s[52:55], s66 offen nt lds
    v_mfma_f32_16x16x32_bf16 v[80:83], v[148:151], v[20:23], v[80:83]
    s_add_u32 m0, s79, 2048
    ds_read_b128 v[144:147], v186 offset:6144
    s_waitcnt lgkmcnt(4)
    v_mfma_f32_16x16x32_bf16 v[72:75], v[152:155], v[24:27], v[72:75]
    s_nop 0
    buffer_load_dwordx4 v199, s[52:55], s66 offen nt lds
    v_mfma_f32_16x16x32_bf16 v[76:79], v[152:155], v[28:31], v[76:79]
    s_add_u32 m0, s79, 12288
    v_mfma_f32_16x16x32_bf16 v[80:83], v[152:155], v[32:35], v[80:83]
    s_nop 0
    ds_read_b128 v[148:151], v187 offset:6144
    s_waitcnt lgkmcnt(4)
    v_mfma_f32_16x16x32_bf16 v[72:75], v[156:159], v[36:39], v[72:75]
    buffer_load_dwordx4 v197, s[48:51], s65 offen nt lds
    v_mfma_f32_16x16x32_bf16 v[76:79], v[156:159], v[40:43], v[76:79]
    s_add_u32 m0, s79, 13312
    v_mfma_f32_16x16x32_bf16 v[80:83], v[156:159], v[44:47], v[80:83]
    s_nop 0
    ds_read_b128 v[152:155], v186 offset:6272
    s_waitcnt lgkmcnt(4)
    v_mfma_f32_16x16x32_bf16 v[72:75], v[160:163], v[48:51], v[72:75]
    buffer_load_dwordx4 v198, s[48:51], s65 offen nt lds
    v_mfma_f32_16x16x32_bf16 v[76:79], v[160:163], v[52:55], v[76:79]
    s_add_u32 m0, s79, 14336
    s_nop 0
    v_mfma_f32_16x16x32_bf16 v[80:83], v[160:163], v[56:59], v[80:83]
    buffer_load_dwordx4 v199, s[48:51], s65 offen nt lds
    ds_read_b128 v[156:159], v187 offset:6272
    s_waitcnt lgkmcnt(4)
    v_mfma_f32_16x16x32_bf16 v[72:75], v[164:167], v[60:63], v[72:75]
    s_add_u32 s66, s66, 12288
    v_mfma_f32_16x16x32_bf16 v[76:79], v[164:167], v[64:67], v[76:79]
    s_add_u32 s65, s65, 12288
    v_mfma_f32_16x16x32_bf16 v[80:83], v[164:167], v[68:71], v[80:83]
    s_add_u32 s79, s79, 24576
    ds_read_b128 v[160:163], v186 offset:6400
    s_waitcnt lgkmcnt(4)
    v_mfma_f32_16x16x32_bf16 v[84:87], v[144:147], v[0:3], v[168:171]
    s_cmp_ge_u32 s79, 147456
    v_mfma_f32_16x16x32_bf16 v[88:91], v[144:147], v[4:7], v[172:175]
    s_cselect_b32 s79, s67, s79
    v_mfma_f32_16x16x32_bf16 v[92:95], v[144:147], v[8:11], v[176:179]
    ds_read_b128 v[164:167], v187 offset:6400
    s_waitcnt lgkmcnt(4)
    v_mfma_f32_16x16x32_bf16 v[84:87], v[148:151], v[12:15], v[84:87]
    v_mfma_f32_16x16x32_bf16 v[88:91], v[148:151], v[16:19], v[88:91]
    v_mfma_f32_16x16x32_bf16 v[92:95], v[148:151], v[20:23], v[92:95]
    ds_read_b128 v[144:147], v186 offset:12288
    s_waitcnt lgkmcnt(4)
    v_mfma_f32_16x16x32_bf16 v[84:87], v[152:155], v[24:27], v[84:87]
    v_mfma_f32_16x16x32_bf16 v[88:91], v[152:155], v[28:31], v[88:91]
    v_mfma_f32_16x16x32_bf16 v[92:95], v[152:155], v[32:35], v[92:95]
    ds_read_b128 v[148:151], v187 offset:12288
    s_waitcnt lgkmcnt(4)
    v_mfma_f32_16x16x32_bf16 v[84:87], v[156:159], v[36:39], v[84:87]
    v_mfma_f32_16x16x32_bf16 v[88:91], v[156:159], v[40:43], v[88:91]
    v_mfma_f32_16x16x32_bf16 v[92:95], v[156:159], v[44:47], v[92:95]
    ds_read_b128 v[152:155], v186 offset:12416
    s_waitcnt lgkmcnt(4)
    v_mfma_f32_16x16x32_bf16 v[84:87], v[160:163], v[48:51], v[84:87]
    v_mfma_f32_16x16x32_bf16 v[88:91], v[160:163], v[52:55], v[88:91]
    v_mfma_f32_16x16x32_bf16 v[92:95], v[160:163], v[56:59], v[92:95]
    ds_read_b128 v[156:159], v187 offset:12416
    s_waitcnt lgkmcnt(4)
    v_mfma_f32_16x16x32_bf16 v[84:87], v[164:167], v[60:63], v[84:87]
    v_mfma_f32_16x16x32_bf16 v[88:91], v[164:167], v[64:67], v[88:91]
    v_mfma_f32_16x16x32_bf16 v[92:95], v[164:167], v[68:71], v[92:95]
    s_nop 7
    v_max3_f32 v215, v72, v73, v74
    v_max3_f32 v215, v215, v75, v84
    v_max3_f32 v215, v215, v85, v86
    v_max_f32 v215, v215, v87
    v_mov_b32 v218, v215
    s_nop 1
    v_permlane32_swap_b32 v215, v218
    v_max_f32 v215, v215, v218
    v_mov_b32 v218, v215
    s_nop 1
    v_permlane16_swap_b32 v215, v218
    v_max_f32 v215, v215, v218
    v_max_f32 v215, s86, v215
    v_sub_f32 v218, 0, v215
    v_exp_f32 v209, v218
    v_sub_f32 v168, v168, v215
    v_sub_f32 v169, v169, v215
    v_sub_f32 v170, v170, v215
    v_sub_f32 v171, v171, v215
    v_sub_f32 v72, v72, v215
    v_sub_f32 v73, v73, v215
    v_sub_f32 v74, v74, v215
    v_sub_f32 v75, v75, v215
    v_sub_f32 v84, v84, v215
    v_sub_f32 v85, v85, v215
    v_sub_f32 v86, v86, v215
    v_sub_f32 v87, v87, v215
    v_mul_f32 v206, v206, v209
    v_max3_f32 v216, v76, v77, v78
    v_max3_f32 v216, v216, v79, v88
    v_max3_f32 v216, v216, v89, v90
    v_max_f32 v216, v216, v91
    v_mov_b32 v218, v216
    s_nop 1
    v_permlane32_swap_b32 v216, v218
    v_max_f32 v216, v216, v218
    v_mov_b32 v218, v216
    s_nop 1
    v_permlane16_swap_b32 v216, v218
    v_max_f32 v216, v216, v218
    v_max_f32 v216, s86, v216
    v_sub_f32 v218, 0, v216
    v_exp_f32 v210, v218
    v_sub_f32 v172, v172, v216
    v_sub_f32 v173, v173, v216
    v_sub_f32 v174, v174, v216
    v_sub_f32 v175, v175, v216
    v_sub_f32 v76, v76, v216
    v_sub_f32 v77, v77, v216
    v_sub_f32 v78, v78, v216
    v_sub_f32 v79, v79, v216
    v_sub_f32 v88, v88, v216
    v_sub_f32 v89, v89, v216
    v_sub_f32 v90, v90, v216
    v_sub_f32 v91, v91, v216
    v_mul_f32 v207, v207, v210
    v_max3_f32 v217, v80, v81, v82
    v_max3_f32 v217, v217, v83, v92
    v_max3_f32 v217, v217, v93, v94
    v_max_f32 v217, v217, v95
    v_mov_b32 v218, v217
    s_nop 1
    v_permlane32_swap_b32 v217, v218
    v_max_f32 v217, v217, v218
    v_mov_b32 v218, v217
    s_nop 1
    v_permlane16_swap_b32 v217, v218
    v_max_f32 v217, v217, v218
    v_max_f32 v217, s86, v217
    v_sub_f32 v218, 0, v217
    v_exp_f32 v211, v218
    v_sub_f32 v176, v176, v217
    v_sub_f32 v177, v177, v217
    v_sub_f32 v178, v178, v217
    v_sub_f32 v179, v179, v217
    v_sub_f32 v80, v80, v217
    v_sub_f32 v81, v81, v217
    v_sub_f32 v82, v82, v217
    v_sub_f32 v83, v83, v217
    v_sub_f32 v92, v92, v217
    v_sub_f32 v93, v93, v217
    v_sub_f32 v94, v94, v217
    v_sub_f32 v95, v95, v217
    v_mul_f32 v208, v208, v211
    v_exp_f32 v228, v72
    v_exp_f32 v229, v73
    v_exp_f32 v230, v74
    v_exp_f32 v231, v75
    v_exp_f32 v232, v84
    v_exp_f32 v233, v85
    v_exp_f32 v234, v86
    v_exp_f32 v235, v87
    v_exp_f32 v236, v76
    v_exp_f32 v237, v77
    v_exp_f32 v238, v78
    v_exp_f32 v239, v79
    v_exp_f32 v240, v88
    v_exp_f32 v241, v89
    v_exp_f32 v242, v90
    v_exp_f32 v243, v91
    v_exp_f32 v244, v80
    v_exp_f32 v245, v81
    v_exp_f32 v246, v82
    v_exp_f32 v247, v83
    v_exp_f32 v248, v92
    v_exp_f32 v249, v93
    v_exp_f32 v250, v94
    v_exp_f32 v251, v95
    v_add_f32 v212, v228, v229
    v_add_f32 v213, v236, v237
    v_add_f32 v214, v244, v245
    v_add_f32 v212, v212, v230
    v_add_f32 v213, v213, v238
    v_add_f32 v214, v214, v246
    v_add_f32 v212, v212, v231
    v_add_f32 v213, v213, v239
    v_add_f32 v214, v214, v247
    v_add_f32 v212, v212, v232
    v_add_f32 v213, v213, v240
    v_add_f32 v214, v214, v248
    v_add_f32 v212, v212, v233
    v_add_f32 v213, v213, v241
    v_add_f32 v214, v214, v249
    v_add_f32 v212, v212, v234
    v_add_f32 v213, v213, v242
    v_add_f32 v214, v214, v250
    v_add_f32 v212, v212, v235
    v_add_f32 v213, v213, v243
    v_add_f32 v214, v214, v251
    s_mov_b32 s72, 1
    s_mov_b32 s86, 0
    s_nop 1
    ds_read_b128 v[160:163], v186 offset:12544
    s_waitcnt lgkmcnt(4)
    v_mfma_f32_16x16x32_bf16 v[96:99], v[144:147], v[0:3], v[168:171]
    v_add_f32 v206, v206, v212
    v_mfma_f32_16x16x32_bf16 v[100:103], v[144:147], v[4:7], v[172:175]
    v_mfma_f32_16x16x32_bf16 v[104:107], v[144:147], v[8:11], v[176:179]
    v_add_f32 v207, v207, v213
    ds_read_b128 v[164:167], v187 offset:12544
    s_waitcnt lgkmcnt(4)
    v_mfma_f32_16x16x32_bf16 v[96:99], v[148:151], v[12:15], v[96:99]
    v_mfma_f32_16x16x32_bf16 v[100:103], v[148:151], v[16:19], v[100:103]
    v_add_f32 v208, v208, v214
    v_mfma_f32_16x16x32_bf16 v[104:107], v[148:151], v[20:23], v[104:107]
    ds_read_b128 v[144:147], v186 offset:18432
    s_waitcnt lgkmcnt(4)
    v_mfma_f32_16x16x32_bf16 v[96:99], v[152:155], v[24:27], v[96:99]
    v_mfma_f32_16x16x32_bf16 v[100:103], v[152:155], v[28:31], v[100:103]
    v_cvt_pk_bf16_f32 v120, v228, v229
    v_mfma_f32_16x16x32_bf16 v[104:107], v[152:155], v[32:35], v[104:107]
    ds_read_b128 v[148:151], v187 offset:18432
    s_waitcnt lgkmcnt(4)
    v_mfma_f32_16x16x32_bf16 v[96:99], v[156:159], v[36:39], v[96:99]
    v_cvt_pk_bf16_f32 v121, v230, v231
    v_mfma_f32_16x16x32_bf16 v[100:103], v[156:159], v[40:43], v[100:103]
    v_mfma_f32_16x16x32_bf16 v[104:107], v[156:159], v[44:47], v[104:107]
    ds_read_b128 v[152:155], v186 offset:18560
    s_waitcnt lgkmcnt(4)
    v_mfma_f32_16x16x32_bf16 v[96:99], v[160:163], v[48:51], v[96:99]
    v_cvt_pk_bf16_f32 v122, v232, v233
    v_mfma_f32_16x16x32_bf16 v[100:103], v[160:163], v[52:55], v[100:103]
    v_mfma_f32_16x16x32_bf16 v[104:107], v[160:163], v[56:59], v[104:107]
    v_cvt_pk_bf16_f32 v123, v234, v235
    ds_read_b128 v[156:159], v187 offset:18560
    s_waitcnt lgkmcnt(4)
    v_mfma_f32_16x16x32_bf16 v[96:99], v[164:167], v[60:63], v[96:99]
    v_mfma_f32_16x16x32_bf16 v[100:103], v[164:167], v[64:67], v[100:103]
    v_cvt_pk_bf16_f32 v124, v236, v237
    v_mfma_f32_16x16x32_bf16 v[104:107], v[164:167], v[68:71], v[104:107]
    ds_read_b128 v[160:163], v186 offset:18688
    s_waitcnt lgkmcnt(4)
    v_mfma_f32_16x16x32_bf16 v[108:111], v[144:147], v[0:3], v[168:171]
    v_mfma_f32_16x16x32_bf16 v[112:115], v[144:147], v[4:7], v[172:175]
    v_cvt_pk_bf16_f32 v125, v238, v239
    v_mfma_f32_16x16x32_bf16 v[116:119], v[144:147], v[8:11], v[176:179]
    ds_read_b128 v[164:167], v187 offset:18688
    s_waitcnt lgkmcnt(4)
    v_mfma_f32_16x16x32_bf16 v[108:111], v[148:151], v[12:15], v[108:111]
    v_cvt_pk_bf16_f32 v126, v240, v241
    v_mfma_f32_16x16x32_bf16 v[112:115], v[148:151], v[16:19], v[112:115]
    v_mfma_f32_16x16x32_bf16 v[116:119], v[148:151], v[20:23], v[116:119]
    v_add_u32 v188, s77, v182
    v_add_u32 v189, s77, v183
    v_add_u32 v190, s77, v184
    v_add_u32 v191, s77, v185
    ds_read_b64_tr_b16 v[144:145], v188 offset:0
    ds_read_b64_tr_b16 v[146:147], v188 offset:6144
    s_waitcnt lgkmcnt(5)
    v_mfma_f32_16x16x32_bf16 v[108:111], v[152:155], v[24:27], v[108:111]
    v_cvt_pk_bf16_f32 v127, v242, v243
    v_mfma_f32_16x16x32_bf16 v[112:115], v[152:155], v[28:31], v[112:115]
    v_mfma_f32_16x16x32_bf16 v[116:119], v[152:155], v[32:35], v[116:119]
    v_cvt_pk_bf16_f32 v128, v244, v245
    ds_read_b64_tr_b16 v[148:149], v189 offset:0
    ds_read_b64_tr_b16 v[150:151], v189 offset:6144
    s_waitcnt lgkmcnt(6)
    v_mfma_f32_16x16x32_bf16 v[108:111], v[156:159], v[36:39], v[108:111]
    v_mfma_f32_16x16x32_bf16 v[112:115], v[156:159], v[40:43], v[112:115]
    v_cvt_pk_bf16_f32 v129, v246, v247
    v_mfma_f32_16x16x32_bf16 v[116:119], v[156:159], v[44:47], v[116:119]
    ds_read_b64_tr_b16 v[152:153], v190 offset:0
    ds_read_b64_tr_b16 v[154:155], v190 offset:6144
    s_waitcnt lgkmcnt(7)
    v_mfma_f32_16x16x32_bf16 v[108:111], v[160:163], v[48:51], v[108:111]
    v_mfma_f32_16x16x32_bf16 v[112:115], v[160:163], v[52:55], v[112:115]
    v_cvt_pk_bf16_f32 v130, v248, v249
    v_mfma_f32_16x16x32_bf16 v[116:119], v[160:163], v[56:59], v[116:119]
    ds_read_b64_tr_b16 v[156:157], v191 offset:0
    ds_read_b64_tr_b16 v[158:159], v191 offset:6144
    s_waitcnt lgkmcnt(8)
    v_mfma_f32_16x16x32_bf16 v[108:111], v[164:167], v[60:63], v[108:111]
    v_cvt_pk_bf16_f32 v131, v250, v251
    v_mfma_f32_16x16x32_bf16 v[112:115], v[164:167], v[64:67], v[112:115]
    v_mfma_f32_16x16x32_bf16 v[116:119], v[164:167], v[68:71], v[116:119]
    s_mov_b32 s72, 0
    s_mov_b32 s61, s77
    s_mov_b32 s60, 0
L_k1_aloop:
    s_waitcnt vmcnt(18)
    s_barrier
    s_add_u32 s77, s61, 24576
    s_cmp_eq_u32 s77, 147456
    s_cselect_b32 s77, 0, s77
    s_add_u32 s68, s61, 12288
    v_add_u32 v186, s68, v180
    v_add_u32 v187, s68, v181
    ds_read_b64_tr_b16 v[160:161], v188 offset:128
    ds_read_b64_tr_b16 v[162:163], v188 offset:6272
    s_waitcnt lgkmcnt(8)
    v_mfma_f32_16x16x32_bf16 a[0:3], v[144:147], v[120:123], a[0:3]
    v_exp_f32 v228, v96
    v_exp_f32 v229, v97
    v_mfma_f32_16x16x32_bf16 a[4:7], v[144:147], v[124:127], a[4:7]
    v_exp_f32 v230, v98
    v_exp_f32 v231, v99
    v_mfma_f32_16x16x32_bf16 a[8:11], v[144:147], v[128:131], a[8:11]
    v_exp_f32 v232, v108
    ds_read_b64_tr_b16 v[164:165], v189 offset:128
    ds_read_b64_tr_b16 v[166:167], v189 offset:6272
    s_waitcnt lgkmcnt(8)
    v_mfma_f32_16x16x32_bf16 a[12:15], v[148:151], v[120:123], a[12:15]
    v_exp_f32 v233, v109
    v_exp_f32 v234, v110
    v_mfma_f32_16x16x32_bf16 a[16:19], v[148:151], v[124:127], a[16:19]
    v_exp_f32 v235, v111
    v_mfma_f32_16x16x32_bf16 a[20:23], v[148:151], v[128:131], a[20:23]
    v_exp_f32 v236, v100
    v_exp_f32 v237, v101
    ds_read_b64_tr_b16 v[144:145], v190 offset:128
    ds_read_b64_tr_b16 v[146:147], v190 offset:6272
    s_waitcnt lgkmcnt(8)
    v_mfma_f32_16x16x32_bf16 a[24:27], v[152:155], v[120:123], a[24:27]
    v_exp_f32 v238, v102
    v_mfma_f32_16x16x32_bf16 a[28:31], v[152:155], v[124:127], a[28:31]
    v_exp_f32 v239, v103
    v_exp_f32 v240, v112
    v_mfma_f32_16x16x32_bf16 a[32:35], v[152:155], v[128:131], a[32:35]
    v_exp_f32 v241, v113
    ds_read_b64_tr_b16 v[148:149], v191 offset:128
    ds_read_b64_tr_b16 v[150:151], v191 offset:6272
    s_waitcnt lgkmcnt(8)
    v_mfma_f32_16x16x32_bf16 a[36:39], v[156:159], v[120:123], a[36:39]
    v_exp_f32 v242, v114
    v_exp_f32 v243, v115
    v_mfma_f32_16x16x32_bf16 a[40:43], v[156:159], v[124:127], a[40:43]
    v_exp_f32 v244, v104
    v_mfma_f32_16x16x32_bf16 a[44:47], v[156:159], v[128:131], a[44:47]
    v_exp_f32 v245, v105
    v_exp_f32 v246, v106
    ds_read_b64_tr_b16 v[152:153], v188 offset:256
    ds_read_b64_tr_b16 v[154:155], v188 offset:6400
    s_waitcnt lgkmcnt(8)
    v_mfma_f32_16x16x32_bf16 a[48:51], v[160:163], v[120:123], a[48:51]
    v_exp_f32 v247, v107
    v_mfma_f32_16x16x32_bf16 a[52:55], v[160:163], v[124:127], a[52:55]
    v_exp_f32 v248, v116
    v_exp_f32 v249, v117
    v_mfma_f32_16x16x32_bf16 a[56:59], v[160:163], v[128:131], a[56:59]
    v_exp_f32 v250, v118
    ds_read_b64_tr_b16 v[156:157], v189 offset:256
    ds_read_b64_tr_b16 v[158:159], v189 offset:6400
    s_waitcnt lgkmcnt(8)
    v_mfma_f32_16x16x32_bf16 a[60:63], v[164:167], v[120:123], a[60:63]
    v_exp_f32 v251, v119
    v_add_f32 v212, v228, v229
    v_mfma_f32_16x16x32_bf16 a[64:67], v[164:167], v[124:127], a[64:67]
    v_add_f32 v213, v236, v237
    v_mfma_f32_16x16x32_bf16 a[68:71], v[164:167], v[128:131], a[68:71]
    v_add_f32 v214, v244, v245
    v_add_f32 v212, v212, v230
    ds_read_b64_tr_b16 v[160:161], v190 offset:256
    ds_read_b64_tr_b16 v[162:163], v190 offset:6400
    s_waitcnt lgkmcnt(8)
    v_mfma_f32_16x16x32_bf16 a[72:75], v[144:147], v[120:123], a[72:75]
    v_add_f32 v213, v213, v238
    v_add_f32 v214, v214, v246
    v_mfma_f32_16x16x32_bf16 a[76:79], v[144:147], v[124:127], a[76:79]
    v_add_f32 v212, v212, v231
    v_mfma_f32_16x16x32_bf16 a[80:83], v[144:147], v[128:131], a[80:83]
    v_add_f32 v213, v213, v239
    v_add_f32 v214, v214, v247
    ds_read_b64_tr_b16 v[164:165], v191 offset:256
    ds_read_b64_tr_b16 v[166:167], v191 offset:6400
    s_waitcnt lgkmcnt(8)
    v_mfma_f32_16x16x32_bf16 a[84:87], v[148:151], v[120:123], a[84:87]
    v_add_f32 v212, v212, v232
    v_mfma_f32_16x16x32_bf16 a[88:91], v[148:151], v[124:127], a[88:91]
    v_add_f32 v213, v213, v240
    v_add_f32 v214, v214, v248
    v_mfma_f32_16x16x32_bf16 a[92:95], v[148:151], v[128:131], a[92:95]
    v_add_f32 v212, v212, v233
    ds_read_b128 v[144:147], v186 offset:0
    s_waitcnt lgkmcnt(7)
    v_mfma_f32_16x16x32_bf16 a[96:99], v[152:155], v[120:123], a[96:99]
    v_add_f32 v213, v213, v241
    v_add_f32 v214, v214, v249
    v_mfma_f32_16x16x32_bf16 a[100:103], v[152:155], v[124:127], a[100:103]
    v_add_f32 v212, v212, v234
    v_mfma_f32_16x16x32_bf16 a[104:107], v[152:155], v[128:131], a[104:107]
    v_add_f32 v213, v213, v242
    v_add_f32 v214, v214, v250
    ds_read_b128 v[148:151], v187 offset:0
    s_waitcnt lgkmcnt(6)
    v_mfma_f32_16x16x32_bf16 a[108:111], v[156:159], v[120:123], a[108:111]
    v_add_f32 v212, v212, v235
    v_mfma_f32_16x16x32_bf16 a[112:115], v[156:159], v[124:127], a[112:115]
    v_add_f32 v213, v213, v243
    v_add_f32 v214, v214, v251
    v_mfma_f32_16x16x32_bf16 a[116:119], v[156:159], v[128:131], a[116:119]
    v_cmp_gt_f32 s[80:81], v212, s71
    ds_read_b128 v[152:155], v186 offset:128
    s_waitcnt lgkmcnt(5)
    v_mfma_f32_16x16x32_bf16 a[120:123], v[160:163], v[120:123], a[120:123]
    v_cmp_gt_f32 s[82:83], v213, s71
    v_cmp_gt_f32 s[84:85], v214, s71
    v_mfma_f32_16x16x32_bf16 a[124:127], v[160:163], v[124:127], a[124:127]
    s_or_b64 s[80:81], s[80:81], s[82:83]
    v_mfma_f32_16x16x32_bf16 a[128:131], v[160:163], v[128:131], a[128:131]
    s_or_b64 s[80:81], s[80:81], s[84:85]
    s_cbranch_scc1 L_k1_sm_2_slow
L_k1_sm_2_ret:
    ds_read_b128 v[156:159], v187 offset:128
    s_waitcnt lgkmcnt(4)
    v_mfma_f32_16x16x32_bf16 a[132:135], v[164:167], v[120:123], a[132:135]
    v_mfma_f32_16x16x32_bf16 a[136:139], v[164:167], v[124:127], a[136:139]
    v_mfma_f32_16x16x32_bf16 a[140:143], v[164:167], v[128:131], a[140:143]
    ds_read_b128 v[160:163], v186 offset:256
    s_waitcnt lgkmcnt(4)
    v_mfma_f32_16x16x32_bf16 v[72:75], v[144:147], v[0:3], v[168:171]
    s_add_u32 m0, s79, 0
    s_nop 0
    v_mfma_f32_16x16x32_bf16 v[76:79], v[144:147], v[4:7], v[172:175]
    buffer_load_dwordx4 v197, s[52:55], s66 offen nt lds
    v_mfma_f32_16x16x32_bf16 v[80:83], v[144:147], v[8:11], v[176:179]
    s_add_u32 m0, s79, 1024
    ds_read_b128 v[164:167], v187 offset:256
    s_waitcnt lgkmcnt(4)
    v_mfma_f32_16x16x32_bf16 v[72:75], v[148:151], v[12:15], v[72:75]
    s_nop 0
    v_mfma_f32_16x16x32_bf16 v[76:79], v[148:151], v[16:19], v[76:79]
    buffer_load_dwordx4 v198, s[52:55], s66 offen nt lds
    v_mfma_f32_16x16x32_bf16 v[80:83], v[148:151], v[20:23], v[80:83]
    s_add_u32 m0, s79, 2048
    ds_read_b128 v[144:147], v186 offset:6144
    s_waitcnt lgkmcnt(4)
    v_mfma_f32_16x16x32_bf16 v[72:75], v[152:155], v[24:27], v[72:75]
    s_nop 0
    v_mfma_f32_16x16x32_bf16 v[76:79], v[152:155], v[28:31], v[76:79]
    buffer_load_dwordx4 v199, s[52:55], s66 offen nt lds
    v_mfma_f32_16x16x32_bf16 v[80:83], v[152:155], v[32:35], v[80:83]
    s_add_u32 m0, s79, 12288
    ds_read_b128 v[148:151], v187 offset:6144
    s_waitcnt lgkmcnt(4)
    v_mfma_f32_16x16x32_bf16 v[72:75], v[156:159], v[36:39], v[72:75]
    s_nop 0
    v_mfma_f32_16x16x32_bf16 v[76:79], v[156:159], v[40:43], v[76:79]
    buffer_load_dwordx4 v197, s[48:51], s65 offen nt lds
    v_mfma_f32_16x16x32_bf16 v[80:83], v[156:159], v[44:47], v[80:83]
    s_add_u32 m0, s79, 13312
    ds_read_b128 v[152:155], v186 offset:6272
    s_waitcnt lgkmcnt(4)
    v_mfma_f32_16x16x32_bf16 v[72:75], v[160:163], v[48:51], v[72:75]
    s_nop 0
    v_mfma_f32_16x16x32_bf16 v[76:79], v[160:163], v[52:55], v[76:79]
    buffer_load_dwordx4 v198, s[48:51], s65 offen nt lds
    v_mfma_f32_16x16x32_bf16 v[80:83], v[160:163], v[56:59], v[80:83]
    s_add_u32 m0, s79, 14336
    ds_read_b128 v[156:159], v187 offset:6272
    s_waitcnt lgkmcnt(4)
    v_mfma_f32_16x16x32_bf16 v[72:75], v[164:167], v[60:63], v[72:75]
    s_nop 0
    v_mfma_f32_16x16x32_bf16 v[76:79], v[164:167], v[64:67], v[76:79]
    buffer_load_dwordx4 v199, s[48:51], s65 offen nt lds
    v_mfma_f32_16x16x32_bf16 v[80:83], v[164:167], v[68:71], v[80:83]
    s_add_u32 s66, s66, 12288
    ds_read_b128 v[160:163], v186 offset:6400
    s_waitcnt lgkmcnt(4)
    v_mfma_f32_16x16x32_bf16 v[84:87], v[144:147], v[0:3], v[168:171]
    s_add_u32 s65, s65, 12288
    s_add_u32 s79, s79, 24576
    v_mfma_f32_16x16x32_bf16 v[88:91], v[144:147], v[4:7], v[172:175]
    s_cmp_ge_u32 s79, 147456
    v_mfma_f32_16x16x32_bf16 v[92:95], v[144:147], v[8:11], v[176:179]
    s_cselect_b32 s79, s67, s79
    ds_read_b128 v[164:167], v187 offset:6400
    s_waitcnt lgkmcnt(4)
    v_mfma_f32_16x16x32_bf16 v[84:87], v[148:151], v[12:15], v[84:87]
    v_add_f32 v206, v206, v212
    v_mfma_f32_16x16x32_bf16 v[88:91], v[148:151], v[16:19], v[88:91]
    v_add_f32 v207, v207, v213
    v_mfma_f32_16x16x32_bf16 v[92:95], v[148:151], v[20:23], v[92:95]
    v_add_f32 v208, v208, v214
    v_add_u32 v188, s77, v182
    v_add_u32 v189, s77, v183
    v_add_u32 v190, s77, v184
    v_add_u32 v191, s77, v185
    ds_read_b64_tr_b16 v[144:145], v188 offset:0
    ds_read_b64_tr_b16 v[146:147], v188 offset:6144
    s_waitcnt lgkmcnt(5)
    v_mfma_f32_16x16x32_bf16 v[84:87], v[152:155], v[24:27], v[84:87]
    v_cvt_pk_bf16_f32 v132, v228, v229
    v_mfma_f32_16x16x32_bf16 v[88:91], v[152:155], v[28:31], v[88:91]
    v_cvt_pk_bf16_f32 v133, v230, v231
    v_mfma_f32_16x16x32_bf16 v[92:95], v[152:155], v[32:35], v[92:95]
    v_cvt_pk_bf16_f32 v134, v232, v233
    ds_read_b64_tr_b16 v[148:149], v189 offset:0
    ds_read_b64_tr_b16 v[150:151], v189 offset:6144
    s_waitcnt lgkmcnt(6)
    v_mfma_f32_16x16x32_bf16 v[84:87], v[156:159], v[36:39], v[84:87]
    v_cvt_pk_bf16_f32 v135, v234, v235
    v_mfma_f32_16x16x32_bf16 v[88:91], v[156:159], v[40:43], v[88:91]
    v_cvt_pk_bf16_f32 v136, v236, v237
    v_mfma_f32_16x16x32_bf16 v[92:95], v[156:159], v[44:47], v[92:95]
    v_cvt_pk_bf16_f32 v137, v238, v239
    ds_read_b64_tr_b16 v[152:153], v190 offset:0
    ds_read_b64_tr_b16 v[154:155], v190 offset:6144
    s_waitcnt lgkmcnt(7)
    v_mfma_f32_16x16x32_bf16 v[84:87], v[160:163], v[48:51], v[84:87]
    v_cvt_pk_bf16_f32 v138, v240, v241
    v_mfma_f32_16x16x32_bf16 v[88:91], v[160:163], v[52:55], v[88:91]
    v_cvt_pk_bf16_f32 v139, v242, v243
    v_mfma_f32_16x16x32_bf16 v[92:95], v[160:163], v[56:59], v[92:95]
    v_cvt_pk_bf16_f32 v140, v244, v245
    ds_read_b64_tr_b16 v[156:157], v191 offset:0
    ds_read_b64_tr_b16 v[158:159], v191 offset:6144
    s_waitcnt lgkmcnt(8)
    v_mfma_f32_16x16x32_bf16 v[84:87], v[164:167], v[60:63], v[84:87]
    v_cvt_pk_bf16_f32 v141, v246, v247
    v_mfma_f32_16x16x32_bf16 v[88:91], v[164:167], v[64:67], v[88:91]
    v_cvt_pk_bf16_f32 v142, v248, v249
    v_mfma_f32_16x16x32_bf16 v[92:95], v[164:167], v[68:71], v[92:95]
    v_cvt_pk_bf16_f32 v143, v250, v251
    s_cmp_eq_u32 s72, 0
    s_cbranch_scc1 L_k1_rs_3_skip
    s_nop 7
    v_accvgpr_read_b32 v212, a0
    v_accvgpr_read_b32 v213, a1
    v_accvgpr_read_b32 v214, a2
    v_accvgpr_read_b32 v215, a3
    v_accvgpr_read_b32 v216, a4
    v_accvgpr_read_b32 v217, a5
    v_accvgpr_read_b32 v218, a6
    v_accvgpr_read_b32 v219, a7
    v_mul_f32 v212, v212, v209
    v_mul_f32 v213, v213, v209
    v_mul_f32 v214, v214, v209
    v_mul_f32 v215, v215, v209
    v_mul_f32 v216, v216, v210
    v_mul_f32 v217, v217, v210
    v_mul_f32 v218, v218, v210
    v_mul_f32 v219, v219, v210
    v_accvgpr_write_b32 a0, v212
    v_accvgpr_write_b32 a1, v213
    v_accvgpr_write_b32 a2, v214
    v_accvgpr_write_b32 a3, v215
    v_accvgpr_write_b32 a4, v216
    v_accvgpr_write_b32 a5, v217
    v_accvgpr_write_b32 a6, v218
    v_accvgpr_write_b32 a7, v219
    v_accvgpr_read_b32 v212, a8
    v_accvgpr_read_b32 v213, a9
    v_accvgpr_read_b32 v214, a10
    v_accvgpr_read_b32 v215, a11
    v_accvgpr_read_b32 v216, a12
    v_accvgpr_read_b32 v217, a13
    v_accvgpr_read_b32 v218, a14
    v_accvgpr_read_b32 v219, a15
    v_mul_f32 v212, v212, v211
    v_mul_f32 v213, v213, v211
    v_mul_f32 v214, v214, v211
    v_mul_f32 v215, v215, v211
    v_mul_f32 v216, v216, v209
    v_mul_f32 v217, v217, v209
    v_mul_f32 v218, v218, v209
    v_mul_f32 v219, v219, v209
    v_accvgpr_write_b32 a8, v212
    v_accvgpr_write_b32 a9, v213
    v_accvgpr_write_b32 a10, v214
    v_accvgpr_write_b32 a11, v215
    v_accvgpr_write_b32 a12, v216
    v_accvgpr_write_b32 a13, v217
    v_accvgpr_write_b32 a14, v218
    v_accvgpr_write_b32 a15, v219
    v_accvgpr_read_b32 v212, a16
    v_accvgpr_read_b32 v213, a17
    v_accvgpr_read_b32 v214, a18
    v_accvgpr_read_b32 v215, a19
    v_accvgpr_read_b32 v216, a20
    v_accvgpr_read_b32 v217, a21
    v_accvgpr_read_b32 v218, a22
    v_accvgpr_read_b32 v219, a23
    v_mul_f32 v212, v212, v210
    v_mul_f32 v213, v213, v210
    v_mul_f32 v214, v214, v210
    v_mul_f32 v215, v215, v210
    v_mul_f32 v216, v216, v211
    v_mul_f32 v217, v217, v211
    v_mul_f32 v218, v218, v211
    v_mul_f32 v219, v219, v211
    v_accvgpr_write_b32 a16, v212
    v_accvgpr_write_b32 a17, v213
    v_accvgpr_write_b32 a18, v214
    v_accvgpr_write_b32 a19, v215
    v_accvgpr_write_b32 a20, v216
    v_accvgpr_write_b32 a21, v217
    v_accvgpr_write_b32 a22, v218
    v_accvgpr_write_b32 a23, v219
    v_accvgpr_read_b32 v212, a24
    v_accvgpr_read_b32 v213, a25
    v_accvgpr_read_b32 v214, a26
    v_accvgpr_read_b32 v215, a27
    v_accvgpr_read_b32 v216, a28
    v_accvgpr_read_b32 v217, a29
    v_accvgpr_read_b32 v218, a30
    v_accvgpr_read_b32 v219, a31
    v_mul_f32 v212, v212, v209
    v_mul_f32 v213, v213, v209
    v_mul_f32 v214, v214, v209
    v_mul_f32 v215, v215, v209
    v_mul_f32 v216, v216, v210
    v_mul_f32 v217, v217, v210
    v_mul_f32 v218, v218, v210
    v_mul_f32 v219, v219, v210
    v_accvgpr_write_b32 a24, v212
    v_accvgpr_write_b32 a25, v213
    v_accvgpr_write_b32 a26, v214
    v_accvgpr_write_b32 a27, v215
    v_accvgpr_write_b32 a28, v216
    v_accvgpr_write_b32 a29, v217
    v_accvgpr_write_b32 a30, v218
    v_accvgpr_write_b32 a31, v219
    v_accvgpr_read_b32 v212, a32
    v_accvgpr_read_b32 v213, a33
    v_accvgpr_read_b32 v214, a34
    v_accvgpr_read_b32 v215, a35
    v_accvgpr_read_b32 v216, a36
    v_accvgpr_read_b32 v217, a37
    v_accvgpr_read_b32 v218, a38
    v_accvgpr_read_b32 v219, a39
    v_mul_f32 v212, v212, v211
    v_mul_f32 v213, v213, v211
    v_mul_f32 v214, v214, v211
    v_mul_f32 v215, v215, v211
    v_mul_f32 v216, v216, v209
    v_mul_f32 v217, v217, v209
    v_mul_f32 v218, v218, v209
    v_mul_f32 v219, v219, v209
    v_accvgpr_write_b32 a32, v212
    v_accvgpr_write_b32 a33, v213
    v_accvgpr_write_b32 a34, v214
    v_accvgpr_write_b32 a35, v215
    v_accvgpr_write_b32 a36, v216
    v_accvgpr_write_b32 a37, v217
    v_accvgpr_write_b32 a38, v218
    v_accvgpr_write_b32 a39, v219
    v_accvgpr_read_b32 v212, a40
    v_accvgpr_read_b32 v213, a41
    v_accvgpr_read_b32 v214, a42
    v_accvgpr_read_b32 v215, a43
    v_accvgpr_read_b32 v216, a44
    v_accvgpr_read_b32 v217, a45
    v_accvgpr_read_b32 v218, a46
    v_accvgpr_read_b32 v219, a47
    v_mul_f32 v212, v212, v210
    v_mul_f32 v213, v213, v210
    v_mul_f32 v214, v214, v210
    v_mul_f32 v215, v215, v210
    v_mul_f32 v216, v216, v211
    v_mul_f32 v217, v217, v211
    v_mul_f32 v218, v218, v211
    v_mul_f32 v219, v219, v211
    v_accvgpr_write_b32 a40, v212
    v_accvgpr_write_b32 a41, v213
    v_accvgpr_write_b32 a42, v214
    v_accvgpr_write_b32 a43, v215
    v_accvgpr_write_b32 a44, v216
    v_accvgpr_write_b32 a45, v217
    v_accvgpr_write_b32 a46, v218
    v_accvgpr_write_b32 a47, v219
    v_accvgpr_read_b32 v212, a48
    v_accvgpr_read_b32 v213, a49
    v_accvgpr_read_b32 v214, a50
    v_accvgpr_read_b32 v215, a51
    v_accvgpr_read_b32 v216, a52
    v_accvgpr_read_b32 v217, a53
    v_accvgpr_read_b32 v218, a54
    v_accvgpr_read_b32 v219, a55
    v_mul_f32 v212, v212, v209
    v_mul_f32 v213, v213, v209
    v_mul_f32 v214, v214, v209
    v_mul_f32 v215, v215, v209
    v_mul_f32 v216, v216, v210
    v_mul_f32 v217, v217, v210
    v_mul_f32 v218, v218, v210
    v_mul_f32 v219, v219, v210
    v_accvgpr_write_b32 a48, v212
    v_accvgpr_write_b32 a49, v213
    v_accvgpr_write_b32 a50, v214
    v_accvgpr_write_b32 a51, v215
    v_accvgpr_write_b32 a52, v216
    v_accvgpr_write_b32 a53, v217
    v_accvgpr_write_b32 a54, v218
    v_accvgpr_write_b32 a55, v219
    v_accvgpr_read_b32 v212, a56
    v_accvgpr_read_b32 v213, a57
    v_accvgpr_read_b32 v214, a58
    v_accvgpr_read_b32 v215, a59
    v_accvgpr_read_b32 v216, a60
    v_accvgpr_read_b32 v217, a61
    v_accvgpr_read_b32 v218, a62
    v_accvgpr_read_b32 v219, a63
    v_mul_f32 v212, v212, v211
    v_mul_f32 v213, v213, v211
    v_mul_f32 v214, v214, v211
    v_mul_f32 v215, v215, v211
    v_mul_f32 v216, v216, v209
    v_mul_f32 v217, v217, v209
    v_mul_f32 v218, v218, v209
    v_mul_f32 v219, v219, v209
    v_accvgpr_write_b32 a56, v212
    v_accvgpr_write_b32 a57, v213
    v_accvgpr_write_b32 a58, v214
    v_accvgpr_write_b32 a59, v215
    v_accvgpr_write_b32 a60, v216
    v_accvgpr_write_b32 a61, v217
    v_accvgpr_write_b32 a62, v218
    v_accvgpr_write_b32 a63, v219
    v_accvgpr_read_b32 v212, a64
    v_accvgpr_read_b32 v213, a65
    v_accvgpr_read_b32 v214, a66
    v_accvgpr_read_b32 v215, a67
    v_accvgpr_read_b32 v216, a68
    v_accvgpr_read_b32 v217, a69
    v_accvgpr_read_b32 v218, a70
    v_accvgpr_read_b32 v219, a71
    v_mul_f32 v212, v212, v210
    v_mul_f32 v213, v213, v210
    v_mul_f32 v214, v214, v210
    v_mul_f32 v215, v215, v210
    v_mul_f32 v216, v216, v211
    v_mul_f32 v217, v217, v211
    v_mul_f32 v218, v218, v211
    v_mul_f32 v219, v219, v211
    v_accvgpr_write_b32 a64, v212
    v_accvgpr_write_b32 a65, v213
    v_accvgpr_write_b32 a66, v214
    v_accvgpr_write_b32 a67, v215
    v_accvgpr_write_b32 a68, v216
    v_accvgpr_write_b32 a69, v217
    v_accvgpr_write_b32 a70, v218
    v_accvgpr_write_b32 a71, v219
    v_accvgpr_read_b32 v212, a72
    v_accvgpr_read_b32 v213, a73
    v_accvgpr_read_b32 v214, a74
    v_accvgpr_read_b32 v215, a75
    v_accvgpr_read_b32 v216, a76
    v_accvgpr_read_b32 v217, a77
    v_accvgpr_read_b32 v218, a78
    v_accvgpr_read_b32 v219, a79
    v_mul_f32 v212, v212, v209
    v_mul_f32 v213, v213, v209
    v_mul_f32 v214, v214, v209
    v_mul_f32 v215, v215, v209
    v_mul_f32 v216, v216, v210
    v_mul_f32 v217, v217, v210
    v_mul_f32 v218, v218, v210
    v_mul_f32 v219, v219, v210
    v_accvgpr_write_b32 a72, v212
    v_accvgpr_write_b32 a73, v213
    v_accvgpr_write_b32 a74, v214
    v_accvgpr_write_b32 a75, v215
    v_accvgpr_write_b32 a76, v216
    v_accvgpr_write_b32 a77, v217
    v_accvgpr_write_b32 a78, v218
    v_accvgpr_write_b32 a79, v219
    v_accvgpr_read_b32 v212, a80
    v_accvgpr_read_b32 v213, a81
    v_accvgpr_read_b32 v214, a82
    v_accvgpr_read_b32 v215, a83
    v_accvgpr_read_b32 v216, a84
    v_accvgpr_read_b32 v217, a85
    v_accvgpr_read_b32 v218, a86
    v_accvgpr_read_b32 v219, a87
    v_mul_f32 v212, v212, v211
    v_mul_f32 v213, v213, v211
    v_mul_f32 v214, v214, v211
    v_mul_f32 v215, v215, v211
    v_mul_f32 v216, v216, v209
    v_mul_f32 v217, v217, v209
    v_mul_f32 v218, v218, v209
    v_mul_f32 v219, v219, v209
    v_accvgpr_write_b32 a80, v212
    v_accvgpr_write_b32 a81, v213
    v_accvgpr_write_b32 a82, v214
    v_accvgpr_write_b32 a83, v215
    v_accvgpr_write_b32 a84, v216
    v_accvgpr_write_b32 a85, v217
    v_accvgpr_write_b32 a86, v218
    v_accvgpr_write_b32 a87, v219
    v_accvgpr_read_b32 v212, a88
    v_accvgpr_read_b32 v213, a89
    v_accvgpr_read_b32 v214, a90
    v_accvgpr_read_b32 v215, a91
    v_accvgpr_read_b32 v216, a92
    v_accvgpr_read_b32 v217, a93
    v_accvgpr_read_b32 v218, a94
    v_accvgpr_read_b32 v219, a95
    v_mul_f32 v212, v212, v210
    v_mul_f32 v213, v213, v210
    v_mul_f32 v214, v214, v210
    v_mul_f32 v215, v215, v210
    v_mul_f32 v216, v216, v211
    v_mul_f32 v217, v217, v211
    v_mul_f32 v218, v218, v211
    v_mul_f32 v219, v219, v211
    v_accvgpr_write_b32 a88, v212
    v_accvgpr_write_b32 a89, v213
    v_accvgpr_write_b32 a90, v214
    v_accvgpr_write_b32 a91, v215
    v_accvgpr_write_b32 a92, v216
    v_accvgpr_write_b32 a93, v217
    v_accvgpr_write_b32 a94, v218
    v_accvgpr_write_b32 a95, v219
    v_accvgpr_read_b32 v212, a96
    v_accvgpr_read_b32 v213, a97
    v_accvgpr_read_b32 v214, a98
    v_accvgpr_read_b32 v215, a99
    v_accvgpr_read_b32 v216, a100
    v_accvgpr_read_b32 v217, a101
    v_accvgpr_read_b32 v218, a102
    v_accvgpr_read_b32 v219, a103
    v_mul_f32 v212, v212, v209
    v_mul_f32 v213, v213, v209
    v_mul_f32 v214, v214, v209
    v_mul_f32 v215, v215, v209
    v_mul_f32 v216, v216, v210
    v_mul_f32 v217, v217, v210
    v_mul_f32 v218, v218, v210
    v_mul_f32 v219, v219, v210
    v_accvgpr_write_b32 a96, v212
    v_accvgpr_write_b32 a97, v213
    v_accvgpr_write_b32 a98, v214
    v_accvgpr_write_b32 a99, v215
    v_accvgpr_write_b32 a100, v216
    v_accvgpr_write_b32 a101, v217
    v_accvgpr_write_b32 a102, v218
    v_accvgpr_write_b32 a103, v219
    v_accvgpr_read_b32 v212, a104
    v_accvgpr_read_b32 v213, a105
    v_accvgpr_read_b32 v214, a106
    v_accvgpr_read_b32 v215, a107
    v_accvgpr_read_b32 v216, a108
    v_accvgpr_read_b32 v217, a109
    v_accvgpr_read_b32 v218, a110
    v_accvgpr_read_b32 v219, a111
    v_mul_f32 v212, v212, v211
    v_mul_f32 v213, v213, v211
    v_mul_f32 v214, v214, v211
    v_mul_f32 v215, v215, v211
    v_mul_f32 v216, v216, v209
    v_mul_f32 v217, v217, v209
    v_mul_f32 v218, v218, v209
    v_mul_f32 v219, v219, v209
    v_accvgpr_write_b32 a104, v212
    v_accvgpr_write_b32 a105, v213
    v_accvgpr_write_b32 a106, v214
    v_accvgpr_write_b32 a107, v215
    v_accvgpr_write_b32 a108, v216
    v_accvgpr_write_b32 a109, v217
    v_accvgpr_write_b32 a110, v218
    v_accvgpr_write_b32 a111, v219
    v_accvgpr_read_b32 v212, a112
    v_accvgpr_read_b32 v213, a113
    v_accvgpr_read_b32 v214, a114
    v_accvgpr_read_b32 v215, a115
    v_accvgpr_read_b32 v216, a116
    v_accvgpr_read_b32 v217, a117
    v_accvgpr_read_b32 v218, a118
    v_accvgpr_read_b32 v219, a119
    v_mul_f32 v212, v212, v210
    v_mul_f32 v213, v213, v210
    v_mul_f32 v214, v214, v210
    v_mul_f32 v215, v215, v210
    v_mul_f32 v216, v216, v211
    v_mul_f32 v217, v217, v211
    v_mul_f32 v218, v218, v211
    v_mul_f32 v219, v219, v211
    v_accvgpr_write_b32 a112, v212
    v_accvgpr_write_b32 a113, v213
    v_accvgpr_write_b32 a114, v214
    v_accvgpr_write_b32 a115, v215
    v_accvgpr_write_b32 a116, v216
    v_accvgpr_write_b32 a117, v217
    v_accvgpr_write_b32 a118, v218
    v_accvgpr_write_b32 a119, v219
    v_accvgpr_read_b32 v212, a120
    v_accvgpr_read_b32 v213, a121
    v_accvgpr_read_b32 v214, a122
    v_accvgpr_read_b32 v215, a123
    v_accvgpr_read_b32 v216, a124
    v_accvgpr_read_b32 v217, a125
    v_accvgpr_read_b32 v218, a126
    v_accvgpr_read_b32 v219, a127
    v_mul_f32 v212, v212, v209
    v_mul_f32 v213, v213, v209
    v_mul_f32 v214, v214, v209
    v_mul_f32 v215, v215, v209
    v_mul_f32 v216, v216, v210
    v_mul_f32 v217, v217, v210
    v_mul_f32 v218, v218, v210
    v_mul_f32 v219, v219, v210
    v_accvgpr_write_b32 a120, v212
    v_accvgpr_write_b32 a121, v213
    v_accvgpr_write_b32 a122, v214
    v_accvgpr_write_b32 a123, v215
    v_accvgpr_write_b32 a124, v216
    v_accvgpr_write_b32 a125, v217
    v_accvgpr_write_b32 a126, v218
    v_accvgpr_write_b32 a127, v219
    v_accvgpr_read_b32 v212, a128
    v_accvgpr_read_b32 v213, a129
    v_accvgpr_read_b32 v214, a130
    v_accvgpr_read_b32 v215, a131
    v_accvgpr_read_b32 v216, a132
    v_accvgpr_read_b32 v217, a133
    v_accvgpr_read_b32 v218, a134
    v_accvgpr_read_b32 v219, a135
    v_mul_f32 v212, v212, v211
    v_mul_f32 v213, v213, v211
    v_mul_f32 v214, v214, v211
    v_mul_f32 v215, v215, v211
    v_mul_f32 v216, v216, v209
    v_mul_f32 v217, v217, v209
    v_mul_f32 v218, v218, v209
    v_mul_f32 v219, v219, v209
    v_accvgpr_write_b32 a128, v212
    v_accvgpr_write_b32 a129, v213
    v_accvgpr_write_b32 a130, v214
    v_accvgpr_write_b32 a131, v215
    v_accvgpr_write_b32 a132, v216
    v_accvgpr_write_b32 a133, v217
    v_accvgpr_write_b32 a134, v218
    v_accvgpr_write_b32 a135, v219
    v_accvgpr_read_b32 v212, a136
    v_accvgpr_read_b32 v213, a137
    v_accvgpr_read_b32 v214, a138
    v_accvgpr_read_b32 v215, a139
    v_accvgpr_read_b32 v216, a140
    v_accvgpr_read_b32 v217, a141
    v_accvgpr_read_b32 v218, a142
    v_accvgpr_read_b32 v219, a143
    v_mul_f32 v212, v212, v210
    v_mul_f32 v213, v213, v210
    v_mul_f32 v214, v214, v210
    v_mul_f32 v215, v215, v210
    v_mul_f32 v216, v216, v211
    v_mul_f32 v217, v217, v211
    v_mul_f32 v218, v218, v211
    v_mul_f32 v219, v219, v211
    v_accvgpr_write_b32 a136, v212
    v_accvgpr_write_b32 a137, v213
    v_accvgpr_write_b32 a138, v214
    v_accvgpr_write_b32 a139, v215
    v_accvgpr_write_b32 a140, v216
    v_accvgpr_write_b32 a141, v217
    v_accvgpr_write_b32 a142, v218
    v_accvgpr_write_b32 a143, v219
    s_mov_b32 s72, 0
    s_nop 1
L_k1_rs_3_skip:
    s_mov_b32 s61, s77
    s_waitcnt vmcnt(18)
    s_barrier
    s_add_u32 s77, s61, 24576
    s_cmp_eq_u32 s77, 147456
    s_cselect_b32 s77, 0, s77
    s_add_u32 s68, s61, 12288
    v_add_u32 v186, s68, v180
    v_add_u32 v187, s68, v181
    ds_read_b64_tr_b16 v[160:161], v188 offset:128
    ds_read_b64_tr_b16 v[162:163], v188 offset:6272
    s_waitcnt lgkmcnt(8)
    v_mfma_f32_16x16x32_bf16 a[0:3], v[144:147], v[132:135], a[0:3]
    v_exp_f32 v228, v72
    v_exp_f32 v229, v73
    v_mfma_f32_16x16x32_bf16 a[4:7], v[144:147], v[136:139], a[4:7]
    v_exp_f32 v230, v74
    v_exp_f32 v231, v75
    v_mfma_f32_16x16x32_bf16 a[8:11], v[144:147], v[140:143], a[8:11]
    v_exp_f32 v232, v84
    ds_read_b64_tr_b16 v[164:165], v189 offset:128
    ds_read_b64_tr_b16 v[166:167], v189 offset:6272
    s_waitcnt lgkmcnt(8)
    v_mfma_f32_16x16x32_bf16 a[12:15], v[148:151], v[132:135], a[12:15]
    v_exp_f32 v233, v85
    v_exp_f32 v234, v86
    v_mfma_f32_16x16x32_bf16 a[16:19], v[148:151], v[136:139], a[16:19]
    v_exp_f32 v235, v87
    v_mfma_f32_16x16x32_bf16 a[20:23], v[148:151], v[140:143], a[20:23]
    v_exp_f32 v236, v76
    v_exp_f32 v237, v77
    ds_read_b64_tr_b16 v[144:145], v190 offset:128
    ds_read_b64_tr_b16 v[146:147], v190 offset:6272
    s_waitcnt lgkmcnt(8)
    v_mfma_f32_16x16x32_bf16 a[24:27], v[152:155], v[132:135], a[24:27]
    v_exp_f32 v238, v78
    v_mfma_f32_16x16x32_bf16 a[28:31], v[152:155], v[136:139], a[28:31]
    v_exp_f32 v239, v79
    v_exp_f32 v240, v88
    v_mfma_f32_16x16x32_bf16 a[32:35], v[152:155], v[140:143], a[32:35]
    v_exp_f32 v241, v89
    ds_read_b64_tr_b16 v[148:149], v191 offset:128
    ds_read_b64_tr_b16 v[150:151], v191 offset:6272
    s_waitcnt lgkmcnt(8)
    v_mfma_f32_16x16x32_bf16 a[36:39], v[156:159], v[132:135], a[36:39]
    v_exp_f32 v242, v90
    v_exp_f32 v243, v91
    v_mfma_f32_16x16x32_bf16 a[40:43], v[156:159], v[136:139], a[40:43]
    v_exp_f32 v244, v80
    v_mfma_f32_16x16x32_bf16 a[44:47], v[156:159], v[140:143], a[44:47]
    v_exp_f32 v245, v81
    v_exp_f32 v246, v82
    ds_read_b64_tr_b16 v[152:153], v188 offset:256
    ds_read_b64_tr_b16 v[154:155], v188 offset:6400
    s_waitcnt lgkmcnt(8)
    v_mfma_f32_16x16x32_bf16 a[48:51], v[160:163], v[132:135], a[48:51]
    v_exp_f32 v247, v83
    v_mfma_f32_16x16x32_bf16 a[52:55], v[160:163], v[136:139], a[52:55]
    v_exp_f32 v248, v92
    v_exp_f32 v249, v93
    v_mfma_f32_16x16x32_bf16 a[56:59], v[160:163], v[140:143], a[56:59]
    v_exp_f32 v250, v94
    ds_read_b64_tr_b16 v[156:157], v189 offset:256
    ds_read_b64_tr_b16 v[158:159], v189 offset:6400
    s_waitcnt lgkmcnt(8)
    v_mfma_f32_16x16x32_bf16 a[60:63], v[164:167], v[132:135], a[60:63]
    v_exp_f32 v251, v95
    v_add_f32 v212, v228, v229
    v_mfma_f32_16x16x32_bf16 a[64:67], v[164:167], v[136:139], a[64:67]
    v_add_f32 v213, v236, v237
    v_mfma_f32_16x16x32_bf16 a[68:71], v[164:167], v[140:143], a[68:71]
    v_add_f32 v214, v244, v245
    v_add_f32 v212, v212, v230
    ds_read_b64_tr_b16 v[160:161], v190 offset:256
    ds_read_b64_tr_b16 v[162:163], v190 offset:6400
    s_waitcnt lgkmcnt(8)
    v_mfma_f32_16x16x32_bf16 a[72:75], v[144:147], v[132:135], a[72:75]
    v_add_f32 v213, v213, v238
    v_add_f32 v214, v214, v246
    v_mfma_f32_16x16x32_bf16 a[76:79], v[144:147], v[136:139], a[76:79]
    v_add_f32 v212, v212, v231
    v_mfma_f32_16x16x32_bf16 a[80:83], v[144:147], v[140:143], a[80:83]
    v_add_f32 v213, v213, v239
    v_add_f32 v214, v214, v247
    ds_read_b64_tr_b16 v[164:165], v191 offset:256
    ds_read_b64_tr_b16 v[166:167], v191 offset:6400
    s_waitcnt lgkmcnt(8)
    v_mfma_f32_16x16x32_bf16 a[84:87], v[148:151], v[132:135], a[84:87]
    v_add_f32 v212, v212, v232
    v_mfma_f32_16x16x32_bf16 a[88:91], v[148:151], v[136:139], a[88:91]
    v_add_f32 v213, v213, v240
    v_add_f32 v214, v214, v248
    v_mfma_f32_16x16x32_bf16 a[92:95], v[148:151], v[140:143], a[92:95]
    v_add_f32 v212, v212, v233
    ds_read_b128 v[144:147], v186 offset:0
    s_waitcnt lgkmcnt(7)
    v_mfma_f32_16x16x32_bf16 a[96:99], v[152:155], v[132:135], a[96:99]
    v_add_f32 v213, v213, v241
    v_add_f32 v214, v214, v249
    v_mfma_f32_16x16x32_bf16 a[100:103], v[152:155], v[136:139], a[100:103]
    v_add_f32 v212, v212, v234
    v_mfma_f32_16x16x32_bf16 a[104:107], v[152:155], v[140:143], a[104:107]
    v_add_f32 v213, v213, v242
    v_add_f32 v214, v214, v250
    ds_read_b128 v[148:151], v187 offset:0
    s_waitcnt lgkmcnt(6)
    v_mfma_f32_16x16x32_bf16 a[108:111], v[156:159], v[132:135], a[108:111]
    v_add_f32 v212, v212, v235
    v_mfma_f32_16x16x32_bf16 a[112:115], v[156:159], v[136:139], a[112:115]
    v_add_f32 v213, v213, v243
    v_add_f32 v214, v214, v251
    v_mfma_f32_16x16x32_bf16 a[116:119], v[156:159], v[140:143], a[116:119]
    v_cmp_gt_f32 s[80:81], v212, s71
    ds_read_b128 v[152:155], v186 offset:128
    s_waitcnt lgkmcnt(5)
    v_mfma_f32_16x16x32_bf16 a[120:123], v[160:163], v[132:135], a[120:123]
    v_cmp_gt_f32 s[82:83], v213, s71
    v_cmp_gt_f32 s[84:85], v214, s71
    v_mfma_f32_16x16x32_bf16 a[124:127], v[160:163], v[136:139], a[124:127]
    s_or_b64 s[80:81], s[80:81], s[82:83]
    v_mfma_f32_16x16x32_bf16 a[128:131], v[160:163], v[140:143], a[128:131]
    s_or_b64 s[80:81], s[80:81], s[84:85]
    s_cbranch_scc1 L_k1_sm_4_slow
L_k1_sm_4_ret:
    ds_read_b128 v[156:159], v187 offset:128
    s_waitcnt lgkmcnt(4)
    v_mfma_f32_16x16x32_bf16 a[132:135], v[164:167], v[132:135], a[132:135]
    v_mfma_f32_16x16x32_bf16 a[136:139], v[164:167], v[136:139], a[136:139]
    v_mfma_f32_16x16x32_bf16 a[140:143], v[164:167], v[140:143], a[140:143]
    ds_read_b128 v[160:163], v186 offset:256
    s_waitcnt lgkmcnt(4)
    v_mfma_f32_16x16x32_bf16 v[96:99], v[144:147], v[0:3], v[168:171]
    s_add_u32 m0, s79, 0
    s_nop 0
    v_mfma_f32_16x16x32_bf16 v[100:103], v[144:147], v[4:7], v[172:175]
    buffer_load_dwordx4 v197, s[52:55], s66 offen nt lds
    v_mfma_f32_16x16x32_bf16 v[104:107], v[144:147], v[8:11], v[176:179]
    s_add_u32 m0, s79, 1024
    ds_read_b128 v[164:167], v187 offset:256
    s_waitcnt lgkmcnt(4)
    v_mfma_f32_16x16x32_bf16 v[96:99], v[148:151], v[12:15], v[96:99]
    s_nop 0
    v_mfma_f32_16x16x32_bf16 v[100:103], v[148:151], v[16:19], v[100:103]
    buffer_load_dwordx4 v198, s[52:55], s66 offen nt lds
    v_mfma_f32_16x16x32_bf16 v[104:107], v[148:151], v[20:23], v[104:107]
    s_add_u32 m0, s79, 2048
    ds_read_b128 v[144:147], v186 offset:6144
    s_waitcnt lgkmcnt(4)
    v_mfma_f32_16x16x32_bf16 v[96:99], v[152:155], v[24:27], v[96:99]
    s_nop 0
    v_mfma_f32_16x16x32_bf16 v[100:103], v[152:155], v[28:31], v[100:103]
    buffer_load_dwordx4 v199, s[52:55], s66 offen nt lds
    v_mfma_f32_16x16x32_bf16 v[104:107], v[152:155], v[32:35], v[104:107]
    s_add_u32 m0, s79, 12288
    ds_read_b128 v[148:151], v187 offset:6144
    s_waitcnt lgkmcnt(4)
    v_mfma_f32_16x16x32_bf16 v[96:99], v[156:159], v[36:39], v[96:99]
    s_nop 0
    v_mfma_f32_16x16x32_bf16 v[100:103], v[156:159], v[40:43], v[100:103]
    buffer_load_dwordx4 v197, s[48:51], s65 offen nt lds
    v_mfma_f32_16x16x32_bf16 v[104:107], v[156:159], v[44:47], v[104:107]
    s_add_u32 m0, s79, 13312
    ds_read_b128 v[152:155], v186 offset:6272
    s_waitcnt lgkmcnt(4)
    v_mfma_f32_16x16x32_bf16 v[96:99], v[160:163], v[48:51], v[96:99]
    s_nop 0
    v_mfma_f32_16x16x32_bf16 v[100:103], v[160:163], v[52:55], v[100:103]
    buffer_load_dwordx4 v198, s[48:51], s65 offen nt lds
    v_mfma_f32_16x16x32_bf16 v[104:107], v[160:163], v[56:59], v[104:107]
    s_add_u32 m0, s79, 14336
    ds_read_b128 v[156:159], v187 offset:6272
    s_waitcnt lgkmcnt(4)
    v_mfma_f32_16x16x32_bf16 v[96:99], v[164:167], v[60:63], v[96:99]
    s_nop 0
    v_mfma_f32_16x16x32_bf16 v[100:103], v[164:167], v[64:67], v[100:103]
    buffer_load_dwordx4 v199, s[48:51], s65 offen nt lds
    v_mfma_f32_16x16x32_bf16 v[104:107], v[164:167], v[68:71], v[104:107]
    s_add_u32 s66, s66, 12288
    ds_read_b128 v[160:163], v186 offset:6400
    s_waitcnt lgkmcnt(4)
    v_mfma_f32_16x16x32_bf16 v[108:111], v[144:147], v[0:3], v[168:171]
    s_add_u32 s65, s65, 12288
    s_add_u32 s79, s79, 24576
    v_mfma_f32_16x16x32_bf16 v[112:115], v[144:147], v[4:7], v[172:175]
    s_cmp_ge_u32 s79, 147456
    v_mfma_f32_16x16x32_bf16 v[116:119], v[144:147], v[8:11], v[176:179]
    s_cselect_b32 s79, s67, s79
    ds_read_b128 v[164:167], v187 offset:6400
    s_waitcnt lgkmcnt(4)
    v_mfma_f32_16x16x32_bf16 v[108:111], v[148:151], v[12:15], v[108:111]
    v_add_f32 v206, v206, v212
    v_mfma_f32_16x16x32_bf16 v[112:115], v[148:151], v[16:19], v[112:115]
    v_add_f32 v207, v207, v213
    v_mfma_f32_16x16x32_bf16 v[116:119], v[148:151], v[20:23], v[116:119]
    v_add_f32 v208, v208, v214
    v_add_u32 v188, s77, v182
    v_add_u32 v189, s77, v183
    v_add_u32 v190, s77, v184
    v_add_u32 v191, s77, v185
    ds_read_b64_tr_b16 v[144:145], v188 offset:0
    ds_read_b64_tr_b16 v[146:147], v188 offset:6144
    s_waitcnt lgkmcnt(5)
    v_mfma_f32_16x16x32_bf16 v[108:111], v[152:155], v[24:27], v[108:111]
    v_cvt_pk_bf16_f32 v120, v228, v229
    v_mfma_f32_16x16x32_bf16 v[112:115], v[152:155], v[28:31], v[112:115]
    v_cvt_pk_bf16_f32 v121, v230, v231
    v_mfma_f32_16x16x32_bf16 v[116:119], v[152:155], v[32:35], v[116:119]
    v_cvt_pk_bf16_f32 v122, v232, v233
    ds_read_b64_tr_b16 v[148:149], v189 offset:0
    ds_read_b64_tr_b16 v[150:151], v189 offset:6144
    s_waitcnt lgkmcnt(6)
    v_mfma_f32_16x16x32_bf16 v[108:111], v[156:159], v[36:39], v[108:111]
    v_cvt_pk_bf16_f32 v123, v234, v235
    v_mfma_f32_16x16x32_bf16 v[112:115], v[156:159], v[40:43], v[112:115]
    v_cvt_pk_bf16_f32 v124, v236, v237
    v_mfma_f32_16x16x32_bf16 v[116:119], v[156:159], v[44:47], v[116:119]
    v_cvt_pk_bf16_f32 v125, v238, v239
    ds_read_b64_tr_b16 v[152:153], v190 offset:0
    ds_read_b64_tr_b16 v[154:155], v190 offset:6144
    s_waitcnt lgkmcnt(7)
    v_mfma_f32_16x16x32_bf16 v[108:111], v[160:163], v[48:51], v[108:111]
    v_cvt_pk_bf16_f32 v126, v240, v241
    v_mfma_f32_16x16x32_bf16 v[112:115], v[160:163], v[52:55], v[112:115]
    v_cvt_pk_bf16_f32 v127, v242, v243
    v_mfma_f32_16x16x32_bf16 v[116:119], v[160:163], v[56:59], v[116:119]
    v_cvt_pk_bf16_f32 v128, v244, v245
    ds_read_b64_tr_b16 v[156:157], v191 offset:0
    ds_read_b64_tr_b16 v[158:159], v191 offset:6144
    s_waitcnt lgkmcnt(8)
    v_mfma_f32_16x16x32_bf16 v[108:111], v[164:167], v[60:63], v[108:111]
    v_cvt_pk_bf16_f32 v129, v246, v247
    v_mfma_f32_16x16x32_bf16 v[112:115], v[164:167], v[64:67], v[112:115]
    v_cvt_pk_bf16_f32 v130, v248, v249
    v_mfma_f32_16x16x32_bf16 v[116:119], v[164:167], v[68:71], v[116:119]
    v_cvt_pk_bf16_f32 v131, v250, v251
    s_cmp_eq_u32 s72, 0
    s_cbranch_scc1 L_k1_rs_5_skip
    s_nop 7
    v_accvgpr_read_b32 v212, a0
    v_accvgpr_read_b32 v213, a1
    v_accvgpr_read_b32 v214, a2
    v_accvgpr_read_b32 v215, a3
    v_accvgpr_read_b32 v216, a4
    v_accvgpr_read_b32 v217, a5
    v_accvgpr_read_b32 v218, a6
    v_accvgpr_read_b32 v219, a7
    v_mul_f32 v212, v212, v209
    v_mul_f32 v213, v213, v209
    v_mul_f32 v214, v214, v209
    v_mul_f32 v215, v215, v209
    v_mul_f32 v216, v216, v210
    v_mul_f32 v217, v217, v210
    v_mul_f32 v218, v218, v210
    v_mul_f32 v219, v219, v210
    v_accvgpr_write_b32 a0, v212
    v_accvgpr_write_b32 a1, v213
    v_accvgpr_write_b32 a2, v214
    v_accvgpr_write_b32 a3, v215
    v_accvgpr_write_b32 a4, v216
    v_accvgpr_write_b32 a5, v217
    v_accvgpr_write_b32 a6, v218
    v_accvgpr_write_b32 a7, v219
    v_accvgpr_read_b32 v212, a8
    v_accvgpr_read_b32 v213, a9
    v_accvgpr_read_b32 v214, a10
    v_accvgpr_read_b32 v215, a11
    v_accvgpr_read_b32 v216, a12
    v_accvgpr_read_b32 v217, a13
    v_accvgpr_read_b32 v218, a14
    v_accvgpr_read_b32 v219, a15
    v_mul_f32 v212, v212, v211
    v_mul_f32 v213, v213, v211
    v_mul_f32 v214, v214, v211
    v_mul_f32 v215, v215, v211
    v_mul_f32 v216, v216, v209
    v_mul_f32 v217, v217, v209
    v_mul_f32 v218, v218, v209
    v_mul_f32 v219, v219, v209
    v_accvgpr_write_b32 a8, v212
    v_accvgpr_write_b32 a9, v213
    v_accvgpr_write_b32 a10, v214
    v_accvgpr_write_b32 a11, v215
    v_accvgpr_write_b32 a12, v216
    v_accvgpr_write_b32 a13, v217
    v_accvgpr_write_b32 a14, v218
    v_accvgpr_write_b32 a15, v219
    v_accvgpr_read_b32 v212, a16
    v_accvgpr_read_b32 v213, a17
    v_accvgpr_read_b32 v214, a18
    v_accvgpr_read_b32 v215, a19
    v_accvgpr_read_b32 v216, a20
    v_accvgpr_read_b32 v217, a21
    v_accvgpr_read_b32 v218, a22
    v_accvgpr_read_b32 v219, a23
    v_mul_f32 v212, v212, v210
    v_mul_f32 v213, v213, v210
    v_mul_f32 v214, v214, v210
    v_mul_f32 v215, v215, v210
    v_mul_f32 v216, v216, v211
    v_mul_f32 v217, v217, v211
    v_mul_f32 v218, v218, v211
    v_mul_f32 v219, v219, v211
    v_accvgpr_write_b32 a16, v212
    v_accvgpr_write_b32 a17, v213
    v_accvgpr_write_b32 a18, v214
    v_accvgpr_write_b32 a19, v215
    v_accvgpr_write_b32 a20, v216
    v_accvgpr_write_b32 a21, v217
    v_accvgpr_write_b32 a22, v218
    v_accvgpr_write_b32 a23, v219
    v_accvgpr_read_b32 v212, a24
    v_accvgpr_read_b32 v213, a25
    v_accvgpr_read_b32 v214, a26
    v_accvgpr_read_b32 v215, a27
    v_accvgpr_read_b32 v216, a28
    v_accvgpr_read_b32 v217, a29
    v_accvgpr_read_b32 v218, a30
    v_accvgpr_read_b32 v219, a31
    v_mul_f32 v212, v212, v209
    v_mul_f32 v213, v213, v209
    v_mul_f32 v214, v214, v209
    v_mul_f32 v215, v215, v209
    v_mul_f32 v216, v216, v210
    v_mul_f32 v217, v217, v210
    v_mul_f32 v218, v218, v210
    v_mul_f32 v219, v219, v210
    v_accvgpr_write_b32 a24, v212
    v_accvgpr_write_b32 a25, v213
    v_accvgpr_write_b32 a26, v214
    v_accvgpr_write_b32 a27, v215
    v_accvgpr_write_b32 a28, v216
    v_accvgpr_write_b32 a29, v217
    v_accvgpr_write_b32 a30, v218
    v_accvgpr_write_b32 a31, v219
    v_accvgpr_read_b32 v212, a32
    v_accvgpr_read_b32 v213, a33
    v_accvgpr_read_b32 v214, a34
    v_accvgpr_read_b32 v215, a35
    v_accvgpr_read_b32 v216, a36
    v_accvgpr_read_b32 v217, a37
    v_accvgpr_read_b32 v218, a38
    v_accvgpr_read_b32 v219, a39
    v_mul_f32 v212, v212, v211
    v_mul_f32 v213, v213, v211
    v_mul_f32 v214, v214, v211
    v_mul_f32 v215, v215, v211
    v_mul_f32 v216, v216, v209
    v_mul_f32 v217, v217, v209
    v_mul_f32 v218, v218, v209
    v_mul_f32 v219, v219, v209
    v_accvgpr_write_b32 a32, v212
    v_accvgpr_write_b32 a33, v213
    v_accvgpr_write_b32 a34, v214
    v_accvgpr_write_b32 a35, v215
    v_accvgpr_write_b32 a36, v216
    v_accvgpr_write_b32 a37, v217
    v_accvgpr_write_b32 a38, v218
    v_accvgpr_write_b32 a39, v219
    v_accvgpr_read_b32 v212, a40
    v_accvgpr_read_b32 v213, a41
    v_accvgpr_read_b32 v214, a42
    v_accvgpr_read_b32 v215, a43
    v_accvgpr_read_b32 v216, a44
    v_accvgpr_read_b32 v217, a45
    v_accvgpr_read_b32 v218, a46
    v_accvgpr_read_b32 v219, a47
    v_mul_f32 v212, v212, v210
    v_mul_f32 v213, v213, v210
    v_mul_f32 v214, v214, v210
    v_mul_f32 v215, v215, v210
    v_mul_f32 v216, v216, v211
    v_mul_f32 v217, v217, v211
    v_mul_f32 v218, v218, v211
    v_mul_f32 v219, v219, v211
    v_accvgpr_write_b32 a40, v212
    v_accvgpr_write_b32 a41, v213
    v_accvgpr_write_b32 a42, v214
    v_accvgpr_write_b32 a43, v215
    v_accvgpr_write_b32 a44, v216
    v_accvgpr_write_b32 a45, v217
    v_accvgpr_write_b32 a46, v218
    v_accvgpr_write_b32 a47, v219
    v_accvgpr_read_b32 v212, a48
    v_accvgpr_read_b32 v213, a49
    v_accvgpr_read_b32 v214, a50
    v_accvgpr_read_b32 v215, a51
    v_accvgpr_read_b32 v216, a52
    v_accvgpr_read_b32 v217, a53
    v_accvgpr_read_b32 v218, a54
    v_accvgpr_read_b32 v219, a55
    v_mul_f32 v212, v212, v209
    v_mul_f32 v213, v213, v209
    v_mul_f32 v214, v214, v209
    v_mul_f32 v215, v215, v209
    v_mul_f32 v216, v216, v210
    v_mul_f32 v217, v217, v210
    v_mul_f32 v218, v218, v210
    v_mul_f32 v219, v219, v210
    v_accvgpr_write_b32 a48, v212
    v_accvgpr_write_b32 a49, v213
    v_accvgpr_write_b32 a50, v214
    v_accvgpr_write_b32 a51, v215
    v_accvgpr_write_b32 a52, v216
    v_accvgpr_write_b32 a53, v217
    v_accvgpr_write_b32 a54, v218
    v_accvgpr_write_b32 a55, v219
    v_accvgpr_read_b32 v212, a56
    v_accvgpr_read_b32 v213, a57
    v_accvgpr_read_b32 v214, a58
    v_accvgpr_read_b32 v215, a59
    v_accvgpr_read_b32 v216, a60
    v_accvgpr_read_b32 v217, a61
    v_accvgpr_read_b32 v218, a62
    v_accvgpr_read_b32 v219, a63
    v_mul_f32 v212, v212, v211
    v_mul_f32 v213, v213, v211
    v_mul_f32 v214, v214, v211
    v_mul_f32 v215, v215, v211
    v_mul_f32 v216, v216, v209
    v_mul_f32 v217, v217, v209
    v_mul_f32 v218, v218, v209
    v_mul_f32 v219, v219, v209
    v_accvgpr_write_b32 a56, v212
    v_accvgpr_write_b32 a57, v213
    v_accvgpr_write_b32 a58, v214
    v_accvgpr_write_b32 a59, v215
    v_accvgpr_write_b32 a60, v216
    v_accvgpr_write_b32 a61, v217
    v_accvgpr_write_b32 a62, v218
    v_accvgpr_write_b32 a63, v219
    v_accvgpr_read_b32 v212, a64
    v_accvgpr_read_b32 v213, a65
    v_accvgpr_read_b32 v214, a66
    v_accvgpr_read_b32 v215, a67
    v_accvgpr_read_b32 v216, a68
    v_accvgpr_read_b32 v217, a69
    v_accvgpr_read_b32 v218, a70
    v_accvgpr_read_b32 v219, a71
    v_mul_f32 v212, v212, v210
    v_mul_f32 v213, v213, v210
    v_mul_f32 v214, v214, v210
    v_mul_f32 v215, v215, v210
    v_mul_f32 v216, v216, v211
    v_mul_f32 v217, v217, v211
    v_mul_f32 v218, v218, v211
    v_mul_f32 v219, v219, v211
    v_accvgpr_write_b32 a64, v212
    v_accvgpr_write_b32 a65, v213
    v_accvgpr_write_b32 a66, v214
    v_accvgpr_write_b32 a67, v215
    v_accvgpr_write_b32 a68, v216
    v_accvgpr_write_b32 a69, v217
    v_accvgpr_write_b32 a70, v218
    v_accvgpr_write_b32 a71, v219
    v_accvgpr_read_b32 v212, a72
    v_accvgpr_read_b32 v213, a73
    v_accvgpr_read_b32 v214, a74
    v_accvgpr_read_b32 v215, a75
    v_accvgpr_read_b32 v216, a76
    v_accvgpr_read_b32 v217, a77
    v_accvgpr_read_b32 v218, a78
    v_accvgpr_read_b32 v219, a79
    v_mul_f32 v212, v212, v209
    v_mul_f32 v213, v213, v209
    v_mul_f32 v214, v214, v209
    v_mul_f32 v215, v215, v209
    v_mul_f32 v216, v216, v210
    v_mul_f32 v217, v217, v210
    v_mul_f32 v218, v218, v210
    v_mul_f32 v219, v219, v210
    v_accvgpr_write_b32 a72, v212
    v_accvgpr_write_b32 a73, v213
    v_accvgpr_write_b32 a74, v214
    v_accvgpr_write_b32 a75, v215
    v_accvgpr_write_b32 a76, v216
    v_accvgpr_write_b32 a77, v217
    v_accvgpr_write_b32 a78, v218
    v_accvgpr_write_b32 a79, v219
    v_accvgpr_read_b32 v212, a80
    v_accvgpr_read_b32 v213, a81
    v_accvgpr_read_b32 v214, a82
    v_accvgpr_read_b32 v215, a83
    v_accvgpr_read_b32 v216, a84
    v_accvgpr_read_b32 v217, a85
    v_accvgpr_read_b32 v218, a86
    v_accvgpr_read_b32 v219, a87
    v_mul_f32 v212, v212, v211
    v_mul_f32 v213, v213, v211
    v_mul_f32 v214, v214, v211
    v_mul_f32 v215, v215, v211
    v_mul_f32 v216, v216, v209
    v_mul_f32 v217, v217, v209
    v_mul_f32 v218, v218, v209
    v_mul_f32 v219, v219, v209
    v_accvgpr_write_b32 a80, v212
    v_accvgpr_write_b32 a81, v213
    v_accvgpr_write_b32 a82, v214
    v_accvgpr_write_b32 a83, v215
    v_accvgpr_write_b32 a84, v216
    v_accvgpr_write_b32 a85, v217
    v_accvgpr_write_b32 a86, v218
    v_accvgpr_write_b32 a87, v219
    v_accvgpr_read_b32 v212, a88
    v_accvgpr_read_b32 v213, a89
    v_accvgpr_read_b32 v214, a90
    v_accvgpr_read_b32 v215, a91
    v_accvgpr_read_b32 v216, a92
    v_accvgpr_read_b32 v217, a93
    v_accvgpr_read_b32 v218, a94
    v_accvgpr_read_b32 v219, a95
    v_mul_f32 v212, v212, v210
    v_mul_f32 v213, v213, v210
    v_mul_f32 v214, v214, v210
    v_mul_f32 v215, v215, v210
    v_mul_f32 v216, v216, v211
    v_mul_f32 v217, v217, v211
    v_mul_f32 v218, v218, v211
    v_mul_f32 v219, v219, v211
    v_accvgpr_write_b32 a88, v212
    v_accvgpr_write_b32 a89, v213
    v_accvgpr_write_b32 a90, v214
    v_accvgpr_write_b32 a91, v215
    v_accvgpr_write_b32 a92, v216
    v_accvgpr_write_b32 a93, v217
    v_accvgpr_write_b32 a94, v218
    v_accvgpr_write_b32 a95, v219
    v_accvgpr_read_b32 v212, a96
    v_accvgpr_read_b32 v213, a97
    v_accvgpr_read_b32 v214, a98
    v_accvgpr_read_b32 v215, a99
    v_accvgpr_read_b32 v216, a100
    v_accvgpr_read_b32 v217, a101
    v_accvgpr_read_b32 v218, a102
    v_accvgpr_read_b32 v219, a103
    v_mul_f32 v212, v212, v209
    v_mul_f32 v213, v213, v209
    v_mul_f32 v214, v214, v209
    v_mul_f32 v215, v215, v209
    v_mul_f32 v216, v216, v210
    v_mul_f32 v217, v217, v210
    v_mul_f32 v218, v218, v210
    v_mul_f32 v219, v219, v210
    v_accvgpr_write_b32 a96, v212
    v_accvgpr_write_b32 a97, v213
    v_accvgpr_write_b32 a98, v214
    v_accvgpr_write_b32 a99, v215
    v_accvgpr_write_b32 a100, v216
    v_accvgpr_write_b32 a101, v217
    v_accvgpr_write_b32 a102, v218
    v_accvgpr_write_b32 a103, v219
    v_accvgpr_read_b32 v212, a104
    v_accvgpr_read_b32 v213, a105
    v_accvgpr_read_b32 v214, a106
    v_accvgpr_read_b32 v215, a107
    v_accvgpr_read_b32 v216, a108
    v_accvgpr_read_b32 v217, a109
    v_accvgpr_read_b32 v218, a110
    v_accvgpr_read_b32 v219, a111
    v_mul_f32 v212, v212, v211
    v_mul_f32 v213, v213, v211
    v_mul_f32 v214, v214, v211
    v_mul_f32 v215, v215, v211
    v_mul_f32 v216, v216, v209
    v_mul_f32 v217, v217, v209
    v_mul_f32 v218, v218, v209
    v_mul_f32 v219, v219, v209
    v_accvgpr_write_b32 a104, v212
    v_accvgpr_write_b32 a105, v213
    v_accvgpr_write_b32 a106, v214
    v_accvgpr_write_b32 a107, v215
    v_accvgpr_write_b32 a108, v216
    v_accvgpr_write_b32 a109, v217
    v_accvgpr_write_b32 a110, v218
    v_accvgpr_write_b32 a111, v219
    v_accvgpr_read_b32 v212, a112
    v_accvgpr_read_b32 v213, a113
    v_accvgpr_read_b32 v214, a114
    v_accvgpr_read_b32 v215, a115
    v_accvgpr_read_b32 v216, a116
    v_accvgpr_read_b32 v217, a117
    v_accvgpr_read_b32 v218, a118
    v_accvgpr_read_b32 v219, a119
    v_mul_f32 v212, v212, v210
    v_mul_f32 v213, v213, v210
    v_mul_f32 v214, v214, v210
    v_mul_f32 v215, v215, v210
    v_mul_f32 v216, v216, v211
    v_mul_f32 v217, v217, v211
    v_mul_f32 v218, v218, v211
    v_mul_f32 v219, v219, v211
    v_accvgpr_write_b32 a112, v212
    v_accvgpr_write_b32 a113, v213
    v_accvgpr_write_b32 a114, v214
    v_accvgpr_write_b32 a115, v215
    v_accvgpr_write_b32 a116, v216
    v_accvgpr_write_b32 a117, v217
    v_accvgpr_write_b32 a118, v218
    v_accvgpr_write_b32 a119, v219
    v_accvgpr_read_b32 v212, a120
    v_accvgpr_read_b32 v213, a121
    v_accvgpr_read_b32 v214, a122
    v_accvgpr_read_b32 v215, a123
    v_accvgpr_read_b32 v216, a124
    v_accvgpr_read_b32 v217, a125
    v_accvgpr_read_b32 v218, a126
    v_accvgpr_read_b32 v219, a127
    v_mul_f32 v212, v212, v209
    v_mul_f32 v213, v213, v209
    v_mul_f32 v214, v214, v209
    v_mul_f32 v215, v215, v209
    v_mul_f32 v216, v216, v210
    v_mul_f32 v217, v217, v210
    v_mul_f32 v218, v218, v210
    v_mul_f32 v219, v219, v210
    v_accvgpr_write_b32 a120, v212
    v_accvgpr_write_b32 a121, v213
    v_accvgpr_write_b32 a122, v214
    v_accvgpr_write_b32 a123, v215
    v_accvgpr_write_b32 a124, v216
    v_accvgpr_write_b32 a125, v217
    v_accvgpr_write_b32 a126, v218
    v_accvgpr_write_b32 a127, v219
    v_accvgpr_read_b32 v212, a128
    v_accvgpr_read_b32 v213, a129
    v_accvgpr_read_b32 v214, a130
    v_accvgpr_read_b32 v215, a131
    v_accvgpr_read_b32 v216, a132
    v_accvgpr_read_b32 v217, a133
    v_accvgpr_read_b32 v218, a134
    v_accvgpr_read_b32 v219, a135
    v_mul_f32 v212, v212, v211
    v_mul_f32 v213, v213, v211
    v_mul_f32 v214, v214, v211
    v_mul_f32 v215, v215, v211
    v_mul_f32 v216, v216, v209
    v_mul_f32 v217, v217, v209
    v_mul_f32 v218, v218, v209
    v_mul_f32 v219, v219, v209
    v_accvgpr_write_b32 a128, v212
    v_accvgpr_write_b32 a129, v213
    v_accvgpr_write_b32 a130, v214
    v_accvgpr_write_b32 a131, v215
    v_accvgpr_write_b32 a132, v216
    v_accvgpr_write_b32 a133, v217
    v_accvgpr_write_b32 a134, v218
    v_accvgpr_write_b32 a135, v219
    v_accvgpr_read_b32 v212, a136
    v_accvgpr_read_b32 v213, a137
    v_accvgpr_read_b32 v214, a138
    v_accvgpr_read_b32 v215, a139
    v_accvgpr_read_b32 v216, a140
    v_accvgpr_read_b32 v217, a141
    v_accvgpr_read_b32 v218, a142
    v_accvgpr_read_b32 v219, a143
    v_mul_f32 v212, v212, v210
    v_mul_f32 v213, v213, v210
    v_mul_f32 v214, v214, v210
    v_mul_f32 v215, v215, v210
    v_mul_f32 v216, v216, v211
    v_mul_f32 v217, v217, v211
    v_mul_f32 v218, v218, v211
    v_mul_f32 v219, v219, v211
    v_accvgpr_write_b32 a136, v212
    v_accvgpr_write_b32 a137, v213
    v_accvgpr_write_b32 a138, v214
    v_accvgpr_write_b32 a139, v215
    v_accvgpr_write_b32 a140, v216
    v_accvgpr_write_b32 a141, v217
    v_accvgpr_write_b32 a142, v218
    v_accvgpr_write_b32 a143, v219
    s_mov_b32 s72, 0
    s_nop 1
L_k1_rs_5_skip:
    s_mov_b32 s61, s77
    s_add_u32 s60, s60, 1
    s_cmp_lt_u32 s60, 5
    s_cbranch_scc1 L_k1_aloop
    s_waitcnt vmcnt(18)
    s_barrier
    s_add_u32 s77, s61, 24576
    s_cmp_eq_u32 s77, 147456
    s_cselect_b32 s77, 0, s77
    s_add_u32 s68, s61, 12288
    v_add_u32 v186, s68, v180
    v_add_u32 v187, s68, v181
    ds_read_b64_tr_b16 v[160:161], v188 offset:128
    ds_read_b64_tr_b16 v[162:163], v188 offset:6272
    s_waitcnt lgkmcnt(8)
    v_mfma_f32_16x16x32_bf16 a[0:3], v[144:147], v[120:123], a[0:3]
    v_exp_f32 v228, v96
    v_exp_f32 v229, v97
    v_mfma_f32_16x16x32_bf16 a[4:7], v[144:147], v[124:127], a[4:7]
    v_exp_f32 v230, v98
    v_exp_f32 v231, v99
    v_mfma_f32_16x16x32_bf16 a[8:11], v[144:147], v[128:131], a[8:11]
    v_exp_f32 v232, v108
    ds_read_b64_tr_b16 v[164:165], v189 offset:128
    ds_read_b64_tr_b16 v[166:167], v189 offset:6272
    s_waitcnt lgkmcnt(8)
    v_mfma_f32_16x16x32_bf16 a[12:15], v[148:151], v[120:123], a[12:15]
    v_exp_f32 v233, v109
    v_exp_f32 v234, v110
    v_mfma_f32_16x16x32_bf16 a[16:19], v[148:151], v[124:127], a[16:19]
    v_exp_f32 v235, v111
    v_mfma_f32_16x16x32_bf16 a[20:23], v[148:151], v[128:131], a[20:23]
    v_exp_f32 v236, v100
    v_exp_f32 v237, v101
    ds_read_b64_tr_b16 v[144:145], v190 offset:128
    ds_read_b64_tr_b16 v[146:147], v190 offset:6272
    s_waitcnt lgkmcnt(8)
    v_mfma_f32_16x16x32_bf16 a[24:27], v[152:155], v[120:123], a[24:27]
    v_exp_f32 v238, v102
    v_mfma_f32_16x16x32_bf16 a[28:31], v[152:155], v[124:127], a[28:31]
    v_exp_f32 v239, v103
    v_exp_f32 v240, v112
    v_mfma_f32_16x16x32_bf16 a[32:35], v[152:155], v[128:131], a[32:35]
    v_exp_f32 v241, v113
    ds_read_b64_tr_b16 v[148:149], v191 offset:128
    ds_read_b64_tr_b16 v[150:151], v191 offset:6272
    s_waitcnt lgkmcnt(8)
    v_mfma_f32_16x16x32_bf16 a[36:39], v[156:159], v[120:123], a[36:39]
    v_exp_f32 v242, v114
    v_exp_f32 v243, v115
    v_mfma_f32_16x16x32_bf16 a[40:43], v[156:159], v[124:127], a[40:43]
    v_exp_f32 v244, v104
    v_mfma_f32_16x16x32_bf16 a[44:47], v[156:159], v[128:131], a[44:47]
    v_exp_f32 v245, v105
    v_exp_f32 v246, v106
    ds_read_b64_tr_b16 v[152:153], v188 offset:256
    ds_read_b64_tr_b16 v[154:155], v188 offset:6400
    s_waitcnt lgkmcnt(8)
    v_mfma_f32_16x16x32_bf16 a[48:51], v[160:163], v[120:123], a[48:51]
    v_exp_f32 v247, v107
    v_mfma_f32_16x16x32_bf16 a[52:55], v[160:163], v[124:127], a[52:55]
    v_exp_f32 v248, v116
    v_exp_f32 v249, v117
    v_mfma_f32_16x16x32_bf16 a[56:59], v[160:163], v[128:131], a[56:59]
    v_exp_f32 v250, v118
    ds_read_b64_tr_b16 v[156:157], v189 offset:256
    ds_read_b64_tr_b16 v[158:159], v189 offset:6400
    s_waitcnt lgkmcnt(8)
    v_mfma_f32_16x16x32_bf16 a[60:63], v[164:167], v[120:123], a[60:63]
    v_exp_f32 v251, v119
    v_add_f32 v212, v228, v229
    v_mfma_f32_16x16x32_bf16 a[64:67], v[164:167], v[124:127], a[64:67]
    v_add_f32 v213, v236, v237
    v_mfma_f32_16x16x32_bf16 a[68:71], v[164:167], v[128:131], a[68:71]
    v_add_f32 v214, v244, v245
    v_add_f32 v212, v212, v230
    ds_read_b64_tr_b16 v[160:161], v190 offset:256
    ds_read_b64_tr_b16 v[162:163], v190 offset:6400
    s_waitcnt lgkmcnt(8)
    v_mfma_f32_16x16x32_bf16 a[72:75], v[144:147], v[120:123], a[72:75]
    v_add_f32 v213, v213, v238
    v_add_f32 v214, v214, v246
    v_mfma_f32_16x16x32_bf16 a[76:79], v[144:147], v[124:127], a[76:79]
    v_add_f32 v212, v212, v231
    v_mfma_f32_16x16x32_bf16 a[80:83], v[144:147], v[128:131], a[80:83]
    v_add_f32 v213, v213, v239
    v_add_f32 v214, v214, v247
    ds_read_b64_tr_b16 v[164:165], v191 offset:256
    ds_read_b64_tr_b16 v[166:167], v191 offset:6400
    s_waitcnt lgkmcnt(8)
    v_mfma_f32_16x16x32_bf16 a[84:87], v[148:151], v[120:123], a[84:87]
    v_add_f32 v212, v212, v232
    v_mfma_f32_16x16x32_bf16 a[88:91], v[148:151], v[124:127], a[88:91]
    v_add_f32 v213, v213, v240
    v_add_f32 v214, v214, v248
    v_mfma_f32_16x16x32_bf16 a[92:95], v[148:151], v[128:131], a[92:95]
    v_add_f32 v212, v212, v233
    ds_read_b128 v[144:147], v186 offset:0
    s_waitcnt lgkmcnt(7)
    v_mfma_f32_16x16x32_bf16 a[96:99], v[152:155], v[120:123], a[96:99]
    v_add_f32 v213, v213, v241
    v_add_f32 v214, v214, v249
    v_mfma_f32_16x16x32_bf16 a[100:103], v[152:155], v[124:127], a[100:103]
    v_add_f32 v212, v212, v234
    v_mfma_f32_16x16x32_bf16 a[104:107], v[152:155], v[128:131], a[104:107]
    v_add_f32 v213, v213, v242
    v_add_f32 v214, v214, v250
    ds_read_b128 v[148:151], v187 offset:0
    s_waitcnt lgkmcnt(6)
    v_mfma_f32_16x16x32_bf16 a[108:111], v[156:159], v[120:123], a[108:111]
    v_add_f32 v212, v212, v235
    v_mfma_f32_16x16x32_bf16 a[112:115], v[156:159], v[124:127], a[112:115]
    v_add_f32 v213, v213, v243
    v_add_f32 v214, v214, v251
    v_mfma_f32_16x16x32_bf16 a[116:119], v[156:159], v[128:131], a[116:119]
    v_cmp_gt_f32 s[80:81], v212, s71
    ds_read_b128 v[152:155], v186 offset:128
    s_waitcnt lgkmcnt(5)
    v_mfma_f32_16x16x32_bf16 a[120:123], v[160:163], v[120:123], a[120:123]
    v_cmp_gt_f32 s[82:83], v213, s71
    v_cmp_gt_f32 s[84:85], v214, s71
    v_mfma_f32_16x16x32_bf16 a[124:127], v[160:163], v[124:127], a[124:127]
    s_or_b64 s[80:81], s[80:81], s[82:83]
    v_mfma_f32_16x16x32_bf16 a[128:131], v[160:163], v[128:131], a[128:131]
    s_or_b64 s[80:81], s[80:81], s[84:85]
    s_cbranch_scc1 L_k1_sm_6_slow
L_k1_sm_6_ret:
    ds_read_b128 v[156:159], v187 offset:128
    s_waitcnt lgkmcnt(4)
    v_mfma_f32_16x16x32_bf16 a[132:135], v[164:167], v[120:123], a[132:135]
    v_mfma_f32_16x16x32_bf16 a[136:139], v[164:167], v[124:127], a[136:139]
    v_mfma_f32_16x16x32_bf16 a[140:143], v[164:167], v[128:131], a[140:143]
    ds_read_b128 v[160:163], v186 offset:256
    s_waitcnt lgkmcnt(4)
    v_mfma_f32_16x16x32_bf16 v[72:75], v[144:147], v[0:3], v[168:171]
    s_add_u32 m0, s79, 0
    s_nop 0
    v_mfma_f32_16x16x32_bf16 v[76:79], v[144:147], v[4:7], v[172:175]
    buffer_load_dwordx4 v197, s[52:55], s66 offen nt lds
    v_mfma_f32_16x16x32_bf16 v[80:83], v[144:147], v[8:11], v[176:179]
    s_add_u32 m0, s79, 1024
    ds_read_b128 v[164:167], v187 offset:256
    s_waitcnt lgkmcnt(4)
    v_mfma_f32_16x16x32_bf16 v[72:75], v[148:151], v[12:15], v[72:75]
    s_nop 0
    v_mfma_f32_16x16x32_bf16 v[76:79], v[148:151], v[16:19], v[76:79]
    buffer_load_dwordx4 v198, s[52:55], s66 offen nt lds
    v_mfma_f32_16x16x32_bf16 v[80:83], v[148:151], v[20:23], v[80:83]
    s_add_u32 m0, s79, 2048
    ds_read_b128 v[144:147], v186 offset:6144
    s_waitcnt lgkmcnt(4)
    v_mfma_f32_16x16x32_bf16 v[72:75], v[152:155], v[24:27], v[72:75]
    s_nop 0
    v_mfma_f32_16x16x32_bf16 v[76:79], v[152:155], v[28:31], v[76:79]
    buffer_load_dwordx4 v199, s[52:55], s66 offen nt lds
    v_mfma_f32_16x16x32_bf16 v[80:83], v[152:155], v[32:35], v[80:83]
    s_add_u32 m0, s79, 12288
    ds_read_b128 v[148:151], v187 offset:6144
    s_waitcnt lgkmcnt(4)
    v_mfma_f32_16x16x32_bf16 v[72:75], v[156:159], v[36:39], v[72:75]
    s_nop 0
    v_mfma_f32_16x16x32_bf16 v[76:79], v[156:159], v[40:43], v[76:79]
    buffer_load_dwordx4 v197, s[48:51], s65 offen nt lds
    v_mfma_f32_16x16x32_bf16 v[80:83], v[156:159], v[44:47], v[80:83]
    s_add_u32 m0, s79, 13312
    ds_read_b128 v[152:155], v186 offset:6272
    s_waitcnt lgkmcnt(4)
    v_mfma_f32_16x16x32_bf16 v[72:75], v[160:163], v[48:51], v[72:75]
    s_nop 0
    v_mfma_f32_16x16x32_bf16 v[76:79], v[160:163], v[52:55], v[76:79]
    buffer_load_dwordx4 v198, s[48:51], s65 offen nt lds
    v_mfma_f32_16x16x32_bf16 v[80:83], v[160:163], v[56:59], v[80:83]
    s_add_u32 m0, s79, 14336
    ds_read_b128 v[156:159], v187 offset:6272
    s_waitcnt lgkmcnt(4)
    v_mfma_f32_16x16x32_bf16 v[72:75], v[164:167], v[60:63], v[72:75]
    s_nop 0
    v_mfma_f32_16x16x32_bf16 v[76:79], v[164:167], v[64:67], v[76:79]
    buffer_load_dwordx4 v199, s[48:51], s65 offen nt lds
    v_mfma_f32_16x16x32_bf16 v[80:83], v[164:167], v[68:71], v[80:83]
    s_add_u32 s66, s66, 12288
    ds_read_b128 v[160:163], v186 offset:6400
    s_waitcnt lgkmcnt(4)
    v_mfma_f32_16x16x32_bf16 v[84:87], v[144:147], v[0:3], v[168:171]
    s_add_u32 s65, s65, 12288
    s_add_u32 s79, s79, 24576
    v_mfma_f32_16x16x32_bf16 v[88:91], v[144:147], v[4:7], v[172:175]
    s_cmp_ge_u32 s79, 147456
    v_mfma_f32_16x16x32_bf16 v[92:95], v[144:147], v[8:11], v[176:179]
    s_cselect_b32 s79, s67, s79
    ds_read_b128 v[164:167], v187 offset:6400
    s_waitcnt lgkmcnt(4)
    v_mfma_f32_16x16x32_bf16 v[84:87], v[148:151], v[12:15], v[84:87]
    v_add_f32 v206, v206, v212
    v_mfma_f32_16x16x32_bf16 v[88:91], v[148:151], v[16:19], v[88:91]
    v_add_f32 v207, v207, v213
    v_mfma_f32_16x16x32_bf16 v[92:95], v[148:151], v[20:23], v[92:95]
    v_add_f32 v208, v208, v214
    v_add_u32 v188, s77, v182
    v_add_u32 v189, s77, v183
    v_add_u32 v190, s77, v184
    v_add_u32 v191, s77, v185
    ds_read_b64_tr_b16 v[144:145], v188 offset:0
    ds_read_b64_tr_b16 v[146:147], v188 offset:6144
    s_waitcnt lgkmcnt(5)
    v_mfma_f32_16x16x32_bf16 v[84:87], v[152:155], v[24:27], v[84:87]
    v_cvt_pk_bf16_f32 v132, v228, v229
    v_mfma_f32_16x16x32_bf16 v[88:91], v[152:155], v[28:31], v[88:91]
    v_cvt_pk_bf16_f32 v133, v230, v231
    v_mfma_f32_16x16x32_bf16 v[92:95], v[152:155], v[32:35], v[92:95]
    v_cvt_pk_bf16_f32 v134, v232, v233
    ds_read_b64_tr_b16 v[148:149], v189 offset:0
    ds_read_b64_tr_b16 v[150:151], v189 offset:6144
    s_waitcnt lgkmcnt(6)
    v_mfma_f32_16x16x32_bf16 v[84:87], v[156:159], v[36:39], v[84:87]
    v_cvt_pk_bf16_f32 v135, v234, v235
    v_mfma_f32_16x16x32_bf16 v[88:91], v[156:159], v[40:43], v[88:91]
    v_cvt_pk_bf16_f32 v136, v236, v237
    v_mfma_f32_16x16x32_bf16 v[92:95], v[156:159], v[44:47], v[92:95]
    v_cvt_pk_bf16_f32 v137, v238, v239
    ds_read_b64_tr_b16 v[152:153], v190 offset:0
    ds_read_b64_tr_b16 v[154:155], v190 offset:6144
    s_waitcnt lgkmcnt(7)
    v_mfma_f32_16x16x32_bf16 v[84:87], v[160:163], v[48:51], v[84:87]
    v_cvt_pk_bf16_f32 v138, v240, v241
    v_mfma_f32_16x16x32_bf16 v[88:91], v[160:163], v[52:55], v[88:91]
    v_cvt_pk_bf16_f32 v139, v242, v243
    v_mfma_f32_16x16x32_bf16 v[92:95], v[160:163], v[56:59], v[92:95]
    v_cvt_pk_bf16_f32 v140, v244, v245
    ds_read_b64_tr_b16 v[156:157], v191 offset:0
    ds_read_b64_tr_b16 v[158:159], v191 offset:6144
    s_waitcnt lgkmcnt(8)
    v_mfma_f32_16x16x32_bf16 v[84:87], v[164:167], v[60:63], v[84:87]
    v_cvt_pk_bf16_f32 v141, v246, v247
    v_mfma_f32_16x16x32_bf16 v[88:91], v[164:167], v[64:67], v[88:91]
    v_cvt_pk_bf16_f32 v142, v248, v249
    v_mfma_f32_16x16x32_bf16 v[92:95], v[164:167], v[68:71], v[92:95]
    v_cvt_pk_bf16_f32 v143, v250, v251
    s_cmp_eq_u32 s72, 0
    s_cbranch_scc1 L_k1_rs_7_skip
    s_nop 7
    v_accvgpr_read_b32 v212, a0
    v_accvgpr_read_b32 v213, a1
    v_accvgpr_read_b32 v214, a2
    v_accvgpr_read_b32 v215, a3
    v_accvgpr_read_b32 v216, a4
    v_accvgpr_read_b32 v217, a5
    v_accvgpr_read_b32 v218, a6
    v_accvgpr_read_b32 v219, a7
    v_mul_f32 v212, v212, v209
    v_mul_f32 v213, v213, v209
    v_mul_f32 v214, v214, v209
    v_mul_f32 v215, v215, v209
    v_mul_f32 v216, v216, v210
    v_mul_f32 v217, v217, v210
    v_mul_f32 v218, v218, v210
    v_mul_f32 v219, v219, v210
    v_accvgpr_write_b32 a0, v212
    v_accvgpr_write_b32 a1, v213
    v_accvgpr_write_b32 a2, v214
    v_accvgpr_write_b32 a3, v215
    v_accvgpr_write_b32 a4, v216
    v_accvgpr_write_b32 a5, v217
    v_accvgpr_write_b32 a6, v218
    v_accvgpr_write_b32 a7, v219
    v_accvgpr_read_b32 v212, a8
    v_accvgpr_read_b32 v213, a9
    v_accvgpr_read_b32 v214, a10
    v_accvgpr_read_b32 v215, a11
    v_accvgpr_read_b32 v216, a12
    v_accvgpr_read_b32 v217, a13
    v_accvgpr_read_b32 v218, a14
    v_accvgpr_read_b32 v219, a15
    v_mul_f32 v212, v212, v211
    v_mul_f32 v213, v213, v211
    v_mul_f32 v214, v214, v211
    v_mul_f32 v215, v215, v211
    v_mul_f32 v216, v216, v209
    v_mul_f32 v217, v217, v209
    v_mul_f32 v218, v218, v209
    v_mul_f32 v219, v219, v209
    v_accvgpr_write_b32 a8, v212
    v_accvgpr_write_b32 a9, v213
    v_accvgpr_write_b32 a10, v214
    v_accvgpr_write_b32 a11, v215
    v_accvgpr_write_b32 a12, v216
    v_accvgpr_write_b32 a13, v217
    v_accvgpr_write_b32 a14, v218
    v_accvgpr_write_b32 a15, v219
    v_accvgpr_read_b32 v212, a16
    v_accvgpr_read_b32 v213, a17
    v_accvgpr_read_b32 v214, a18
    v_accvgpr_read_b32 v215, a19
    v_accvgpr_read_b32 v216, a20
    v_accvgpr_read_b32 v217, a21
    v_accvgpr_read_b32 v218, a22
    v_accvgpr_read_b32 v219, a23
    v_mul_f32 v212, v212, v210
    v_mul_f32 v213, v213, v210
    v_mul_f32 v214, v214, v210
    v_mul_f32 v215, v215, v210
    v_mul_f32 v216, v216, v211
    v_mul_f32 v217, v217, v211
    v_mul_f32 v218, v218, v211
    v_mul_f32 v219, v219, v211
    v_accvgpr_write_b32 a16, v212
    v_accvgpr_write_b32 a17, v213
    v_accvgpr_write_b32 a18, v214
    v_accvgpr_write_b32 a19, v215
    v_accvgpr_write_b32 a20, v216
    v_accvgpr_write_b32 a21, v217
    v_accvgpr_write_b32 a22, v218
    v_accvgpr_write_b32 a23, v219
    v_accvgpr_read_b32 v212, a24
    v_accvgpr_read_b32 v213, a25
    v_accvgpr_read_b32 v214, a26
    v_accvgpr_read_b32 v215, a27
    v_accvgpr_read_b32 v216, a28
    v_accvgpr_read_b32 v217, a29
    v_accvgpr_read_b32 v218, a30
    v_accvgpr_read_b32 v219, a31
    v_mul_f32 v212, v212, v209
    v_mul_f32 v213, v213, v209
    v_mul_f32 v214, v214, v209
    v_mul_f32 v215, v215, v209
    v_mul_f32 v216, v216, v210
    v_mul_f32 v217, v217, v210
    v_mul_f32 v218, v218, v210
    v_mul_f32 v219, v219, v210
    v_accvgpr_write_b32 a24, v212
    v_accvgpr_write_b32 a25, v213
    v_accvgpr_write_b32 a26, v214
    v_accvgpr_write_b32 a27, v215
    v_accvgpr_write_b32 a28, v216
    v_accvgpr_write_b32 a29, v217
    v_accvgpr_write_b32 a30, v218
    v_accvgpr_write_b32 a31, v219
    v_accvgpr_read_b32 v212, a32
    v_accvgpr_read_b32 v213, a33
    v_accvgpr_read_b32 v214, a34
    v_accvgpr_read_b32 v215, a35
    v_accvgpr_read_b32 v216, a36
    v_accvgpr_read_b32 v217, a37
    v_accvgpr_read_b32 v218, a38
    v_accvgpr_read_b32 v219, a39
    v_mul_f32 v212, v212, v211
    v_mul_f32 v213, v213, v211
    v_mul_f32 v214, v214, v211
    v_mul_f32 v215, v215, v211
    v_mul_f32 v216, v216, v209
    v_mul_f32 v217, v217, v209
    v_mul_f32 v218, v218, v209
    v_mul_f32 v219, v219, v209
    v_accvgpr_write_b32 a32, v212
    v_accvgpr_write_b32 a33, v213
    v_accvgpr_write_b32 a34, v214
    v_accvgpr_write_b32 a35, v215
    v_accvgpr_write_b32 a36, v216
    v_accvgpr_write_b32 a37, v217
    v_accvgpr_write_b32 a38, v218
    v_accvgpr_write_b32 a39, v219
    v_accvgpr_read_b32 v212, a40
    v_accvgpr_read_b32 v213, a41
    v_accvgpr_read_b32 v214, a42
    v_accvgpr_read_b32 v215, a43
    v_accvgpr_read_b32 v216, a44
    v_accvgpr_read_b32 v217, a45
    v_accvgpr_read_b32 v218, a46
    v_accvgpr_read_b32 v219, a47
    v_mul_f32 v212, v212, v210
    v_mul_f32 v213, v213, v210
    v_mul_f32 v214, v214, v210
    v_mul_f32 v215, v215, v210
    v_mul_f32 v216, v216, v211
    v_mul_f32 v217, v217, v211
    v_mul_f32 v218, v218, v211
    v_mul_f32 v219, v219, v211
    v_accvgpr_write_b32 a40, v212
    v_accvgpr_write_b32 a41, v213
    v_accvgpr_write_b32 a42, v214
    v_accvgpr_write_b32 a43, v215
    v_accvgpr_write_b32 a44, v216
    v_accvgpr_write_b32 a45, v217
    v_accvgpr_write_b32 a46, v218
    v_accvgpr_write_b32 a47, v219
    v_accvgpr_read_b32 v212, a48
    v_accvgpr_read_b32 v213, a49
    v_accvgpr_read_b32 v214, a50
    v_accvgpr_read_b32 v215, a51
    v_accvgpr_read_b32 v216, a52
    v_accvgpr_read_b32 v217, a53
    v_accvgpr_read_b32 v218, a54
    v_accvgpr_read_b32 v219, a55
    v_mul_f32 v212, v212, v209
    v_mul_f32 v213, v213, v209
    v_mul_f32 v214, v214, v209
    v_mul_f32 v215, v215, v209
    v_mul_f32 v216, v216, v210
    v_mul_f32 v217, v217, v210
    v_mul_f32 v218, v218, v210
    v_mul_f32 v219, v219, v210
    v_accvgpr_write_b32 a48, v212
    v_accvgpr_write_b32 a49, v213
    v_accvgpr_write_b32 a50, v214
    v_accvgpr_write_b32 a51, v215
    v_accvgpr_write_b32 a52, v216
    v_accvgpr_write_b32 a53, v217
    v_accvgpr_write_b32 a54, v218
    v_accvgpr_write_b32 a55, v219
    v_accvgpr_read_b32 v212, a56
    v_accvgpr_read_b32 v213, a57
    v_accvgpr_read_b32 v214, a58
    v_accvgpr_read_b32 v215, a59
    v_accvgpr_read_b32 v216, a60
    v_accvgpr_read_b32 v217, a61
    v_accvgpr_read_b32 v218, a62
    v_accvgpr_read_b32 v219, a63
    v_mul_f32 v212, v212, v211
    v_mul_f32 v213, v213, v211
    v_mul_f32 v214, v214, v211
    v_mul_f32 v215, v215, v211
    v_mul_f32 v216, v216, v209
    v_mul_f32 v217, v217, v209
    v_mul_f32 v218, v218, v209
    v_mul_f32 v219, v219, v209
    v_accvgpr_write_b32 a56, v212
    v_accvgpr_write_b32 a57, v213
    v_accvgpr_write_b32 a58, v214
    v_accvgpr_write_b32 a59, v215
    v_accvgpr_write_b32 a60, v216
    v_accvgpr_write_b32 a61, v217
    v_accvgpr_write_b32 a62, v218
    v_accvgpr_write_b32 a63, v219
    v_accvgpr_read_b32 v212, a64
    v_accvgpr_read_b32 v213, a65
    v_accvgpr_read_b32 v214, a66
    v_accvgpr_read_b32 v215, a67
    v_accvgpr_read_b32 v216, a68
    v_accvgpr_read_b32 v217, a69
    v_accvgpr_read_b32 v218, a70
    v_accvgpr_read_b32 v219, a71
    v_mul_f32 v212, v212, v210
    v_mul_f32 v213, v213, v210
    v_mul_f32 v214, v214, v210
    v_mul_f32 v215, v215, v210
    v_mul_f32 v216, v216, v211
    v_mul_f32 v217, v217, v211
    v_mul_f32 v218, v218, v211
    v_mul_f32 v219, v219, v211
    v_accvgpr_write_b32 a64, v212
    v_accvgpr_write_b32 a65, v213
    v_accvgpr_write_b32 a66, v214
    v_accvgpr_write_b32 a67, v215
    v_accvgpr_write_b32 a68, v216
    v_accvgpr_write_b32 a69, v217
    v_accvgpr_write_b32 a70, v218
    v_accvgpr_write_b32 a71, v219
    v_accvgpr_read_b32 v212, a72
    v_accvgpr_read_b32 v213, a73
    v_accvgpr_read_b32 v214, a74
    v_accvgpr_read_b32 v215, a75
    v_accvgpr_read_b32 v216, a76
    v_accvgpr_read_b32 v217, a77
    v_accvgpr_read_b32 v218, a78
    v_accvgpr_read_b32 v219, a79
    v_mul_f32 v212, v212, v209
    v_mul_f32 v213, v213, v209
    v_mul_f32 v214, v214, v209
    v_mul_f32 v215, v215, v209
    v_mul_f32 v216, v216, v210
    v_mul_f32 v217, v217, v210
    v_mul_f32 v218, v218, v210
    v_mul_f32 v219, v219, v210
    v_accvgpr_write_b32 a72, v212
    v_accvgpr_write_b32 a73, v213
    v_accvgpr_write_b32 a74, v214
    v_accvgpr_write_b32 a75, v215
    v_accvgpr_write_b32 a76, v216
    v_accvgpr_write_b32 a77, v217
    v_accvgpr_write_b32 a78, v218
    v_accvgpr_write_b32 a79, v219
    v_accvgpr_read_b32 v212, a80
    v_accvgpr_read_b32 v213, a81
    v_accvgpr_read_b32 v214, a82
    v_accvgpr_read_b32 v215, a83
    v_accvgpr_read_b32 v216, a84
    v_accvgpr_read_b32 v217, a85
    v_accvgpr_read_b32 v218, a86
    v_accvgpr_read_b32 v219, a87
    v_mul_f32 v212, v212, v211
    v_mul_f32 v213, v213, v211
    v_mul_f32 v214, v214, v211
    v_mul_f32 v215, v215, v211
    v_mul_f32 v216, v216, v209
    v_mul_f32 v217, v217, v209
    v_mul_f32 v218, v218, v209
    v_mul_f32 v219, v219, v209
    v_accvgpr_write_b32 a80, v212
    v_accvgpr_write_b32 a81, v213
    v_accvgpr_write_b32 a82, v214
    v_accvgpr_write_b32 a83, v215
    v_accvgpr_write_b32 a84, v216
    v_accvgpr_write_b32 a85, v217
    v_accvgpr_write_b32 a86, v218
    v_accvgpr_write_b32 a87, v219
    v_accvgpr_read_b32 v212, a88
    v_accvgpr_read_b32 v213, a89
    v_accvgpr_read_b32 v214, a90
    v_accvgpr_read_b32 v215, a91
    v_accvgpr_read_b32 v216, a92
    v_accvgpr_read_b32 v217, a93
    v_accvgpr_read_b32 v218, a94
    v_accvgpr_read_b32 v219, a95
    v_mul_f32 v212, v212, v210
    v_mul_f32 v213, v213, v210
    v_mul_f32 v214, v214, v210
    v_mul_f32 v215, v215, v210
    v_mul_f32 v216, v216, v211
    v_mul_f32 v217, v217, v211
    v_mul_f32 v218, v218, v211
    v_mul_f32 v219, v219, v211
    v_accvgpr_write_b32 a88, v212
    v_accvgpr_write_b32 a89, v213
    v_accvgpr_write_b32 a90, v214
    v_accvgpr_write_b32 a91, v215
    v_accvgpr_write_b32 a92, v216
    v_accvgpr_write_b32 a93, v217
    v_accvgpr_write_b32 a94, v218
    v_accvgpr_write_b32 a95, v219
    v_accvgpr_read_b32 v212, a96
    v_accvgpr_read_b32 v213, a97
    v_accvgpr_read_b32 v214, a98
    v_accvgpr_read_b32 v215, a99
    v_accvgpr_read_b32 v216, a100
    v_accvgpr_read_b32 v217, a101
    v_accvgpr_read_b32 v218, a102
    v_accvgpr_read_b32 v219, a103
    v_mul_f32 v212, v212, v209
    v_mul_f32 v213, v213, v209
    v_mul_f32 v214, v214, v209
    v_mul_f32 v215, v215, v209
    v_mul_f32 v216, v216, v210
    v_mul_f32 v217, v217, v210
    v_mul_f32 v218, v218, v210
    v_mul_f32 v219, v219, v210
    v_accvgpr_write_b32 a96, v212
    v_accvgpr_write_b32 a97, v213
    v_accvgpr_write_b32 a98, v214
    v_accvgpr_write_b32 a99, v215
    v_accvgpr_write_b32 a100, v216
    v_accvgpr_write_b32 a101, v217
    v_accvgpr_write_b32 a102, v218
    v_accvgpr_write_b32 a103, v219
    v_accvgpr_read_b32 v212, a104
    v_accvgpr_read_b32 v213, a105
    v_accvgpr_read_b32 v214, a106
    v_accvgpr_read_b32 v215, a107
    v_accvgpr_read_b32 v216, a108
    v_accvgpr_read_b32 v217, a109
    v_accvgpr_read_b32 v218, a110
    v_accvgpr_read_b32 v219, a111
    v_mul_f32 v212, v212, v211
    v_mul_f32 v213, v213, v211
    v_mul_f32 v214, v214, v211
    v_mul_f32 v215, v215, v211
    v_mul_f32 v216, v216, v209
    v_mul_f32 v217, v217, v209
    v_mul_f32 v218, v218, v209
    v_mul_f32 v219, v219, v209
    v_accvgpr_write_b32 a104, v212
    v_accvgpr_write_b32 a105, v213
    v_accvgpr_write_b32 a106, v214
    v_accvgpr_write_b32 a107, v215
    v_accvgpr_write_b32 a108, v216
    v_accvgpr_write_b32 a109, v217
    v_accvgpr_write_b32 a110, v218
    v_accvgpr_write_b32 a111, v219
    v_accvgpr_read_b32 v212, a112
    v_accvgpr_read_b32 v213, a113
    v_accvgpr_read_b32 v214, a114
    v_accvgpr_read_b32 v215, a115
    v_accvgpr_read_b32 v216, a116
    v_accvgpr_read_b32 v217, a117
    v_accvgpr_read_b32 v218, a118
    v_accvgpr_read_b32 v219, a119
    v_mul_f32 v212, v212, v210
    v_mul_f32 v213, v213, v210
    v_mul_f32 v214, v214, v210
    v_mul_f32 v215, v215, v210
    v_mul_f32 v216, v216, v211
    v_mul_f32 v217, v217, v211
    v_mul_f32 v218, v218, v211
    v_mul_f32 v219, v219, v211
    v_accvgpr_write_b32 a112, v212
    v_accvgpr_write_b32 a113, v213
    v_accvgpr_write_b32 a114, v214
    v_accvgpr_write_b32 a115, v215
    v_accvgpr_write_b32 a116, v216
    v_accvgpr_write_b32 a117, v217
    v_accvgpr_write_b32 a118, v218
    v_accvgpr_write_b32 a119, v219
    v_accvgpr_read_b32 v212, a120
    v_accvgpr_read_b32 v213, a121
    v_accvgpr_read_b32 v214, a122
    v_accvgpr_read_b32 v215, a123
    v_accvgpr_read_b32 v216, a124
    v_accvgpr_read_b32 v217, a125
    v_accvgpr_read_b32 v218, a126
    v_accvgpr_read_b32 v219, a127
    v_mul_f32 v212, v212, v209
    v_mul_f32 v213, v213, v209
    v_mul_f32 v214, v214, v209
    v_mul_f32 v215, v215, v209
    v_mul_f32 v216, v216, v210
    v_mul_f32 v217, v217, v210
    v_mul_f32 v218, v218, v210
    v_mul_f32 v219, v219, v210
    v_accvgpr_write_b32 a120, v212
    v_accvgpr_write_b32 a121, v213
    v_accvgpr_write_b32 a122, v214
    v_accvgpr_write_b32 a123, v215
    v_accvgpr_write_b32 a124, v216
    v_accvgpr_write_b32 a125, v217
    v_accvgpr_write_b32 a126, v218
    v_accvgpr_write_b32 a127, v219
    v_accvgpr_read_b32 v212, a128
    v_accvgpr_read_b32 v213, a129
    v_accvgpr_read_b32 v214, a130
    v_accvgpr_read_b32 v215, a131
    v_accvgpr_read_b32 v216, a132
    v_accvgpr_read_b32 v217, a133
    v_accvgpr_read_b32 v218, a134
    v_accvgpr_read_b32 v219, a135
    v_mul_f32 v212, v212, v211
    v_mul_f32 v213, v213, v211
    v_mul_f32 v214, v214, v211
    v_mul_f32 v215, v215, v211
    v_mul_f32 v216, v216, v209
    v_mul_f32 v217, v217, v209
    v_mul_f32 v218, v218, v209
    v_mul_f32 v219, v219, v209
    v_accvgpr_write_b32 a128, v212
    v_accvgpr_write_b32 a129, v213
    v_accvgpr_write_b32 a130, v214
    v_accvgpr_write_b32 a131, v215
    v_accvgpr_write_b32 a132, v216
    v_accvgpr_write_b32 a133, v217
    v_accvgpr_write_b32 a134, v218
    v_accvgpr_write_b32 a135, v219
    v_accvgpr_read_b32 v212, a136
    v_accvgpr_read_b32 v213, a137
    v_accvgpr_read_b32 v214, a138
    v_accvgpr_read_b32 v215, a139
    v_accvgpr_read_b32 v216, a140
    v_accvgpr_read_b32 v217, a141
    v_accvgpr_read_b32 v218, a142
    v_accvgpr_read_b32 v219, a143
    v_mul_f32 v212, v212, v210
    v_mul_f32 v213, v213, v210
    v_mul_f32 v214, v214, v210
    v_mul_f32 v215, v215, v210
    v_mul_f32 v216, v216, v211
    v_mul_f32 v217, v217, v211
    v_mul_f32 v218, v218, v211
    v_mul_f32 v219, v219, v211
    v_accvgpr_write_b32 a136, v212
    v_accvgpr_write_b32 a137, v213
    v_accvgpr_write_b32 a138, v214
    v_accvgpr_write_b32 a139, v215
    v_accvgpr_write_b32 a140, v216
    v_accvgpr_write_b32 a141, v217
    v_accvgpr_write_b32 a142, v218
    v_accvgpr_write_b32 a143, v219
    s_mov_b32 s72, 0
    s_nop 1
L_k1_rs_7_skip:
    s_mov_b32 s61, s77
    s_waitcnt vmcnt(18)
    s_barrier
    s_add_u32 s77, s61, 24576
    s_cmp_eq_u32 s77, 147456
    s_cselect_b32 s77, 0, s77
    s_mov_b32 s65, 0
    s_mov_b32 s66, 0
    s_add_u32 s48, s48, 196608
    s_addc_u32 s49, s49, 0
    s_add_u32 s52, s52, 196608
    s_addc_u32 s53, s53, 0
    s_cmp_eq_u32 s87, 0
    s_cselect_b32 s50, s50, 0
    s_cselect_b32 s54, s54, 0
    s_add_u32 s68, s61, 12288
    v_add_u32 v186, s68, v180
    v_add_u32 v187, s68, v181
    ds_read_b64_tr_b16 v[160:161], v188 offset:128
    ds_read_b64_tr_b16 v[162:163], v188 offset:6272
    s_waitcnt lgkmcnt(8)
    v_mfma_f32_16x16x32_bf16 a[0:3], v[144:147], v[132:135], a[0:3]
    v_exp_f32 v228, v72
    v_exp_f32 v229, v73
    v_mfma_f32_16x16x32_bf16 a[4:7], v[144:147], v[136:139], a[4:7]
    v_exp_f32 v230, v74
    v_exp_f32 v231, v75
    v_mfma_f32_16x16x32_bf16 a[8:11], v[144:147], v[140:143], a[8:11]
    v_exp_f32 v232, v84
    ds_read_b64_tr_b16 v[164:165], v189 offset:128
    ds_read_b64_tr_b16 v[166:167], v189 offset:6272
    s_waitcnt lgkmcnt(8)
    v_mfma_f32_16x16x32_bf16 a[12:15], v[148:151], v[132:135], a[12:15]
    v_exp_f32 v233, v85
    v_exp_f32 v234, v86
    v_mfma_f32_16x16x32_bf16 a[16:19], v[148:151], v[136:139], a[16:19]
    v_exp_f32 v235, v87
    v_mfma_f32_16x16x32_bf16 a[20:23], v[148:151], v[140:143], a[20:23]
    v_exp_f32 v236, v76
    v_exp_f32 v237, v77
    ds_read_b64_tr_b16 v[144:145], v190 offset:128
    ds_read_b64_tr_b16 v[146:147], v190 offset:6272
    s_waitcnt lgkmcnt(8)
    v_mfma_f32_16x16x32_bf16 a[24:27], v[152:155], v[132:135], a[24:27]
    v_exp_f32 v238, v78
    v_mfma_f32_16x16x32_bf16 a[28:31], v[152:155], v[136:139], a[28:31]
    v_exp_f32 v239, v79
    v_exp_f32 v240, v88
    v_mfma_f32_16x16x32_bf16 a[32:35], v[152:155], v[140:143], a[32:35]
    v_exp_f32 v241, v89
    ds_read_b64_tr_b16 v[148:149], v191 offset:128
    ds_read_b64_tr_b16 v[150:151], v191 offset:6272
    s_waitcnt lgkmcnt(8)
    v_mfma_f32_16x16x32_bf16 a[36:39], v[156:159], v[132:135], a[36:39]
    v_exp_f32 v242, v90
    v_exp_f32 v243, v91
    v_mfma_f32_16x16x32_bf16 a[40:43], v[156:159], v[136:139], a[40:43]
    v_exp_f32 v244, v80
    v_mfma_f32_16x16x32_bf16 a[44:47], v[156:159], v[140:143], a[44:47]
    v_exp_f32 v245, v81
    v_exp_f32 v246, v82
    ds_read_b64_tr_b16 v[152:153], v188 offset:256
    ds_read_b64_tr_b16 v[154:155], v188 offset:6400
    s_waitcnt lgkmcnt(8)
    v_mfma_f32_16x16x32_bf16 a[48:51], v[160:163], v[132:135], a[48:51]
    v_exp_f32 v247, v83
    v_mfma_f32_16x16x32_bf16 a[52:55], v[160:163], v[136:139], a[52:55]
    v_exp_f32 v248, v92
    v_exp_f32 v249, v93
    v_mfma_f32_16x16x32_bf16 a[56:59], v[160:163], v[140:143], a[56:59]
    v_exp_f32 v250, v94
    ds_read_b64_tr_b16 v[156:157], v189 offset:256
    ds_read_b64_tr_b16 v[158:159], v189 offset:6400
    s_waitcnt lgkmcnt(8)
    v_mfma_f32_16x16x32_bf16 a[60:63], v[164:167], v[132:135], a[60:63]
    v_exp_f32 v251, v95
    v_add_f32 v212, v228, v229
    v_mfma_f32_16x16x32_bf16 a[64:67], v[164:167], v[136:139], a[64:67]
    v_add_f32 v213, v236, v237
    v_mfma_f32_16x16x32_bf16 a[68:71], v[164:167], v[140:143], a[68:71]
    v_add_f32 v214, v244, v245
    v_add_f32 v212, v212, v230
    ds_read_b64_tr_b16 v[160:161], v190 offset:256
    ds_read_b64_tr_b16 v[162:163], v190 offset:6400
    s_waitcnt lgkmcnt(8)
    v_mfma_f32_16x16x32_bf16 a[72:75], v[144:147], v[132:135], a[72:75]
    v_add_f32 v213, v213, v238
    v_add_f32 v214, v214, v246
    v_mfma_f32_16x16x32_bf16 a[76:79], v[144:147], v[136:139], a[76:79]
    v_add_f32 v212, v212, v231
    v_mfma_f32_16x16x32_bf16 a[80:83], v[144:147], v[140:143], a[80:83]
    v_add_f32 v213, v213, v239
    v_add_f32 v214, v214, v247
    ds_read_b64_tr_b16 v[164:165], v191 offset:256
    ds_read_b64_tr_b16 v[166:167], v191 offset:6400
    s_waitcnt lgkmcnt(8)
    v_mfma_f32_16x16x32_bf16 a[84:87], v[148:151], v[132:135], a[84:87]
    v_add_f32 v212, v212, v232
    v_mfma_f32_16x16x32_bf16 a[88:91], v[148:151], v[136:139], a[88:91]
    v_add_f32 v213, v213, v240
    v_add_f32 v214, v214, v248
    v_mfma_f32_16x16x32_bf16 a[92:95], v[148:151], v[140:143], a[92:95]
    v_add_f32 v212, v212, v233
    ds_read_b128 v[144:147], v186 offset:0
    s_waitcnt lgkmcnt(7)
    v_mfma_f32_16x16x32_bf16 a[96:99], v[152:155], v[132:135], a[96:99]
    v_add_f32 v213, v213, v241
    v_add_f32 v214, v214, v249
    v_mfma_f32_16x16x32_bf16 a[100:103], v[152:155], v[136:139], a[100:103]
    v_add_f32 v212, v212, v234
    v_mfma_f32_16x16x32_bf16 a[104:107], v[152:155], v[140:143], a[104:107]
    v_add_f32 v213, v213, v242
    v_add_f32 v214, v214, v250
    ds_read_b128 v[148:151], v187 offset:0
    s_waitcnt lgkmcnt(6)
    v_mfma_f32_16x16x32_bf16 a[108:111], v[156:159], v[132:135], a[108:111]
    v_add_f32 v212, v212, v235
    v_mfma_f32_16x16x32_bf16 a[112:115], v[156:159], v[136:139], a[112:115]
    v_add_f32 v213, v213, v243
    v_add_f32 v214, v214, v251
    v_mfma_f32_16x16x32_bf16 a[116:119], v[156:159], v[140:143], a[116:119]
    v_cmp_gt_f32 s[80:81], v212, s71
    ds_read_b128 v[152:155], v186 offset:128
    s_waitcnt lgkmcnt(5)
    v_mfma_f32_16x16x32_bf16 a[120:123], v[160:163], v[132:135], a[120:123]
    v_cmp_gt_f32 s[82:83], v213, s71
    v_cmp_gt_f32 s[84:85], v214, s71
    v_mfma_f32_16x16x32_bf16 a[124:127], v[160:163], v[136:139], a[124:127]
    s_or_b64 s[80:81], s[80:81], s[82:83]
    v_mfma_f32_16x16x32_bf16 a[128:131], v[160:163], v[140:143], a[128:131]
    s_or_b64 s[80:81], s[80:81], s[84:85]
    s_cbranch_scc1 L_k1_sm_8_slow
L_k1_sm_8_ret:
    ds_read_b128 v[156:159], v187 offset:128
    s_waitcnt lgkmcnt(4)
    v_mfma_f32_16x16x32_bf16 a[132:135], v[164:167], v[132:135], a[132:135]
    v_mfma_f32_16x16x32_bf16 a[136:139], v[164:167], v[136:139], a[136:139]
    v_mfma_f32_16x16x32_bf16 a[140:143], v[164:167], v[140:143], a[140:143]
    ds_read_b128 v[160:163], v186 offset:256
    s_waitcnt lgkmcnt(4)
    v_mfma_f32_16x16x32_bf16 v[96:99], v[144:147], v[0:3], v[168:171]
    s_add_u32 m0, s79, 0
    s_nop 0
    v_mfma_f32_16x16x32_bf16 v[100:103], v[144:147], v[4:7], v[172:175]
    buffer_load_dwordx4 v197, s[48:51], s65 offen nt lds
    v_mfma_f32_16x16x32_bf16 v[104:107], v[144:147], v[8:11], v[176:179]
    s_add_u32 m0, s79, 1024
    ds_read_b128 v[164:167], v187 offset:256
    s_waitcnt lgkmcnt(4)
    v_mfma_f32_16x16x32_bf16 v[96:99], v[148:151], v[12:15], v[96:99]
    s_nop 0
    v_mfma_f32_16x16x32_bf16 v[100:103], v[148:151], v[16:19], v[100:103]
    buffer_load_dwordx4 v198, s[48:51], s65 offen nt lds
    v_mfma_f32_16x16x32_bf16 v[104:107], v[148:151], v[20:23], v[104:107]
    s_add_u32 m0, s79, 2048
    ds_read_b128 v[144:147], v186 offset:6144
    s_waitcnt lgkmcnt(4)
    v_mfma_f32_16x16x32_bf16 v[96:99], v[152:155], v[24:27], v[96:99]
    s_nop 0
    v_mfma_f32_16x16x32_bf16 v[100:103], v[152:155], v[28:31], v[100:103]
    buffer_load_dwordx4 v199, s[48:51], s65 offen nt lds
    v_mfma_f32_16x16x32_bf16 v[104:107], v[152:155], v[32:35], v[104:107]
    s_add_u32 s65, s65, 12288
    ds_read_b128 v[148:151], v187 offset:6144
    s_waitcnt lgkmcnt(4)
    v_mfma_f32_16x16x32_bf16 v[96:99], v[156:159], v[36:39], v[96:99]
    s_add_u32 m0, s79, 12288
    v_mfma_f32_16x16x32_bf16 v[100:103], v[156:159], v[40:43], v[100:103]
    s_nop 0
    v_mfma_f32_16x16x32_bf16 v[104:107], v[156:159], v[44:47], v[104:107]
    buffer_load_dwordx4 v197, s[48:51], s65 offen nt lds
    ds_read_b128 v[152:155], v186 offset:6272
    s_waitcnt lgkmcnt(4)
    v_mfma_f32_16x16x32_bf16 v[96:99], v[160:163], v[48:51], v[96:99]
    s_add_u32 m0, s79, 13312
    v_mfma_f32_16x16x32_bf16 v[100:103], v[160:163], v[52:55], v[100:103]
    s_nop 0
    v_mfma_f32_16x16x32_bf16 v[104:107], v[160:163], v[56:59], v[104:107]
    buffer_load_dwordx4 v198, s[48:51], s65 offen nt lds
    ds_read_b128 v[156:159], v187 offset:6272
    s_waitcnt lgkmcnt(4)
    v_mfma_f32_16x16x32_bf16 v[96:99], v[164:167], v[60:63], v[96:99]
    s_add_u32 m0, s79, 14336
    v_mfma_f32_16x16x32_bf16 v[100:103], v[164:167], v[64:67], v[100:103]
    s_nop 0
    v_mfma_f32_16x16x32_bf16 v[104:107], v[164:167], v[68:71], v[104:107]
    buffer_load_dwordx4 v199, s[48:51], s65 offen nt lds
    ds_read_b128 v[160:163], v186 offset:6400
    s_waitcnt lgkmcnt(4)
    v_mfma_f32_16x16x32_bf16 v[108:111], v[144:147], v[0:3], v[168:171]
    s_add_u32 s65, s65, 12288
    s_add_u32 s79, s79, 24576
    v_mfma_f32_16x16x32_bf16 v[112:115], v[144:147], v[4:7], v[172:175]
    s_cmp_ge_u32 s79, 147456
    v_mfma_f32_16x16x32_bf16 v[116:119], v[144:147], v[8:11], v[176:179]
    s_cselect_b32 s79, s67, s79
    ds_read_b128 v[164:167], v187 offset:6400
    s_waitcnt lgkmcnt(4)
    v_mfma_f32_16x16x32_bf16 v[108:111], v[148:151], v[12:15], v[108:111]
    v_add_f32 v206, v206, v212
    v_mfma_f32_16x16x32_bf16 v[112:115], v[148:151], v[16:19], v[112:115]
    v_add_f32 v207, v207, v213
    v_mfma_f32_16x16x32_bf16 v[116:119], v[148:151], v[20:23], v[116:119]
    v_add_f32 v208, v208, v214
    v_add_u32 v188, s77, v182
    v_add_u32 v189, s77, v183
    v_add_u32 v190, s77, v184
    v_add_u32 v191, s77, v185
    ds_read_b64_tr_b16 v[144:145], v188 offset:0
    ds_read_b64_tr_b16 v[146:147], v188 offset:6144
    s_waitcnt lgkmcnt(5)
    v_mfma_f32_16x16x32_bf16 v[108:111], v[152:155], v[24:27], v[108:111]
    v_cvt_pk_bf16_f32 v120, v228, v229
    v_mfma_f32_16x16x32_bf16 v[112:115], v[152:155], v[28:31], v[112:115]
    v_cvt_pk_bf16_f32 v121, v230, v231
    v_mfma_f32_16x16x32_bf16 v[116:119], v[152:155], v[32:35], v[116:119]
    v_cvt_pk_bf16_f32 v122, v232, v233
    ds_read_b64_tr_b16 v[148:149], v189 offset:0
    ds_read_b64_tr_b16 v[150:151], v189 offset:6144
    s_waitcnt lgkmcnt(6)
    v_mfma_f32_16x16x32_bf16 v[108:111], v[156:159], v[36:39], v[108:111]
    v_cvt_pk_bf16_f32 v123, v234, v235
    v_mfma_f32_16x16x32_bf16 v[112:115], v[156:159], v[40:43], v[112:115]
    v_cvt_pk_bf16_f32 v124, v236, v237
    v_mfma_f32_16x16x32_bf16 v[116:119], v[156:159], v[44:47], v[116:119]
    v_cvt_pk_bf16_f32 v125, v238, v239
    ds_read_b64_tr_b16 v[152:153], v190 offset:0
    ds_read_b64_tr_b16 v[154:155], v190 offset:6144
    s_waitcnt lgkmcnt(7)
    v_mfma_f32_16x16x32_bf16 v[108:111], v[160:163], v[48:51], v[108:111]
    v_cvt_pk_bf16_f32 v126, v240, v241
    v_mfma_f32_16x16x32_bf16 v[112:115], v[160:163], v[52:55], v[112:115]
    v_cvt_pk_bf16_f32 v127, v242, v243
    v_mfma_f32_16x16x32_bf16 v[116:119], v[160:163], v[56:59], v[116:119]
    v_cvt_pk_bf16_f32 v128, v244, v245
    ds_read_b64_tr_b16 v[156:157], v191 offset:0
    ds_read_b64_tr_b16 v[158:159], v191 offset:6144
    s_waitcnt lgkmcnt(8)
    v_mfma_f32_16x16x32_bf16 v[108:111], v[164:167], v[60:63], v[108:111]
    v_cvt_pk_bf16_f32 v129, v246, v247
    v_mfma_f32_16x16x32_bf16 v[112:115], v[164:167], v[64:67], v[112:115]
    v_cvt_pk_bf16_f32 v130, v248, v249
    v_mfma_f32_16x16x32_bf16 v[116:119], v[164:167], v[68:71], v[116:119]
    v_cvt_pk_bf16_f32 v131, v250, v251
    s_cmp_eq_u32 s72, 0
    s_cbranch_scc1 L_k1_rs_9_skip
    s_nop 7
    v_accvgpr_read_b32 v212, a0
    v_accvgpr_read_b32 v213, a1
    v_accvgpr_read_b32 v214, a2
    v_accvgpr_read_b32 v215, a3
    v_accvgpr_read_b32 v216, a4
    v_accvgpr_read_b32 v217, a5
    v_accvgpr_read_b32 v218, a6
    v_accvgpr_read_b32 v219, a7
    v_mul_f32 v212, v212, v209
    v_mul_f32 v213, v213, v209
    v_mul_f32 v214, v214, v209
    v_mul_f32 v215, v215, v209
    v_mul_f32 v216, v216, v210
    v_mul_f32 v217, v217, v210
    v_mul_f32 v218, v218, v210
    v_mul_f32 v219, v219, v210
    v_accvgpr_write_b32 a0, v212
    v_accvgpr_write_b32 a1, v213
    v_accvgpr_write_b32 a2, v214
    v_accvgpr_write_b32 a3, v215
    v_accvgpr_write_b32 a4, v216
    v_accvgpr_write_b32 a5, v217
    v_accvgpr_write_b32 a6, v218
    v_accvgpr_write_b32 a7, v219
    v_accvgpr_read_b32 v212, a8
    v_accvgpr_read_b32 v213, a9
    v_accvgpr_read_b32 v214, a10
    v_accvgpr_read_b32 v215, a11
    v_accvgpr_read_b32 v216, a12
    v_accvgpr_read_b32 v217, a13
    v_accvgpr_read_b32 v218, a14
    v_accvgpr_read_b32 v219, a15
    v_mul_f32 v212, v212, v211
    v_mul_f32 v213, v213, v211
    v_mul_f32 v214, v214, v211
    v_mul_f32 v215, v215, v211
    v_mul_f32 v216, v216, v209
    v_mul_f32 v217, v217, v209
    v_mul_f32 v218, v218, v209
    v_mul_f32 v219, v219, v209
    v_accvgpr_write_b32 a8, v212
    v_accvgpr_write_b32 a9, v213
    v_accvgpr_write_b32 a10, v214
    v_accvgpr_write_b32 a11, v215
    v_accvgpr_write_b32 a12, v216
    v_accvgpr_write_b32 a13, v217
    v_accvgpr_write_b32 a14, v218
    v_accvgpr_write_b32 a15, v219
    v_accvgpr_read_b32 v212, a16
    v_accvgpr_read_b32 v213, a17
    v_accvgpr_read_b32 v214, a18
    v_accvgpr_read_b32 v215, a19
    v_accvgpr_read_b32 v216, a20
    v_accvgpr_read_b32 v217, a21
    v_accvgpr_read_b32 v218, a22
    v_accvgpr_read_b32 v219, a23
    v_mul_f32 v212, v212, v210
    v_mul_f32 v213, v213, v210
    v_mul_f32 v214, v214, v210
    v_mul_f32 v215, v215, v210
    v_mul_f32 v216, v216, v211
    v_mul_f32 v217, v217, v211
    v_mul_f32 v218, v218, v211
    v_mul_f32 v219, v219, v211
    v_accvgpr_write_b32 a16, v212
    v_accvgpr_write_b32 a17, v213
    v_accvgpr_write_b32 a18, v214
    v_accvgpr_write_b32 a19, v215
    v_accvgpr_write_b32 a20, v216
    v_accvgpr_write_b32 a21, v217
    v_accvgpr_write_b32 a22, v218
    v_accvgpr_write_b32 a23, v219
    v_accvgpr_read_b32 v212, a24
    v_accvgpr_read_b32 v213, a25
    v_accvgpr_read_b32 v214, a26
    v_accvgpr_read_b32 v215, a27
    v_accvgpr_read_b32 v216, a28
    v_accvgpr_read_b32 v217, a29
    v_accvgpr_read_b32 v218, a30
    v_accvgpr_read_b32 v219, a31
    v_mul_f32 v212, v212, v209
    v_mul_f32 v213, v213, v209
    v_mul_f32 v214, v214, v209
    v_mul_f32 v215, v215, v209
    v_mul_f32 v216, v216, v210
    v_mul_f32 v217, v217, v210
    v_mul_f32 v218, v218, v210
    v_mul_f32 v219, v219, v210
    v_accvgpr_write_b32 a24, v212
    v_accvgpr_write_b32 a25, v213
    v_accvgpr_write_b32 a26, v214
    v_accvgpr_write_b32 a27, v215
    v_accvgpr_write_b32 a28, v216
    v_accvgpr_write_b32 a29, v217
    v_accvgpr_write_b32 a30, v218
    v_accvgpr_write_b32 a31, v219
    v_accvgpr_read_b32 v212, a32
    v_accvgpr_read_b32 v213, a33
    v_accvgpr_read_b32 v214, a34
    v_accvgpr_read_b32 v215, a35
    v_accvgpr_read_b32 v216, a36
    v_accvgpr_read_b32 v217, a37
    v_accvgpr_read_b32 v218, a38
    v_accvgpr_read_b32 v219, a39
    v_mul_f32 v212, v212, v211
    v_mul_f32 v213, v213, v211
    v_mul_f32 v214, v214, v211
    v_mul_f32 v215, v215, v211
    v_mul_f32 v216, v216, v209
    v_mul_f32 v217, v217, v209
    v_mul_f32 v218, v218, v209
    v_mul_f32 v219, v219, v209
    v_accvgpr_write_b32 a32, v212
    v_accvgpr_write_b32 a33, v213
    v_accvgpr_write_b32 a34, v214
    v_accvgpr_write_b32 a35, v215
    v_accvgpr_write_b32 a36, v216
    v_accvgpr_write_b32 a37, v217
    v_accvgpr_write_b32 a38, v218
    v_accvgpr_write_b32 a39, v219
    v_accvgpr_read_b32 v212, a40
    v_accvgpr_read_b32 v213, a41
    v_accvgpr_read_b32 v214, a42
    v_accvgpr_read_b32 v215, a43
    v_accvgpr_read_b32 v216, a44
    v_accvgpr_read_b32 v217, a45
    v_accvgpr_read_b32 v218, a46
    v_accvgpr_read_b32 v219, a47
    v_mul_f32 v212, v212, v210
    v_mul_f32 v213, v213, v210
    v_mul_f32 v214, v214, v210
    v_mul_f32 v215, v215, v210
    v_mul_f32 v216, v216, v211
    v_mul_f32 v217, v217, v211
    v_mul_f32 v218, v218, v211
    v_mul_f32 v219, v219, v211
    v_accvgpr_write_b32 a40, v212
    v_accvgpr_write_b32 a41, v213
    v_accvgpr_write_b32 a42, v214
    v_accvgpr_write_b32 a43, v215
    v_accvgpr_write_b32 a44, v216
    v_accvgpr_write_b32 a45, v217
    v_accvgpr_write_b32 a46, v218
    v_accvgpr_write_b32 a47, v219
    v_accvgpr_read_b32 v212, a48
    v_accvgpr_read_b32 v213, a49
    v_accvgpr_read_b32 v214, a50
    v_accvgpr_read_b32 v215, a51
    v_accvgpr_read_b32 v216, a52
    v_accvgpr_read_b32 v217, a53
    v_accvgpr_read_b32 v218, a54
    v_accvgpr_read_b32 v219, a55
    v_mul_f32 v212, v212, v209
    v_mul_f32 v213, v213, v209
    v_mul_f32 v214, v214, v209
    v_mul_f32 v215, v215, v209
    v_mul_f32 v216, v216, v210
    v_mul_f32 v217, v217, v210
    v_mul_f32 v218, v218, v210
    v_mul_f32 v219, v219, v210
    v_accvgpr_write_b32 a48, v212
    v_accvgpr_write_b32 a49, v213
    v_accvgpr_write_b32 a50, v214
    v_accvgpr_write_b32 a51, v215
    v_accvgpr_write_b32 a52, v216
    v_accvgpr_write_b32 a53, v217
    v_accvgpr_write_b32 a54, v218
    v_accvgpr_write_b32 a55, v219
    v_accvgpr_read_b32 v212, a56
    v_accvgpr_read_b32 v213, a57
    v_accvgpr_read_b32 v214, a58
    v_accvgpr_read_b32 v215, a59
    v_accvgpr_read_b32 v216, a60
    v_accvgpr_read_b32 v217, a61
    v_accvgpr_read_b32 v218, a62
    v_accvgpr_read_b32 v219, a63
    v_mul_f32 v212, v212, v211
    v_mul_f32 v213, v213, v211
    v_mul_f32 v214, v214, v211
    v_mul_f32 v215, v215, v211
    v_mul_f32 v216, v216, v209
    v_mul_f32 v217, v217, v209
    v_mul_f32 v218, v218, v209
    v_mul_f32 v219, v219, v209
    v_accvgpr_write_b32 a56, v212
    v_accvgpr_write_b32 a57, v213
    v_accvgpr_write_b32 a58, v214
    v_accvgpr_write_b32 a59, v215
    v_accvgpr_write_b32 a60, v216
    v_accvgpr_write_b32 a61, v217
    v_accvgpr_write_b32 a62, v218
    v_accvgpr_write_b32 a63, v219
    v_accvgpr_read_b32 v212, a64
    v_accvgpr_read_b32 v213, a65
    v_accvgpr_read_b32 v214, a66
    v_accvgpr_read_b32 v215, a67
    v_accvgpr_read_b32 v216, a68
    v_accvgpr_read_b32 v217, a69
    v_accvgpr_read_b32 v218, a70
    v_accvgpr_read_b32 v219, a71
    v_mul_f32 v212, v212, v210
    v_mul_f32 v213, v213, v210
    v_mul_f32 v214, v214, v210
    v_mul_f32 v215, v215, v210
    v_mul_f32 v216, v216, v211
    v_mul_f32 v217, v217, v211
    v_mul_f32 v218, v218, v211
    v_mul_f32 v219, v219, v211
    v_accvgpr_write_b32 a64, v212
    v_accvgpr_write_b32 a65, v213
    v_accvgpr_write_b32 a66, v214
    v_accvgpr_write_b32 a67, v215
    v_accvgpr_write_b32 a68, v216
    v_accvgpr_write_b32 a69, v217
    v_accvgpr_write_b32 a70, v218
    v_accvgpr_write_b32 a71, v219
    v_accvgpr_read_b32 v212, a72
    v_accvgpr_read_b32 v213, a73
    v_accvgpr_read_b32 v214, a74
    v_accvgpr_read_b32 v215, a75
    v_accvgpr_read_b32 v216, a76
    v_accvgpr_read_b32 v217, a77
    v_accvgpr_read_b32 v218, a78
    v_accvgpr_read_b32 v219, a79
    v_mul_f32 v212, v212, v209
    v_mul_f32 v213, v213, v209
    v_mul_f32 v214, v214, v209
    v_mul_f32 v215, v215, v209
    v_mul_f32 v216, v216, v210
    v_mul_f32 v217, v217, v210
    v_mul_f32 v218, v218, v210
    v_mul_f32 v219, v219, v210
    v_accvgpr_write_b32 a72, v212
    v_accvgpr_write_b32 a73, v213
    v_accvgpr_write_b32 a74, v214
    v_accvgpr_write_b32 a75, v215
    v_accvgpr_write_b32 a76, v216
    v_accvgpr_write_b32 a77, v217
    v_accvgpr_write_b32 a78, v218
    v_accvgpr_write_b32 a79, v219
    v_accvgpr_read_b32 v212, a80
    v_accvgpr_read_b32 v213, a81
    v_accvgpr_read_b32 v214, a82
    v_accvgpr_read_b32 v215, a83
    v_accvgpr_read_b32 v216, a84
    v_accvgpr_read_b32 v217, a85
    v_accvgpr_read_b32 v218, a86
    v_accvgpr_read_b32 v219, a87
    v_mul_f32 v212, v212, v211
    v_mul_f32 v213, v213, v211
    v_mul_f32 v214, v214, v211
    v_mul_f32 v215, v215, v211
    v_mul_f32 v216, v216, v209
    v_mul_f32 v217, v217, v209
    v_mul_f32 v218, v218, v209
    v_mul_f32 v219, v219, v209
    v_accvgpr_write_b32 a80, v212
    v_accvgpr_write_b32 a81, v213
    v_accvgpr_write_b32 a82, v214
    v_accvgpr_write_b32 a83, v215
    v_accvgpr_write_b32 a84, v216
    v_accvgpr_write_b32 a85, v217
    v_accvgpr_write_b32 a86, v218
    v_accvgpr_write_b32 a87, v219
    v_accvgpr_read_b32 v212, a88
    v_accvgpr_read_b32 v213, a89
    v_accvgpr_read_b32 v214, a90
    v_accvgpr_read_b32 v215, a91
    v_accvgpr_read_b32 v216, a92
    v_accvgpr_read_b32 v217, a93
    v_accvgpr_read_b32 v218, a94
    v_accvgpr_read_b32 v219, a95
    v_mul_f32 v212, v212, v210
    v_mul_f32 v213, v213, v210
    v_mul_f32 v214, v214, v210
    v_mul_f32 v215, v215, v210
    v_mul_f32 v216, v216, v211
    v_mul_f32 v217, v217, v211
    v_mul_f32 v218, v218, v211
    v_mul_f32 v219, v219, v211
    v_accvgpr_write_b32 a88, v212
    v_accvgpr_write_b32 a89, v213
    v_accvgpr_write_b32 a90, v214
    v_accvgpr_write_b32 a91, v215
    v_accvgpr_write_b32 a92, v216
    v_accvgpr_write_b32 a93, v217
    v_accvgpr_write_b32 a94, v218
    v_accvgpr_write_b32 a95, v219
    v_accvgpr_read_b32 v212, a96
    v_accvgpr_read_b32 v213, a97
    v_accvgpr_read_b32 v214, a98
    v_accvgpr_read_b32 v215, a99
    v_accvgpr_read_b32 v216, a100
    v_accvgpr_read_b32 v217, a101
    v_accvgpr_read_b32 v218, a102
    v_accvgpr_read_b32 v219, a103
    v_mul_f32 v212, v212, v209
    v_mul_f32 v213, v213, v209
    v_mul_f32 v214, v214, v209
    v_mul_f32 v215, v215, v209
    v_mul_f32 v216, v216, v210
    v_mul_f32 v217, v217, v210
    v_mul_f32 v218, v218, v210
    v_mul_f32 v219, v219, v210
    v_accvgpr_write_b32 a96, v212
    v_accvgpr_write_b32 a97, v213
    v_accvgpr_write_b32 a98, v214
    v_accvgpr_write_b32 a99, v215
    v_accvgpr_write_b32 a100, v216
    v_accvgpr_write_b32 a101, v217
    v_accvgpr_write_b32 a102, v218
    v_accvgpr_write_b32 a103, v219
    v_accvgpr_read_b32 v212, a104
    v_accvgpr_read_b32 v213, a105
    v_accvgpr_read_b32 v214, a106
    v_accvgpr_read_b32 v215, a107
    v_accvgpr_read_b32 v216, a108
    v_accvgpr_read_b32 v217, a109
    v_accvgpr_read_b32 v218, a110
    v_accvgpr_read_b32 v219, a111
    v_mul_f32 v212, v212, v211
    v_mul_f32 v213, v213, v211
    v_mul_f32 v214, v214, v211
    v_mul_f32 v215, v215, v211
    v_mul_f32 v216, v216, v209
    v_mul_f32 v217, v217, v209
    v_mul_f32 v218, v218, v209
    v_mul_f32 v219, v219, v209
    v_accvgpr_write_b32 a104, v212
    v_accvgpr_write_b32 a105, v213
    v_accvgpr_write_b32 a106, v214
    v_accvgpr_write_b32 a107, v215
    v_accvgpr_write_b32 a108, v216
    v_accvgpr_write_b32 a109, v217
    v_accvgpr_write_b32 a110, v218
    v_accvgpr_write_b32 a111, v219
    v_accvgpr_read_b32 v212, a112
    v_accvgpr_read_b32 v213, a113
    v_accvgpr_read_b32 v214, a114
    v_accvgpr_read_b32 v215, a115
    v_accvgpr_read_b32 v216, a116
    v_accvgpr_read_b32 v217, a117
    v_accvgpr_read_b32 v218, a118
    v_accvgpr_read_b32 v219, a119
    v_mul_f32 v212, v212, v210
    v_mul_f32 v213, v213, v210
    v_mul_f32 v214, v214, v210
    v_mul_f32 v215, v215, v210
    v_mul_f32 v216, v216, v211
    v_mul_f32 v217, v217, v211
    v_mul_f32 v218, v218, v211
    v_mul_f32 v219, v219, v211
    v_accvgpr_write_b32 a112, v212
    v_accvgpr_write_b32 a113, v213
    v_accvgpr_write_b32 a114, v214
    v_accvgpr_write_b32 a115, v215
    v_accvgpr_write_b32 a116, v216
    v_accvgpr_write_b32 a117, v217
    v_accvgpr_write_b32 a118, v218
    v_accvgpr_write_b32 a119, v219
    v_accvgpr_read_b32 v212, a120
    v_accvgpr_read_b32 v213, a121
    v_accvgpr_read_b32 v214, a122
    v_accvgpr_read_b32 v215, a123
    v_accvgpr_read_b32 v216, a124
    v_accvgpr_read_b32 v217, a125
    v_accvgpr_read_b32 v218, a126
    v_accvgpr_read_b32 v219, a127
    v_mul_f32 v212, v212, v209
    v_mul_f32 v213, v213, v209
    v_mul_f32 v214, v214, v209
    v_mul_f32 v215, v215, v209
    v_mul_f32 v216, v216, v210
    v_mul_f32 v217, v217, v210
    v_mul_f32 v218, v218, v210
    v_mul_f32 v219, v219, v210
    v_accvgpr_write_b32 a120, v212
    v_accvgpr_write_b32 a121, v213
    v_accvgpr_write_b32 a122, v214
    v_accvgpr_write_b32 a123, v215
    v_accvgpr_write_b32 a124, v216
    v_accvgpr_write_b32 a125, v217
    v_accvgpr_write_b32 a126, v218
    v_accvgpr_write_b32 a127, v219
    v_accvgpr_read_b32 v212, a128
    v_accvgpr_read_b32 v213, a129
    v_accvgpr_read_b32 v214, a130
    v_accvgpr_read_b32 v215, a131
    v_accvgpr_read_b32 v216, a132
    v_accvgpr_read_b32 v217, a133
    v_accvgpr_read_b32 v218, a134
    v_accvgpr_read_b32 v219, a135
    v_mul_f32 v212, v212, v211
    v_mul_f32 v213, v213, v211
    v_mul_f32 v214, v214, v211
    v_mul_f32 v215, v215, v211
    v_mul_f32 v216, v216, v209
    v_mul_f32 v217, v217, v209
    v_mul_f32 v218, v218, v209
    v_mul_f32 v219, v219, v209
    v_accvgpr_write_b32 a128, v212
    v_accvgpr_write_b32 a129, v213
    v_accvgpr_write_b32 a130, v214
    v_accvgpr_write_b32 a131, v215
    v_accvgpr_write_b32 a132, v216
    v_accvgpr_write_b32 a133, v217
    v_accvgpr_write_b32 a134, v218
    v_accvgpr_write_b32 a135, v219
    v_accvgpr_read_b32 v212, a136
    v_accvgpr_read_b32 v213, a137
    v_accvgpr_read_b32 v214, a138
    v_accvgpr_read_b32 v215, a139
    v_accvgpr_read_b32 v216, a140
    v_accvgpr_read_b32 v217, a141
    v_accvgpr_read_b32 v218, a142
    v_accvgpr_read_b32 v219, a143
    v_mul_f32 v212, v212, v210
    v_mul_f32 v213, v213, v210
    v_mul_f32 v214, v214, v210
    v_mul_f32 v215, v215, v210
    v_mul_f32 v216, v216, v211
    v_mul_f32 v217, v217, v211
    v_mul_f32 v218, v218, v211
    v_mul_f32 v219, v219, v211
    v_accvgpr_write_b32 a136, v212
    v_accvgpr_write_b32 a137, v213
    v_accvgpr_write_b32 a138, v214
    v_accvgpr_write_b32 a139, v215
    v_accvgpr_write_b32 a140, v216
    v_accvgpr_write_b32 a141, v217
    v_accvgpr_write_b32 a142, v218
    v_accvgpr_write_b32 a143, v219
    s_mov_b32 s72, 0
    s_nop 1
L_k1_rs_9_skip:
    s_mov_b32 s61, s77
    s_waitcnt vmcnt(18)
    s_barrier
    s_add_u32 s77, s61, 24576
    s_cmp_eq_u32 s77, 147456
    s_cselect_b32 s77, 0, s77
    s_add_u32 s68, s61, 12288
    v_add_u32 v186, s68, v180
    v_add_u32 v187, s68, v181
    ds_read_b64_tr_b16 v[160:161], v188 offset:128
    ds_read_b64_tr_b16 v[162:163], v188 offset:6272
    s_waitcnt lgkmcnt(8)
    v_mfma_f32_16x16x32_bf16 a[0:3], v[144:147], v[120:123], a[0:3]
    v_exp_f32 v228, v96
    v_exp_f32 v229, v97
    v_mfma_f32_16x16x32_bf16 a[4:7], v[144:147], v[124:127], a[4:7]
    v_exp_f32 v230, v98
    v_exp_f32 v231, v99
    v_mfma_f32_16x16x32_bf16 a[8:11], v[144:147], v[128:131], a[8:11]
    v_exp_f32 v232, v108
    ds_read_b64_tr_b16 v[164:165], v189 offset:128
    ds_read_b64_tr_b16 v[166:167], v189 offset:6272
    s_waitcnt lgkmcnt(8)
    v_mfma_f32_16x16x32_bf16 a[12:15], v[148:151], v[120:123], a[12:15]
    v_exp_f32 v233, v109
    v_exp_f32 v234, v110
    v_mfma_f32_16x16x32_bf16 a[16:19], v[148:151], v[124:127], a[16:19]
    v_exp_f32 v235, v111
    v_mfma_f32_16x16x32_bf16 a[20:23], v[148:151], v[128:131], a[20:23]
    v_exp_f32 v236, v100
    v_exp_f32 v237, v101
    ds_read_b64_tr_b16 v[144:145], v190 offset:128
    ds_read_b64_tr_b16 v[146:147], v190 offset:6272
    s_waitcnt lgkmcnt(8)
    v_mfma_f32_16x16x32_bf16 a[24:27], v[152:155], v[120:123], a[24:27]
    v_exp_f32 v238, v102
    v_mfma_f32_16x16x32_bf16 a[28:31], v[152:155], v[124:127], a[28:31]
    v_exp_f32 v239, v103
    v_exp_f32 v240, v112
    v_mfma_f32_16x16x32_bf16 a[32:35], v[152:155], v[128:131], a[32:35]
    v_exp_f32 v241, v113
    ds_read_b64_tr_b16 v[148:149], v191 offset:128
    ds_read_b64_tr_b16 v[150:151], v191 offset:6272
    s_waitcnt lgkmcnt(8)
    v_mfma_f32_16x16x32_bf16 a[36:39], v[156:159], v[120:123], a[36:39]
    v_exp_f32 v242, v114
    v_exp_f32 v243, v115
    v_mfma_f32_16x16x32_bf16 a[40:43], v[156:159], v[124:127], a[40:43]
    v_exp_f32 v244, v104
    v_mfma_f32_16x16x32_bf16 a[44:47], v[156:159], v[128:131], a[44:47]
    v_exp_f32 v245, v105
    v_exp_f32 v246, v106
    ds_read_b64_tr_b16 v[152:153], v188 offset:256
    ds_read_b64_tr_b16 v[154:155], v188 offset:6400
    s_waitcnt lgkmcnt(8)
    v_mfma_f32_16x16x32_bf16 a[48:51], v[160:163], v[120:123], a[48:51]
    v_exp_f32 v247, v107
    v_mfma_f32_16x16x32_bf16 a[52:55], v[160:163], v[124:127], a[52:55]
    v_exp_f32 v248, v116
    v_exp_f32 v249, v117
    v_mfma_f32_16x16x32_bf16 a[56:59], v[160:163], v[128:131], a[56:59]
    v_exp_f32 v250, v118
    ds_read_b64_tr_b16 v[156:157], v189 offset:256
    ds_read_b64_tr_b16 v[158:159], v189 offset:6400
    s_waitcnt lgkmcnt(8)
    v_mfma_f32_16x16x32_bf16 a[60:63], v[164:167], v[120:123], a[60:63]
    v_exp_f32 v251, v119
    v_add_f32 v212, v228, v229
    v_mfma_f32_16x16x32_bf16 a[64:67], v[164:167], v[124:127], a[64:67]
    v_add_f32 v213, v236, v237
    v_mfma_f32_16x16x32_bf16 a[68:71], v[164:167], v[128:131], a[68:71]
    v_add_f32 v214, v244, v245
    v_add_f32 v212, v212, v230
    ds_read_b64_tr_b16 v[160:161], v190 offset:256
    ds_read_b64_tr_b16 v[162:163], v190 offset:6400
    s_waitcnt lgkmcnt(8)
    v_mfma_f32_16x16x32_bf16 a[72:75], v[144:147], v[120:123], a[72:75]
    v_add_f32 v213, v213, v238
    v_add_f32 v214, v214, v246
    v_mfma_f32_16x16x32_bf16 a[76:79], v[144:147], v[124:127], a[76:79]
    v_add_f32 v212, v212, v231
    v_mfma_f32_16x16x32_bf16 a[80:83], v[144:147], v[128:131], a[80:83]
    v_add_f32 v213, v213, v239
    v_add_f32 v214, v214, v247
    ds_read_b64_tr_b16 v[164:165], v191 offset:256
    ds_read_b64_tr_b16 v[166:167], v191 offset:6400
    s_waitcnt lgkmcnt(8)
    v_mfma_f32_16x16x32_bf16 a[84:87], v[148:151], v[120:123], a[84:87]
    v_add_f32 v212, v212, v232
    v_mfma_f32_16x16x32_bf16 a[88:91], v[148:151], v[124:127], a[88:91]
    v_add_f32 v213, v213, v240
    v_add_f32 v214, v214, v248
    v_mfma_f32_16x16x32_bf16 a[92:95], v[148:151], v[128:131], a[92:95]
    v_add_f32 v212, v212, v233
    ds_read_b128 v[144:147], v186 offset:0
    s_waitcnt lgkmcnt(7)
    v_mfma_f32_16x16x32_bf16 a[96:99], v[152:155], v[120:123], a[96:99]
    v_add_f32 v213, v213, v241
    v_add_f32 v214, v214, v249
    v_mfma_f32_16x16x32_bf16 a[100:103], v[152:155], v[124:127], a[100:103]
    v_add_f32 v212, v212, v234
    v_mfma_f32_16x16x32_bf16 a[104:107], v[152:155], v[128:131], a[104:107]
    v_add_f32 v213, v213, v242
    v_add_f32 v214, v214, v250
    ds_read_b128 v[148:151], v187 offset:0
    s_waitcnt lgkmcnt(6)
    v_mfma_f32_16x16x32_bf16 a[108:111], v[156:159], v[120:123], a[108:111]
    v_add_f32 v212, v212, v235
    v_mfma_f32_16x16x32_bf16 a[112:115], v[156:159], v[124:127], a[112:115]
    v_add_f32 v213, v213, v243
    v_add_f32 v214, v214, v251
    v_mfma_f32_16x16x32_bf16 a[116:119], v[156:159], v[128:131], a[116:119]
    v_cmp_gt_f32 s[80:81], v212, s71
    ds_read_b128 v[152:155], v186 offset:128
    s_waitcnt lgkmcnt(5)
    v_mfma_f32_16x16x32_bf16 a[120:123], v[160:163], v[120:123], a[120:123]
    v_cmp_gt_f32 s[82:83], v213, s71
    v_cmp_gt_f32 s[84:85], v214, s71
    v_mfma_f32_16x16x32_bf16 a[124:127], v[160:163], v[124:127], a[124:127]
    s_or_b64 s[80:81], s[80:81], s[82:83]
    v_mfma_f32_16x16x32_bf16 a[128:131], v[160:163], v[128:131], a[128:131]
    s_or_b64 s[80:81], s[80:81], s[84:85]
    s_cbranch_scc1 L_k1_sm_10_slow
L_k1_sm_10_ret:
    ds_read_b128 v[156:159], v187 offset:128
    s_waitcnt lgkmcnt(4)
    v_mfma_f32_16x16x32_bf16 a[132:135], v[164:167], v[120:123], a[132:135]
    v_mfma_f32_16x16x32_bf16 a[136:139], v[164:167], v[124:127], a[136:139]
    v_mfma_f32_16x16x32_bf16 a[140:143], v[164:167], v[128:131], a[140:143]
    ds_read_b128 v[160:163], v186 offset:256
    s_waitcnt lgkmcnt(4)
    v_mfma_f32_16x16x32_bf16 v[72:75], v[144:147], v[0:3], v[168:171]
    s_add_u32 m0, s79, 0
    s_nop 0
    v_mfma_f32_16x16x32_bf16 v[76:79], v[144:147], v[4:7], v[172:175]
    buffer_load_dwordx4 v197, s[52:55], s66 offen nt lds
    v_mfma_f32_16x16x32_bf16 v[80:83], v[144:147], v[8:11], v[176:179]
    s_add_u32 m0, s79, 1024
    ds_read_b128 v[164:167], v187 offset:256
    s_waitcnt lgkmcnt(4)
    v_mfma_f32_16x16x32_bf16 v[72:75], v[148:151], v[12:15], v[72:75]
    s_nop 0
    v_mfma_f32_16x16x32_bf16 v[76:79], v[148:151], v[16:19], v[76:79]
    buffer_load_dwordx4 v198, s[52:55], s66 offen nt lds
    v_mfma_f32_16x16x32_bf16 v[80:83], v[148:151], v[20:23], v[80:83]
    s_add_u32 m0, s79, 2048
    ds_read_b128 v[144:147], v186 offset:6144
    s_waitcnt lgkmcnt(4)
    v_mfma_f32_16x16x32_bf16 v[72:75], v[152:155], v[24:27], v[72:75]
    s_nop 0
    v_mfma_f32_16x16x32_bf16 v[76:79], v[152:155], v[28:31], v[76:79]
    buffer_load_dwordx4 v199, s[52:55], s66 offen nt lds
    v_mfma_f32_16x16x32_bf16 v[80:83], v[152:155], v[32:35], v[80:83]
    s_add_u32 m0, s79, 12288
    ds_read_b128 v[148:151], v187 offset:6144
    s_waitcnt lgkmcnt(4)
    v_mfma_f32_16x16x32_bf16 v[72:75], v[156:159], v[36:39], v[72:75]
    s_nop 0
    v_mfma_f32_16x16x32_bf16 v[76:79], v[156:159], v[40:43], v[76:79]
    buffer_load_dwordx4 v197, s[48:51], s65 offen nt lds
    v_mfma_f32_16x16x32_bf16 v[80:83], v[156:159], v[44:47], v[80:83]
    s_add_u32 m0, s79, 13312
    ds_read_b128 v[152:155], v186 offset:6272
    s_waitcnt lgkmcnt(4)
    v_mfma_f32_16x16x32_bf16 v[72:75], v[160:163], v[48:51], v[72:75]
    s_nop 0
    v_mfma_f32_16x16x32_bf16 v[76:79], v[160:163], v[52:55], v[76:79]
    buffer_load_dwordx4 v198, s[48:51], s65 offen nt lds
    v_mfma_f32_16x16x32_bf16 v[80:83], v[160:163], v[56:59], v[80:83]
    s_add_u32 m0, s79, 14336
    ds_read_b128 v[156:159], v187 offset:6272
    s_waitcnt lgkmcnt(4)
    v_mfma_f32_16x16x32_bf16 v[72:75], v[164:167], v[60:63], v[72:75]
    s_nop 0
    v_mfma_f32_16x16x32_bf16 v[76:79], v[164:167], v[64:67], v[76:79]
    buffer_load_dwordx4 v199, s[48:51], s65 offen nt lds
    v_mfma_f32_16x16x32_bf16 v[80:83], v[164:167], v[68:71], v[80:83]
    s_add_u32 s66, s66, 12288
    ds_read_b128 v[160:163], v186 offset:6400
    s_waitcnt lgkmcnt(4)
    v_mfma_f32_16x16x32_bf16 v[84:87], v[144:147], v[0:3], v[168:171]
    s_add_u32 s65, s65, 12288
    s_add_u32 s79, s79, 24576
    v_mfma_f32_16x16x32_bf16 v[88:91], v[144:147], v[4:7], v[172:175]
    s_cmp_ge_u32 s79, 147456
    v_mfma_f32_16x16x32_bf16 v[92:95], v[144:147], v[8:11], v[176:179]
    s_cselect_b32 s79, s67, s79
    ds_read_b128 v[164:167], v187 offset:6400
    s_waitcnt lgkmcnt(4)
    v_mfma_f32_16x16x32_bf16 v[84:87], v[148:151], v[12:15], v[84:87]
    v_add_f32 v206, v206, v212
    v_mfma_f32_16x16x32_bf16 v[88:91], v[148:151], v[16:19], v[88:91]
    v_add_f32 v207, v207, v213
    v_mfma_f32_16x16x32_bf16 v[92:95], v[148:151], v[20:23], v[92:95]
    v_add_f32 v208, v208, v214
    v_add_u32 v188, s77, v182
    v_add_u32 v189, s77, v183
    v_add_u32 v190, s77, v184
    v_add_u32 v191, s77, v185
    ds_read_b64_tr_b16 v[144:145], v188 offset:0
    ds_read_b64_tr_b16 v[146:147], v188 offset:6144
    s_waitcnt lgkmcnt(5)
    v_mfma_f32_16x16x32_bf16 v[84:87], v[152:155], v[24:27], v[84:87]
    v_cvt_pk_bf16_f32 v132, v228, v229
    v_mfma_f32_16x16x32_bf16 v[88:91], v[152:155], v[28:31], v[88:91]
    v_cvt_pk_bf16_f32 v133, v230, v231
    v_mfma_f32_16x16x32_bf16 v[92:95], v[152:155], v[32:35], v[92:95]
    v_cvt_pk_bf16_f32 v134, v232, v233
    ds_read_b64_tr_b16 v[148:149], v189 offset:0
    ds_read_b64_tr_b16 v[150:151], v189 offset:6144
    s_waitcnt lgkmcnt(6)
    v_mfma_f32_16x16x32_bf16 v[84:87], v[156:159], v[36:39], v[84:87]
    v_cvt_pk_bf16_f32 v135, v234, v235
    v_mfma_f32_16x16x32_bf16 v[88:91], v[156:159], v[40:43], v[88:91]
    v_cvt_pk_bf16_f32 v136, v236, v237
    v_mfma_f32_16x16x32_bf16 v[92:95], v[156:159], v[44:47], v[92:95]
    v_cvt_pk_bf16_f32 v137, v238, v239
    ds_read_b64_tr_b16 v[152:153], v190 offset:0
    ds_read_b64_tr_b16 v[154:155], v190 offset:6144
    s_waitcnt lgkmcnt(7)
    v_mfma_f32_16x16x32_bf16 v[84:87], v[160:163], v[48:51], v[84:87]
    v_cvt_pk_bf16_f32 v138, v240, v241
    v_mfma_f32_16x16x32_bf16 v[88:91], v[160:163], v[52:55], v[88:91]
    v_cvt_pk_bf16_f32 v139, v242, v243
    v_mfma_f32_16x16x32_bf16 v[92:95], v[160:163], v[56:59], v[92:95]
    v_cvt_pk_bf16_f32 v140, v244, v245
    ds_read_b64_tr_b16 v[156:157], v191 offset:0
    ds_read_b64_tr_b16 v[158:159], v191 offset:6144
    s_waitcnt lgkmcnt(8)
    v_mfma_f32_16x16x32_bf16 v[84:87], v[164:167], v[60:63], v[84:87]
    v_cvt_pk_bf16_f32 v141, v246, v247
    v_mfma_f32_16x16x32_bf16 v[88:91], v[164:167], v[64:67], v[88:91]
    v_cvt_pk_bf16_f32 v142, v248, v249
    v_mfma_f32_16x16x32_bf16 v[92:95], v[164:167], v[68:71], v[92:95]
    v_cvt_pk_bf16_f32 v143, v250, v251
    s_cmp_eq_u32 s72, 0
    s_cbranch_scc1 L_k1_rs_11_skip
    s_nop 7
    v_accvgpr_read_b32 v212, a0
    v_accvgpr_read_b32 v213, a1
    v_accvgpr_read_b32 v214, a2
    v_accvgpr_read_b32 v215, a3
    v_accvgpr_read_b32 v216, a4
    v_accvgpr_read_b32 v217, a5
    v_accvgpr_read_b32 v218, a6
    v_accvgpr_read_b32 v219, a7
    v_mul_f32 v212, v212, v209
    v_mul_f32 v213, v213, v209
    v_mul_f32 v214, v214, v209
    v_mul_f32 v215, v215, v209
    v_mul_f32 v216, v216, v210
    v_mul_f32 v217, v217, v210
    v_mul_f32 v218, v218, v210
    v_mul_f32 v219, v219, v210
    v_accvgpr_write_b32 a0, v212
    v_accvgpr_write_b32 a1, v213
    v_accvgpr_write_b32 a2, v214
    v_accvgpr_write_b32 a3, v215
    v_accvgpr_write_b32 a4, v216
    v_accvgpr_write_b32 a5, v217
    v_accvgpr_write_b32 a6, v218
    v_accvgpr_write_b32 a7, v219
    v_accvgpr_read_b32 v212, a8
    v_accvgpr_read_b32 v213, a9
    v_accvgpr_read_b32 v214, a10
    v_accvgpr_read_b32 v215, a11
    v_accvgpr_read_b32 v216, a12
    v_accvgpr_read_b32 v217, a13
    v_accvgpr_read_b32 v218, a14
    v_accvgpr_read_b32 v219, a15
    v_mul_f32 v212, v212, v211
    v_mul_f32 v213, v213, v211
    v_mul_f32 v214, v214, v211
    v_mul_f32 v215, v215, v211
    v_mul_f32 v216, v216, v209
    v_mul_f32 v217, v217, v209
    v_mul_f32 v218, v218, v209
    v_mul_f32 v219, v219, v209
    v_accvgpr_write_b32 a8, v212
    v_accvgpr_write_b32 a9, v213
    v_accvgpr_write_b32 a10, v214
    v_accvgpr_write_b32 a11, v215
    v_accvgpr_write_b32 a12, v216
    v_accvgpr_write_b32 a13, v217
    v_accvgpr_write_b32 a14, v218
    v_accvgpr_write_b32 a15, v219
    v_accvgpr_read_b32 v212, a16
    v_accvgpr_read_b32 v213, a17
    v_accvgpr_read_b32 v214, a18
    v_accvgpr_read_b32 v215, a19
    v_accvgpr_read_b32 v216, a20
    v_accvgpr_read_b32 v217, a21
    v_accvgpr_read_b32 v218, a22
    v_accvgpr_read_b32 v219, a23
    v_mul_f32 v212, v212, v210
    v_mul_f32 v213, v213, v210
    v_mul_f32 v214, v214, v210
    v_mul_f32 v215, v215, v210
    v_mul_f32 v216, v216, v211
    v_mul_f32 v217, v217, v211
    v_mul_f32 v218, v218, v211
    v_mul_f32 v219, v219, v211
    v_accvgpr_write_b32 a16, v212
    v_accvgpr_write_b32 a17, v213
    v_accvgpr_write_b32 a18, v214
    v_accvgpr_write_b32 a19, v215
    v_accvgpr_write_b32 a20, v216
    v_accvgpr_write_b32 a21, v217
    v_accvgpr_write_b32 a22, v218
    v_accvgpr_write_b32 a23, v219
    v_accvgpr_read_b32 v212, a24
    v_accvgpr_read_b32 v213, a25
    v_accvgpr_read_b32 v214, a26
    v_accvgpr_read_b32 v215, a27
    v_accvgpr_read_b32 v216, a28
    v_accvgpr_read_b32 v217, a29
    v_accvgpr_read_b32 v218, a30
    v_accvgpr_read_b32 v219, a31
    v_mul_f32 v212, v212, v209
    v_mul_f32 v213, v213, v209
    v_mul_f32 v214, v214, v209
    v_mul_f32 v215, v215, v209
    v_mul_f32 v216, v216, v210
    v_mul_f32 v217, v217, v210
    v_mul_f32 v218, v218, v210
    v_mul_f32 v219, v219, v210
    v_accvgpr_write_b32 a24, v212
    v_accvgpr_write_b32 a25, v213
    v_accvgpr_write_b32 a26, v214
    v_accvgpr_write_b32 a27, v215
    v_accvgpr_write_b32 a28, v216
    v_accvgpr_write_b32 a29, v217
    v_accvgpr_write_b32 a30, v218
    v_accvgpr_write_b32 a31, v219
    v_accvgpr_read_b32 v212, a32
    v_accvgpr_read_b32 v213, a33
    v_accvgpr_read_b32 v214, a34
    v_accvgpr_read_b32 v215, a35
    v_accvgpr_read_b32 v216, a36
    v_accvgpr_read_b32 v217, a37
    v_accvgpr_read_b32 v218, a38
    v_accvgpr_read_b32 v219, a39
    v_mul_f32 v212, v212, v211
    v_mul_f32 v213, v213, v211
    v_mul_f32 v214, v214, v211
    v_mul_f32 v215, v215, v211
    v_mul_f32 v216, v216, v209
    v_mul_f32 v217, v217, v209
    v_mul_f32 v218, v218, v209
    v_mul_f32 v219, v219, v209
    v_accvgpr_write_b32 a32, v212
    v_accvgpr_write_b32 a33, v213
    v_accvgpr_write_b32 a34, v214
    v_accvgpr_write_b32 a35, v215
    v_accvgpr_write_b32 a36, v216
    v_accvgpr_write_b32 a37, v217
    v_accvgpr_write_b32 a38, v218
    v_accvgpr_write_b32 a39, v219
    v_accvgpr_read_b32 v212, a40
    v_accvgpr_read_b32 v213, a41
    v_accvgpr_read_b32 v214, a42
    v_accvgpr_read_b32 v215, a43
    v_accvgpr_read_b32 v216, a44
    v_accvgpr_read_b32 v217, a45
    v_accvgpr_read_b32 v218, a46
    v_accvgpr_read_b32 v219, a47
    v_mul_f32 v212, v212, v210
    v_mul_f32 v213, v213, v210
    v_mul_f32 v214, v214, v210
    v_mul_f32 v215, v215, v210
    v_mul_f32 v216, v216, v211
    v_mul_f32 v217, v217, v211
    v_mul_f32 v218, v218, v211
    v_mul_f32 v219, v219, v211
    v_accvgpr_write_b32 a40, v212
    v_accvgpr_write_b32 a41, v213
    v_accvgpr_write_b32 a42, v214
    v_accvgpr_write_b32 a43, v215
    v_accvgpr_write_b32 a44, v216
    v_accvgpr_write_b32 a45, v217
    v_accvgpr_write_b32 a46, v218
    v_accvgpr_write_b32 a47, v219
    v_accvgpr_read_b32 v212, a48
    v_accvgpr_read_b32 v213, a49
    v_accvgpr_read_b32 v214, a50
    v_accvgpr_read_b32 v215, a51
    v_accvgpr_read_b32 v216, a52
    v_accvgpr_read_b32 v217, a53
    v_accvgpr_read_b32 v218, a54
    v_accvgpr_read_b32 v219, a55
    v_mul_f32 v212, v212, v209
    v_mul_f32 v213, v213, v209
    v_mul_f32 v214, v214, v209
    v_mul_f32 v215, v215, v209
    v_mul_f32 v216, v216, v210
    v_mul_f32 v217, v217, v210
    v_mul_f32 v218, v218, v210
    v_mul_f32 v219, v219, v210
    v_accvgpr_write_b32 a48, v212
    v_accvgpr_write_b32 a49, v213
    v_accvgpr_write_b32 a50, v214
    v_accvgpr_write_b32 a51, v215
    v_accvgpr_write_b32 a52, v216
    v_accvgpr_write_b32 a53, v217
    v_accvgpr_write_b32 a54, v218
    v_accvgpr_write_b32 a55, v219
    v_accvgpr_read_b32 v212, a56
    v_accvgpr_read_b32 v213, a57
    v_accvgpr_read_b32 v214, a58
    v_accvgpr_read_b32 v215, a59
    v_accvgpr_read_b32 v216, a60
    v_accvgpr_read_b32 v217, a61
    v_accvgpr_read_b32 v218, a62
    v_accvgpr_read_b32 v219, a63
    v_mul_f32 v212, v212, v211
    v_mul_f32 v213, v213, v211
    v_mul_f32 v214, v214, v211
    v_mul_f32 v215, v215, v211
    v_mul_f32 v216, v216, v209
    v_mul_f32 v217, v217, v209
    v_mul_f32 v218, v218, v209
    v_mul_f32 v219, v219, v209
    v_accvgpr_write_b32 a56, v212
    v_accvgpr_write_b32 a57, v213
    v_accvgpr_write_b32 a58, v214
    v_accvgpr_write_b32 a59, v215
    v_accvgpr_write_b32 a60, v216
    v_accvgpr_write_b32 a61, v217
    v_accvgpr_write_b32 a62, v218
    v_accvgpr_write_b32 a63, v219
    v_accvgpr_read_b32 v212, a64
    v_accvgpr_read_b32 v213, a65
    v_accvgpr_read_b32 v214, a66
    v_accvgpr_read_b32 v215, a67
    v_accvgpr_read_b32 v216, a68
    v_accvgpr_read_b32 v217, a69
    v_accvgpr_read_b32 v218, a70
    v_accvgpr_read_b32 v219, a71
    v_mul_f32 v212, v212, v210
    v_mul_f32 v213, v213, v210
    v_mul_f32 v214, v214, v210
    v_mul_f32 v215, v215, v210
    v_mul_f32 v216, v216, v211
    v_mul_f32 v217, v217, v211
    v_mul_f32 v218, v218, v211
    v_mul_f32 v219, v219, v211
    v_accvgpr_write_b32 a64, v212
    v_accvgpr_write_b32 a65, v213
    v_accvgpr_write_b32 a66, v214
    v_accvgpr_write_b32 a67, v215
    v_accvgpr_write_b32 a68, v216
    v_accvgpr_write_b32 a69, v217
    v_accvgpr_write_b32 a70, v218
    v_accvgpr_write_b32 a71, v219
    v_accvgpr_read_b32 v212, a72
    v_accvgpr_read_b32 v213, a73
    v_accvgpr_read_b32 v214, a74
    v_accvgpr_read_b32 v215, a75
    v_accvgpr_read_b32 v216, a76
    v_accvgpr_read_b32 v217, a77
    v_accvgpr_read_b32 v218, a78
    v_accvgpr_read_b32 v219, a79
    v_mul_f32 v212, v212, v209
    v_mul_f32 v213, v213, v209
    v_mul_f32 v214, v214, v209
    v_mul_f32 v215, v215, v209
    v_mul_f32 v216, v216, v210
    v_mul_f32 v217, v217, v210
    v_mul_f32 v218, v218, v210
    v_mul_f32 v219, v219, v210
    v_accvgpr_write_b32 a72, v212
    v_accvgpr_write_b32 a73, v213
    v_accvgpr_write_b32 a74, v214
    v_accvgpr_write_b32 a75, v215
    v_accvgpr_write_b32 a76, v216
    v_accvgpr_write_b32 a77, v217
    v_accvgpr_write_b32 a78, v218
    v_accvgpr_write_b32 a79, v219
    v_accvgpr_read_b32 v212, a80
    v_accvgpr_read_b32 v213, a81
    v_accvgpr_read_b32 v214, a82
    v_accvgpr_read_b32 v215, a83
    v_accvgpr_read_b32 v216, a84
    v_accvgpr_read_b32 v217, a85
    v_accvgpr_read_b32 v218, a86
    v_accvgpr_read_b32 v219, a87
    v_mul_f32 v212, v212, v211
    v_mul_f32 v213, v213, v211
    v_mul_f32 v214, v214, v211
    v_mul_f32 v215, v215, v211
    v_mul_f32 v216, v216, v209
    v_mul_f32 v217, v217, v209
    v_mul_f32 v218, v218, v209
    v_mul_f32 v219, v219, v209
    v_accvgpr_write_b32 a80, v212
    v_accvgpr_write_b32 a81, v213
    v_accvgpr_write_b32 a82, v214
    v_accvgpr_write_b32 a83, v215
    v_accvgpr_write_b32 a84, v216
    v_accvgpr_write_b32 a85, v217
    v_accvgpr_write_b32 a86, v218
    v_accvgpr_write_b32 a87, v219
    v_accvgpr_read_b32 v212, a88
    v_accvgpr_read_b32 v213, a89
    v_accvgpr_read_b32 v214, a90
    v_accvgpr_read_b32 v215, a91
    v_accvgpr_read_b32 v216, a92
    v_accvgpr_read_b32 v217, a93
    v_accvgpr_read_b32 v218, a94
    v_accvgpr_read_b32 v219, a95
    v_mul_f32 v212, v212, v210
    v_mul_f32 v213, v213, v210
    v_mul_f32 v214, v214, v210
    v_mul_f32 v215, v215, v210
    v_mul_f32 v216, v216, v211
    v_mul_f32 v217, v217, v211
    v_mul_f32 v218, v218, v211
    v_mul_f32 v219, v219, v211
    v_accvgpr_write_b32 a88, v212
    v_accvgpr_write_b32 a89, v213
    v_accvgpr_write_b32 a90, v214
    v_accvgpr_write_b32 a91, v215
    v_accvgpr_write_b32 a92, v216
    v_accvgpr_write_b32 a93, v217
    v_accvgpr_write_b32 a94, v218
    v_accvgpr_write_b32 a95, v219
    v_accvgpr_read_b32 v212, a96
    v_accvgpr_read_b32 v213, a97
    v_accvgpr_read_b32 v214, a98
    v_accvgpr_read_b32 v215, a99
    v_accvgpr_read_b32 v216, a100
    v_accvgpr_read_b32 v217, a101
    v_accvgpr_read_b32 v218, a102
    v_accvgpr_read_b32 v219, a103
    v_mul_f32 v212, v212, v209
    v_mul_f32 v213, v213, v209
    v_mul_f32 v214, v214, v209
    v_mul_f32 v215, v215, v209
    v_mul_f32 v216, v216, v210
    v_mul_f32 v217, v217, v210
    v_mul_f32 v218, v218, v210
    v_mul_f32 v219, v219, v210
    v_accvgpr_write_b32 a96, v212
    v_accvgpr_write_b32 a97, v213
    v_accvgpr_write_b32 a98, v214
    v_accvgpr_write_b32 a99, v215
    v_accvgpr_write_b32 a100, v216
    v_accvgpr_write_b32 a101, v217
    v_accvgpr_write_b32 a102, v218
    v_accvgpr_write_b32 a103, v219
    v_accvgpr_read_b32 v212, a104
    v_accvgpr_read_b32 v213, a105
    v_accvgpr_read_b32 v214, a106
    v_accvgpr_read_b32 v215, a107
    v_accvgpr_read_b32 v216, a108
    v_accvgpr_read_b32 v217, a109
    v_accvgpr_read_b32 v218, a110
    v_accvgpr_read_b32 v219, a111
    v_mul_f32 v212, v212, v211
    v_mul_f32 v213, v213, v211
    v_mul_f32 v214, v214, v211
    v_mul_f32 v215, v215, v211
    v_mul_f32 v216, v216, v209
    v_mul_f32 v217, v217, v209
    v_mul_f32 v218, v218, v209
    v_mul_f32 v219, v219, v209
    v_accvgpr_write_b32 a104, v212
    v_accvgpr_write_b32 a105, v213
    v_accvgpr_write_b32 a106, v214
    v_accvgpr_write_b32 a107, v215
    v_accvgpr_write_b32 a108, v216
    v_accvgpr_write_b32 a109, v217
    v_accvgpr_write_b32 a110, v218
    v_accvgpr_write_b32 a111, v219
    v_accvgpr_read_b32 v212, a112
    v_accvgpr_read_b32 v213, a113
    v_accvgpr_read_b32 v214, a114
    v_accvgpr_read_b32 v215, a115
    v_accvgpr_read_b32 v216, a116
    v_accvgpr_read_b32 v217, a117
    v_accvgpr_read_b32 v218, a118
    v_accvgpr_read_b32 v219, a119
    v_mul_f32 v212, v212, v210
    v_mul_f32 v213, v213, v210
    v_mul_f32 v214, v214, v210
    v_mul_f32 v215, v215, v210
    v_mul_f32 v216, v216, v211
    v_mul_f32 v217, v217, v211
    v_mul_f32 v218, v218, v211
    v_mul_f32 v219, v219, v211
    v_accvgpr_write_b32 a112, v212
    v_accvgpr_write_b32 a113, v213
    v_accvgpr_write_b32 a114, v214
    v_accvgpr_write_b32 a115, v215
    v_accvgpr_write_b32 a116, v216
    v_accvgpr_write_b32 a117, v217
    v_accvgpr_write_b32 a118, v218
    v_accvgpr_write_b32 a119, v219
    v_accvgpr_read_b32 v212, a120
    v_accvgpr_read_b32 v213, a121
    v_accvgpr_read_b32 v214, a122
    v_accvgpr_read_b32 v215, a123
    v_accvgpr_read_b32 v216, a124
    v_accvgpr_read_b32 v217, a125
    v_accvgpr_read_b32 v218, a126
    v_accvgpr_read_b32 v219, a127
    v_mul_f32 v212, v212, v209
    v_mul_f32 v213, v213, v209
    v_mul_f32 v214, v214, v209
    v_mul_f32 v215, v215, v209
    v_mul_f32 v216, v216, v210
    v_mul_f32 v217, v217, v210
    v_mul_f32 v218, v218, v210
    v_mul_f32 v219, v219, v210
    v_accvgpr_write_b32 a120, v212
    v_accvgpr_write_b32 a121, v213
    v_accvgpr_write_b32 a122, v214
    v_accvgpr_write_b32 a123, v215
    v_accvgpr_write_b32 a124, v216
    v_accvgpr_write_b32 a125, v217
    v_accvgpr_write_b32 a126, v218
    v_accvgpr_write_b32 a127, v219
    v_accvgpr_read_b32 v212, a128
    v_accvgpr_read_b32 v213, a129
    v_accvgpr_read_b32 v214, a130
    v_accvgpr_read_b32 v215, a131
    v_accvgpr_read_b32 v216, a132
    v_accvgpr_read_b32 v217, a133
    v_accvgpr_read_b32 v218, a134
    v_accvgpr_read_b32 v219, a135
    v_mul_f32 v212, v212, v211
    v_mul_f32 v213, v213, v211
    v_mul_f32 v214, v214, v211
    v_mul_f32 v215, v215, v211
    v_mul_f32 v216, v216, v209
    v_mul_f32 v217, v217, v209
    v_mul_f32 v218, v218, v209
    v_mul_f32 v219, v219, v209
    v_accvgpr_write_b32 a128, v212
    v_accvgpr_write_b32 a129, v213
    v_accvgpr_write_b32 a130, v214
    v_accvgpr_write_b32 a131, v215
    v_accvgpr_write_b32 a132, v216
    v_accvgpr_write_b32 a133, v217
    v_accvgpr_write_b32 a134, v218
    v_accvgpr_write_b32 a135, v219
    v_accvgpr_read_b32 v212, a136
    v_accvgpr_read_b32 v213, a137
    v_accvgpr_read_b32 v214, a138
    v_accvgpr_read_b32 v215, a139
    v_accvgpr_read_b32 v216, a140
    v_accvgpr_read_b32 v217, a141
    v_accvgpr_read_b32 v218, a142
    v_accvgpr_read_b32 v219, a143
    v_mul_f32 v212, v212, v210
    v_mul_f32 v213, v213, v210
    v_mul_f32 v214, v214, v210
    v_mul_f32 v215, v215, v210
    v_mul_f32 v216, v216, v211
    v_mul_f32 v217, v217, v211
    v_mul_f32 v218, v218, v211
    v_mul_f32 v219, v219, v211
    v_accvgpr_write_b32 a136, v212
    v_accvgpr_write_b32 a137, v213
    v_accvgpr_write_b32 a138, v214
    v_accvgpr_write_b32 a139, v215
    v_accvgpr_write_b32 a140, v216
    v_accvgpr_write_b32 a141, v217
    v_accvgpr_write_b32 a142, v218
    v_accvgpr_write_b32 a143, v219
    s_mov_b32 s72, 0
    s_nop 1
L_k1_rs_11_skip:
    s_mov_b32 s61, s77
    s_waitcnt vmcnt(18)
    s_barrier
    s_add_u32 s77, s61, 24576
    s_cmp_eq_u32 s77, 147456
    s_cselect_b32 s77, 0, s77
    s_add_u32 s68, s61, 12288
    v_add_u32 v186, s68, v180
    v_add_u32 v187, s68, v181
    ds_read_b64_tr_b16 v[160:161], v188 offset:128
    ds_read_b64_tr_b16 v[162:163], v188 offset:6272
    s_waitcnt lgkmcnt(8)
    v_mfma_f32_16x16x32_bf16 a[0:3], v[144:147], v[132:135], a[0:3]
    v_exp_f32 v228, v72
    v_exp_f32 v229, v73
    v_mfma_f32_16x16x32_bf16 a[4:7], v[144:147], v[136:139], a[4:7]
    v_exp_f32 v230, v74
    v_exp_f32 v231, v75
    v_mfma_f32_16x16x32_bf16 a[8:11], v[144:147], v[140:143], a[8:11]
    v_exp_f32 v232, v84
    ds_read_b64_tr_b16 v[164:165], v189 offset:128
    ds_read_b64_tr_b16 v[166:167], v189 offset:6272
    s_waitcnt lgkmcnt(8)
    v_mfma_f32_16x16x32_bf16 a[12:15], v[148:151], v[132:135], a[12:15]
    v_exp_f32 v233, v85
    v_exp_f32 v234, v86
    v_mfma_f32_16x16x32_bf16 a[16:19], v[148:151], v[136:139], a[16:19]
    v_exp_f32 v235, v87
    v_mfma_f32_16x16x32_bf16 a[20:23], v[148:151], v[140:143], a[20:23]
    v_exp_f32 v236, v76
    v_exp_f32 v237, v77
    ds_read_b64_tr_b16 v[144:145], v190 offset:128
    ds_read_b64_tr_b16 v[146:147], v190 offset:6272
    s_waitcnt lgkmcnt(8)
    v_mfma_f32_16x16x32_bf16 a[24:27], v[152:155], v[132:135], a[24:27]
    v_exp_f32 v238, v78
    v_mfma_f32_16x16x32_bf16 a[28:31], v[152:155], v[136:139], a[28:31]
    v_exp_f32 v239, v79
    v_exp_f32 v240, v88
    v_mfma_f32_16x16x32_bf16 a[32:35], v[152:155], v[140:143], a[32:35]
    v_exp_f32 v241, v89
    ds_read_b64_tr_b16 v[148:149], v191 offset:128
    ds_read_b64_tr_b16 v[150:151], v191 offset:6272
    s_waitcnt lgkmcnt(8)
    v_mfma_f32_16x16x32_bf16 a[36:39], v[156:159], v[132:135], a[36:39]
    v_exp_f32 v242, v90
    v_exp_f32 v243, v91
    v_mfma_f32_16x16x32_bf16 a[40:43], v[156:159], v[136:139], a[40:43]
    v_exp_f32 v244, v80
    v_mfma_f32_16x16x32_bf16 a[44:47], v[156:159], v[140:143], a[44:47]
    v_exp_f32 v245, v81
    v_exp_f32 v246, v82
    ds_read_b64_tr_b16 v[152:153], v188 offset:256
    ds_read_b64_tr_b16 v[154:155], v188 offset:6400
    s_waitcnt lgkmcnt(8)
    v_mfma_f32_16x16x32_bf16 a[48:51], v[160:163], v[132:135], a[48:51]
    v_exp_f32 v247, v83
    v_mfma_f32_16x16x32_bf16 a[52:55], v[160:163], v[136:139], a[52:55]
    v_exp_f32 v248, v92
    v_exp_f32 v249, v93
    v_mfma_f32_16x16x32_bf16 a[56:59], v[160:163], v[140:143], a[56:59]
    v_exp_f32 v250, v94
    ds_read_b64_tr_b16 v[156:157], v189 offset:256
    ds_read_b64_tr_b16 v[158:159], v189 offset:6400
    s_waitcnt lgkmcnt(8)
    v_mfma_f32_16x16x32_bf16 a[60:63], v[164:167], v[132:135], a[60:63]
    v_exp_f32 v251, v95
    v_add_f32 v212, v228, v229
    v_mfma_f32_16x16x32_bf16 a[64:67], v[164:167], v[136:139], a[64:67]
    v_add_f32 v213, v236, v237
    v_mfma_f32_16x16x32_bf16 a[68:71], v[164:167], v[140:143], a[68:71]
    v_add_f32 v214, v244, v245
    v_add_f32 v212, v212, v230
    ds_read_b64_tr_b16 v[160:161], v190 offset:256
    ds_read_b64_tr_b16 v[162:163], v190 offset:6400
    s_waitcnt lgkmcnt(8)
    v_mfma_f32_16x16x32_bf16 a[72:75], v[144:147], v[132:135], a[72:75]
    v_add_f32 v213, v213, v238
    v_add_f32 v214, v214, v246
    v_mfma_f32_16x16x32_bf16 a[76:79], v[144:147], v[136:139], a[76:79]
    v_add_f32 v212, v212, v231
    v_mfma_f32_16x16x32_bf16 a[80:83], v[144:147], v[140:143], a[80:83]
    v_add_f32 v213, v213, v239
    v_add_f32 v214, v214, v247
    ds_read_b64_tr_b16 v[164:165], v191 offset:256
    ds_read_b64_tr_b16 v[166:167], v191 offset:6400
    s_waitcnt lgkmcnt(8)
    v_mfma_f32_16x16x32_bf16 a[84:87], v[148:151], v[132:135], a[84:87]
    v_add_f32 v212, v212, v232
    v_mfma_f32_16x16x32_bf16 a[88:91], v[148:151], v[136:139], a[88:91]
    v_add_f32 v213, v213, v240
    v_add_f32 v214, v214, v248
    v_mfma_f32_16x16x32_bf16 a[92:95], v[148:151], v[140:143], a[92:95]
    v_add_f32 v212, v212, v233
    ds_read_b128 v[144:147], v186 offset:0
    s_waitcnt lgkmcnt(7)
    v_mfma_f32_16x16x32_bf16 a[96:99], v[152:155], v[132:135], a[96:99]
    v_add_f32 v213, v213, v241
    v_add_f32 v214, v214, v249
    v_mfma_f32_16x16x32_bf16 a[100:103], v[152:155], v[136:139], a[100:103]
    v_add_f32 v212, v212, v234
    v_mfma_f32_16x16x32_bf16 a[104:107], v[152:155], v[140:143], a[104:107]
    v_add_f32 v213, v213, v242
    v_add_f32 v214, v214, v250
    ds_read_b128 v[148:151], v187 offset:0
    s_waitcnt lgkmcnt(6)
    v_mfma_f32_16x16x32_bf16 a[108:111], v[156:159], v[132:135], a[108:111]
    v_add_f32 v212, v212, v235
    v_mfma_f32_16x16x32_bf16 a[112:115], v[156:159], v[136:139], a[112:115]
    v_add_f32 v213, v213, v243
    v_add_f32 v214, v214, v251
    v_mfma_f32_16x16x32_bf16 a[116:119], v[156:159], v[140:143], a[116:119]
    v_cmp_gt_f32 s[80:81], v212, s71
    ds_read_b128 v[152:155], v186 offset:128
    s_waitcnt lgkmcnt(5)
    v_mfma_f32_16x16x32_bf16 a[120:123], v[160:163], v[132:135], a[120:123]
    v_cmp_gt_f32 s[82:83], v213, s71
    v_cmp_gt_f32 s[84:85], v214, s71
    v_mfma_f32_16x16x32_bf16 a[124:127], v[160:163], v[136:139], a[124:127]
    s_or_b64 s[80:81], s[80:81], s[82:83]
    v_mfma_f32_16x16x32_bf16 a[128:131], v[160:163], v[140:143], a[128:131]
    s_or_b64 s[80:81], s[80:81], s[84:85]
    s_cbranch_scc1 L_k1_sm_12_slow
L_k1_sm_12_ret:
    ds_read_b128 v[156:159], v187 offset:128
    s_waitcnt lgkmcnt(4)
    v_mfma_f32_16x16x32_bf16 a[132:135], v[164:167], v[132:135], a[132:135]
    v_mfma_f32_16x16x32_bf16 a[136:139], v[164:167], v[136:139], a[136:139]
    v_mfma_f32_16x16x32_bf16 a[140:143], v[164:167], v[140:143], a[140:143]
    ds_read_b128 v[160:163], v186 offset:256
    s_waitcnt lgkmcnt(4)
    v_mfma_f32_16x16x32_bf16 v[96:99], v[144:147], v[0:3], v[168:171]
    s_add_u32 m0, s79, 0
    s_nop 0
    v_mfma_f32_16x16x32_bf16 v[100:103], v[144:147], v[4:7], v[172:175]
    buffer_load_dwordx4 v197, s[52:55], s66 offen nt lds
    v_mfma_f32_16x16x32_bf16 v[104:107], v[144:147], v[8:11], v[176:179]
    s_add_u32 m0, s79, 1024
    ds_read_b128 v[164:167], v187 offset:256
    s_waitcnt lgkmcnt(4)
    v_mfma_f32_16x16x32_bf16 v[96:99], v[148:151], v[12:15], v[96:99]
    s_nop 0
    v_mfma_f32_16x16x32_bf16 v[100:103], v[148:151], v[16:19], v[100:103]
    buffer_load_dwordx4 v198, s[52:55], s66 offen nt lds
    v_mfma_f32_16x16x32_bf16 v[104:107], v[148:151], v[20:23], v[104:107]
    s_add_u32 m0, s79, 2048
    ds_read_b128 v[144:147], v186 offset:6144
    s_waitcnt lgkmcnt(4)
    v_mfma_f32_16x16x32_bf16 v[96:99], v[152:155], v[24:27], v[96:99]
    s_nop 0
    v_mfma_f32_16x16x32_bf16 v[100:103], v[152:155], v[28:31], v[100:103]
    buffer_load_dwordx4 v199, s[52:55], s66 offen nt lds
    v_mfma_f32_16x16x32_bf16 v[104:107], v[152:155], v[32:35], v[104:107]
    s_add_u32 m0, s79, 12288
    ds_read_b128 v[148:151], v187 offset:6144
    s_waitcnt lgkmcnt(4)
    v_mfma_f32_16x16x32_bf16 v[96:99], v[156:159], v[36:39], v[96:99]
    s_nop 0
    v_mfma_f32_16x16x32_bf16 v[100:103], v[156:159], v[40:43], v[100:103]
    buffer_load_dwordx4 v197, s[48:51], s65 offen nt lds
    v_mfma_f32_16x16x32_bf16 v[104:107], v[156:159], v[44:47], v[104:107]
    s_add_u32 m0, s79, 13312
    ds_read_b128 v[152:155], v186 offset:6272
    s_waitcnt lgkmcnt(4)
    v_mfma_f32_16x16x32_bf16 v[96:99], v[160:163], v[48:51], v[96:99]
    s_nop 0
    v_mfma_f32_16x16x32_bf16 v[100:103], v[160:163], v[52:55], v[100:103]
    buffer_load_dwordx4 v198, s[48:51], s65 offen nt lds
    v_mfma_f32_16x16x32_bf16 v[104:107], v[160:163], v[56:59], v[104:107]
    s_add_u32 m0, s79, 14336
    ds_read_b128 v[156:159], v187 offset:6272
    s_waitcnt lgkmcnt(4)
    v_mfma_f32_16x16x32_bf16 v[96:99], v[164:167], v[60:63], v[96:99]
    s_nop 0
    v_mfma_f32_16x16x32_bf16 v[100:103], v[164:167], v[64:67], v[100:103]
    buffer_load_dwordx4 v199, s[48:51], s65 offen nt lds
    v_mfma_f32_16x16x32_bf16 v[104:107], v[164:167], v[68:71], v[104:107]
    s_add_u32 s66, s66, 12288
    ds_read_b128 v[160:163], v186 offset:6400
    s_waitcnt lgkmcnt(4)
    v_mfma_f32_16x16x32_bf16 v[108:111], v[144:147], v[0:3], v[168:171]
    s_add_u32 s65, s65, 12288
    s_add_u32 s79, s79, 24576
    v_mfma_f32_16x16x32_bf16 v[112:115], v[144:147], v[4:7], v[172:175]
    s_cmp_ge_u32 s79, 147456
    v_mfma_f32_16x16x32_bf16 v[116:119], v[144:147], v[8:11], v[176:179]
    s_cselect_b32 s79, s67, s79
    ds_read_b128 v[164:167], v187 offset:6400
    s_waitcnt lgkmcnt(4)
    v_mfma_f32_16x16x32_bf16 v[108:111], v[148:151], v[12:15], v[108:111]
    v_add_f32 v206, v206, v212
    v_mfma_f32_16x16x32_bf16 v[112:115], v[148:151], v[16:19], v[112:115]
    v_add_f32 v207, v207, v213
    v_mfma_f32_16x16x32_bf16 v[116:119], v[148:151], v[20:23], v[116:119]
    v_add_f32 v208, v208, v214
    v_add_u32 v188, s77, v182
    v_add_u32 v189, s77, v183
    v_add_u32 v190, s77, v184
    v_add_u32 v191, s77, v185
    ds_read_b64_tr_b16 v[144:145], v188 offset:0
    ds_read_b64_tr_b16 v[146:147], v188 offset:6144
    s_waitcnt lgkmcnt(5)
    v_mfma_f32_16x16x32_bf16 v[108:111], v[152:155], v[24:27], v[108:111]
    v_cvt_pk_bf16_f32 v120, v228, v229
    v_mfma_f32_16x16x32_bf16 v[112:115], v[152:155], v[28:31], v[112:115]
    v_cvt_pk_bf16_f32 v121, v230, v231
    v_mfma_f32_16x16x32_bf16 v[116:119], v[152:155], v[32:35], v[116:119]
    v_cvt_pk_bf16_f32 v122, v232, v233
    ds_read_b64_tr_b16 v[148:149], v189 offset:0
    ds_read_b64_tr_b16 v[150:151], v189 offset:6144
    s_waitcnt lgkmcnt(6)
    v_mfma_f32_16x16x32_bf16 v[108:111], v[156:159], v[36:39], v[108:111]
    v_cvt_pk_bf16_f32 v123, v234, v235
    v_mfma_f32_16x16x32_bf16 v[112:115], v[156:159], v[40:43], v[112:115]
    v_cvt_pk_bf16_f32 v124, v236, v237
    v_mfma_f32_16x16x32_bf16 v[116:119], v[156:159], v[44:47], v[116:119]
    v_cvt_pk_bf16_f32 v125, v238, v239
    ds_read_b64_tr_b16 v[152:153], v190 offset:0
    ds_read_b64_tr_b16 v[154:155], v190 offset:6144
    s_waitcnt lgkmcnt(7)
    v_mfma_f32_16x16x32_bf16 v[108:111], v[160:163], v[48:51], v[108:111]
    v_cvt_pk_bf16_f32 v126, v240, v241
    v_mfma_f32_16x16x32_bf16 v[112:115], v[160:163], v[52:55], v[112:115]
    v_cvt_pk_bf16_f32 v127, v242, v243
    v_mfma_f32_16x16x32_bf16 v[116:119], v[160:163], v[56:59], v[116:119]
    v_cvt_pk_bf16_f32 v128, v244, v245
    ds_read_b64_tr_b16 v[156:157], v191 offset:0
    ds_read_b64_tr_b16 v[158:159], v191 offset:6144
    s_waitcnt lgkmcnt(8)
    v_mfma_f32_16x16x32_bf16 v[108:111], v[164:167], v[60:63], v[108:111]
    v_cvt_pk_bf16_f32 v129, v246, v247
    v_mfma_f32_16x16x32_bf16 v[112:115], v[164:167], v[64:67], v[112:115]
    v_cvt_pk_bf16_f32 v130, v248, v249
    v_mfma_f32_16x16x32_bf16 v[116:119], v[164:167], v[68:71], v[116:119]
    v_cvt_pk_bf16_f32 v131, v250, v251
    s_cmp_eq_u32 s72, 0
    s_cbranch_scc1 L_k1_rs_13_skip
    s_nop 7
    v_accvgpr_read_b32 v212, a0
    v_accvgpr_read_b32 v213, a1
    v_accvgpr_read_b32 v214, a2
    v_accvgpr_read_b32 v215, a3
    v_accvgpr_read_b32 v216, a4
    v_accvgpr_read_b32 v217, a5
    v_accvgpr_read_b32 v218, a6
    v_accvgpr_read_b32 v219, a7
    v_mul_f32 v212, v212, v209
    v_mul_f32 v213, v213, v209
    v_mul_f32 v214, v214, v209
    v_mul_f32 v215, v215, v209
    v_mul_f32 v216, v216, v210
    v_mul_f32 v217, v217, v210
    v_mul_f32 v218, v218, v210
    v_mul_f32 v219, v219, v210
    v_accvgpr_write_b32 a0, v212
    v_accvgpr_write_b32 a1, v213
    v_accvgpr_write_b32 a2, v214
    v_accvgpr_write_b32 a3, v215
    v_accvgpr_write_b32 a4, v216
    v_accvgpr_write_b32 a5, v217
    v_accvgpr_write_b32 a6, v218
    v_accvgpr_write_b32 a7, v219
    v_accvgpr_read_b32 v212, a8
    v_accvgpr_read_b32 v213, a9
    v_accvgpr_read_b32 v214, a10
    v_accvgpr_read_b32 v215, a11
    v_accvgpr_read_b32 v216, a12
    v_accvgpr_read_b32 v217, a13
    v_accvgpr_read_b32 v218, a14
    v_accvgpr_read_b32 v219, a15
    v_mul_f32 v212, v212, v211
    v_mul_f32 v213, v213, v211
    v_mul_f32 v214, v214, v211
    v_mul_f32 v215, v215, v211
    v_mul_f32 v216, v216, v209
    v_mul_f32 v217, v217, v209
    v_mul_f32 v218, v218, v209
    v_mul_f32 v219, v219, v209
    v_accvgpr_write_b32 a8, v212
    v_accvgpr_write_b32 a9, v213
    v_accvgpr_write_b32 a10, v214
    v_accvgpr_write_b32 a11, v215
    v_accvgpr_write_b32 a12, v216
    v_accvgpr_write_b32 a13, v217
    v_accvgpr_write_b32 a14, v218
    v_accvgpr_write_b32 a15, v219
    v_accvgpr_read_b32 v212, a16
    v_accvgpr_read_b32 v213, a17
    v_accvgpr_read_b32 v214, a18
    v_accvgpr_read_b32 v215, a19
    v_accvgpr_read_b32 v216, a20
    v_accvgpr_read_b32 v217, a21
    v_accvgpr_read_b32 v218, a22
    v_accvgpr_read_b32 v219, a23
    v_mul_f32 v212, v212, v210
    v_mul_f32 v213, v213, v210
    v_mul_f32 v214, v214, v210
    v_mul_f32 v215, v215, v210
    v_mul_f32 v216, v216, v211
    v_mul_f32 v217, v217, v211
    v_mul_f32 v218, v218, v211
    v_mul_f32 v219, v219, v211
    v_accvgpr_write_b32 a16, v212
    v_accvgpr_write_b32 a17, v213
    v_accvgpr_write_b32 a18, v214
    v_accvgpr_write_b32 a19, v215
    v_accvgpr_write_b32 a20, v216
    v_accvgpr_write_b32 a21, v217
    v_accvgpr_write_b32 a22, v218
    v_accvgpr_write_b32 a23, v219
    v_accvgpr_read_b32 v212, a24
    v_accvgpr_read_b32 v213, a25
    v_accvgpr_read_b32 v214, a26
    v_accvgpr_read_b32 v215, a27
    v_accvgpr_read_b32 v216, a28
    v_accvgpr_read_b32 v217, a29
    v_accvgpr_read_b32 v218, a30
    v_accvgpr_read_b32 v219, a31
    v_mul_f32 v212, v212, v209
    v_mul_f32 v213, v213, v209
    v_mul_f32 v214, v214, v209
    v_mul_f32 v215, v215, v209
    v_mul_f32 v216, v216, v210
    v_mul_f32 v217, v217, v210
    v_mul_f32 v218, v218, v210
    v_mul_f32 v219, v219, v210
    v_accvgpr_write_b32 a24, v212
    v_accvgpr_write_b32 a25, v213
    v_accvgpr_write_b32 a26, v214
    v_accvgpr_write_b32 a27, v215
    v_accvgpr_write_b32 a28, v216
    v_accvgpr_write_b32 a29, v217
    v_accvgpr_write_b32 a30, v218
    v_accvgpr_write_b32 a31, v219
    v_accvgpr_read_b32 v212, a32
    v_accvgpr_read_b32 v213, a33
    v_accvgpr_read_b32 v214, a34
    v_accvgpr_read_b32 v215, a35
    v_accvgpr_read_b32 v216, a36
    v_accvgpr_read_b32 v217, a37
    v_accvgpr_read_b32 v218, a38
    v_accvgpr_read_b32 v219, a39
    v_mul_f32 v212, v212, v211
    v_mul_f32 v213, v213, v211
    v_mul_f32 v214, v214, v211
    v_mul_f32 v215, v215, v211
    v_mul_f32 v216, v216, v209
    v_mul_f32 v217, v217, v209
    v_mul_f32 v218, v218, v209
    v_mul_f32 v219, v219, v209
    v_accvgpr_write_b32 a32, v212
    v_accvgpr_write_b32 a33, v213
    v_accvgpr_write_b32 a34, v214
    v_accvgpr_write_b32 a35, v215
    v_accvgpr_write_b32 a36, v216
    v_accvgpr_write_b32 a37, v217
    v_accvgpr_write_b32 a38, v218
    v_accvgpr_write_b32 a39, v219
    v_accvgpr_read_b32 v212, a40
    v_accvgpr_read_b32 v213, a41
    v_accvgpr_read_b32 v214, a42
    v_accvgpr_read_b32 v215, a43
    v_accvgpr_read_b32 v216, a44
    v_accvgpr_read_b32 v217, a45
    v_accvgpr_read_b32 v218, a46
    v_accvgpr_read_b32 v219, a47
    v_mul_f32 v212, v212, v210
    v_mul_f32 v213, v213, v210
    v_mul_f32 v214, v214, v210
    v_mul_f32 v215, v215, v210
    v_mul_f32 v216, v216, v211
    v_mul_f32 v217, v217, v211
    v_mul_f32 v218, v218, v211
    v_mul_f32 v219, v219, v211
    v_accvgpr_write_b32 a40, v212
    v_accvgpr_write_b32 a41, v213
    v_accvgpr_write_b32 a42, v214
    v_accvgpr_write_b32 a43, v215
    v_accvgpr_write_b32 a44, v216
    v_accvgpr_write_b32 a45, v217
    v_accvgpr_write_b32 a46, v218
    v_accvgpr_write_b32 a47, v219
    v_accvgpr_read_b32 v212, a48
    v_accvgpr_read_b32 v213, a49
    v_accvgpr_read_b32 v214, a50
    v_accvgpr_read_b32 v215, a51
    v_accvgpr_read_b32 v216, a52
    v_accvgpr_read_b32 v217, a53
    v_accvgpr_read_b32 v218, a54
    v_accvgpr_read_b32 v219, a55
    v_mul_f32 v212, v212, v209
    v_mul_f32 v213, v213, v209
    v_mul_f32 v214, v214, v209
    v_mul_f32 v215, v215, v209
    v_mul_f32 v216, v216, v210
    v_mul_f32 v217, v217, v210
    v_mul_f32 v218, v218, v210
    v_mul_f32 v219, v219, v210
    v_accvgpr_write_b32 a48, v212
    v_accvgpr_write_b32 a49, v213
    v_accvgpr_write_b32 a50, v214
    v_accvgpr_write_b32 a51, v215
    v_accvgpr_write_b32 a52, v216
    v_accvgpr_write_b32 a53, v217
    v_accvgpr_write_b32 a54, v218
    v_accvgpr_write_b32 a55, v219
    v_accvgpr_read_b32 v212, a56
    v_accvgpr_read_b32 v213, a57
    v_accvgpr_read_b32 v214, a58
    v_accvgpr_read_b32 v215, a59
    v_accvgpr_read_b32 v216, a60
    v_accvgpr_read_b32 v217, a61
    v_accvgpr_read_b32 v218, a62
    v_accvgpr_read_b32 v219, a63
    v_mul_f32 v212, v212, v211
    v_mul_f32 v213, v213, v211
    v_mul_f32 v214, v214, v211
    v_mul_f32 v215, v215, v211
    v_mul_f32 v216, v216, v209
    v_mul_f32 v217, v217, v209
    v_mul_f32 v218, v218, v209
    v_mul_f32 v219, v219, v209
    v_accvgpr_write_b32 a56, v212
    v_accvgpr_write_b32 a57, v213
    v_accvgpr_write_b32 a58, v214
    v_accvgpr_write_b32 a59, v215
    v_accvgpr_write_b32 a60, v216
    v_accvgpr_write_b32 a61, v217
    v_accvgpr_write_b32 a62, v218
    v_accvgpr_write_b32 a63, v219
    v_accvgpr_read_b32 v212, a64
    v_accvgpr_read_b32 v213, a65
    v_accvgpr_read_b32 v214, a66
    v_accvgpr_read_b32 v215, a67
    v_accvgpr_read_b32 v216, a68
    v_accvgpr_read_b32 v217, a69
    v_accvgpr_read_b32 v218, a70
    v_accvgpr_read_b32 v219, a71
    v_mul_f32 v212, v212, v210
    v_mul_f32 v213, v213, v210
    v_mul_f32 v214, v214, v210
    v_mul_f32 v215, v215, v210
    v_mul_f32 v216, v216, v211
    v_mul_f32 v217, v217, v211
    v_mul_f32 v218, v218, v211
    v_mul_f32 v219, v219, v211
    v_accvgpr_write_b32 a64, v212
    v_accvgpr_write_b32 a65, v213
    v_accvgpr_write_b32 a66, v214
    v_accvgpr_write_b32 a67, v215
    v_accvgpr_write_b32 a68, v216
    v_accvgpr_write_b32 a69, v217
    v_accvgpr_write_b32 a70, v218
    v_accvgpr_write_b32 a71, v219
    v_accvgpr_read_b32 v212, a72
    v_accvgpr_read_b32 v213, a73
    v_accvgpr_read_b32 v214, a74
    v_accvgpr_read_b32 v215, a75
    v_accvgpr_read_b32 v216, a76
    v_accvgpr_read_b32 v217, a77
    v_accvgpr_read_b32 v218, a78
    v_accvgpr_read_b32 v219, a79
    v_mul_f32 v212, v212, v209
    v_mul_f32 v213, v213, v209
    v_mul_f32 v214, v214, v209
    v_mul_f32 v215, v215, v209
    v_mul_f32 v216, v216, v210
    v_mul_f32 v217, v217, v210
    v_mul_f32 v218, v218, v210
    v_mul_f32 v219, v219, v210
    v_accvgpr_write_b32 a72, v212
    v_accvgpr_write_b32 a73, v213
    v_accvgpr_write_b32 a74, v214
    v_accvgpr_write_b32 a75, v215
    v_accvgpr_write_b32 a76, v216
    v_accvgpr_write_b32 a77, v217
    v_accvgpr_write_b32 a78, v218
    v_accvgpr_write_b32 a79, v219
    v_accvgpr_read_b32 v212, a80
    v_accvgpr_read_b32 v213, a81
    v_accvgpr_read_b32 v214, a82
    v_accvgpr_read_b32 v215, a83
    v_accvgpr_read_b32 v216, a84
    v_accvgpr_read_b32 v217, a85
    v_accvgpr_read_b32 v218, a86
    v_accvgpr_read_b32 v219, a87
    v_mul_f32 v212, v212, v211
    v_mul_f32 v213, v213, v211
    v_mul_f32 v214, v214, v211
    v_mul_f32 v215, v215, v211
    v_mul_f32 v216, v216, v209
    v_mul_f32 v217, v217, v209
    v_mul_f32 v218, v218, v209
    v_mul_f32 v219, v219, v209
    v_accvgpr_write_b32 a80, v212
    v_accvgpr_write_b32 a81, v213
    v_accvgpr_write_b32 a82, v214
    v_accvgpr_write_b32 a83, v215
    v_accvgpr_write_b32 a84, v216
    v_accvgpr_write_b32 a85, v217
    v_accvgpr_write_b32 a86, v218
    v_accvgpr_write_b32 a87, v219
    v_accvgpr_read_b32 v212, a88
    v_accvgpr_read_b32 v213, a89
    v_accvgpr_read_b32 v214, a90
    v_accvgpr_read_b32 v215, a91
    v_accvgpr_read_b32 v216, a92
    v_accvgpr_read_b32 v217, a93
    v_accvgpr_read_b32 v218, a94
    v_accvgpr_read_b32 v219, a95
    v_mul_f32 v212, v212, v210
    v_mul_f32 v213, v213, v210
    v_mul_f32 v214, v214, v210
    v_mul_f32 v215, v215, v210
    v_mul_f32 v216, v216, v211
    v_mul_f32 v217, v217, v211
    v_mul_f32 v218, v218, v211
    v_mul_f32 v219, v219, v211
    v_accvgpr_write_b32 a88, v212
    v_accvgpr_write_b32 a89, v213
    v_accvgpr_write_b32 a90, v214
    v_accvgpr_write_b32 a91, v215
    v_accvgpr_write_b32 a92, v216
    v_accvgpr_write_b32 a93, v217
    v_accvgpr_write_b32 a94, v218
    v_accvgpr_write_b32 a95, v219
    v_accvgpr_read_b32 v212, a96
    v_accvgpr_read_b32 v213, a97
    v_accvgpr_read_b32 v214, a98
    v_accvgpr_read_b32 v215, a99
    v_accvgpr_read_b32 v216, a100
    v_accvgpr_read_b32 v217, a101
    v_accvgpr_read_b32 v218, a102
    v_accvgpr_read_b32 v219, a103
    v_mul_f32 v212, v212, v209
    v_mul_f32 v213, v213, v209
    v_mul_f32 v214, v214, v209
    v_mul_f32 v215, v215, v209
    v_mul_f32 v216, v216, v210
    v_mul_f32 v217, v217, v210
    v_mul_f32 v218, v218, v210
    v_mul_f32 v219, v219, v210
    v_accvgpr_write_b32 a96, v212
    v_accvgpr_write_b32 a97, v213
    v_accvgpr_write_b32 a98, v214
    v_accvgpr_write_b32 a99, v215
    v_accvgpr_write_b32 a100, v216
    v_accvgpr_write_b32 a101, v217
    v_accvgpr_write_b32 a102, v218
    v_accvgpr_write_b32 a103, v219
    v_accvgpr_read_b32 v212, a104
    v_accvgpr_read_b32 v213, a105
    v_accvgpr_read_b32 v214, a106
    v_accvgpr_read_b32 v215, a107
    v_accvgpr_read_b32 v216, a108
    v_accvgpr_read_b32 v217, a109
    v_accvgpr_read_b32 v218, a110
    v_accvgpr_read_b32 v219, a111
    v_mul_f32 v212, v212, v211
    v_mul_f32 v213, v213, v211
    v_mul_f32 v214, v214, v211
    v_mul_f32 v215, v215, v211
    v_mul_f32 v216, v216, v209
    v_mul_f32 v217, v217, v209
    v_mul_f32 v218, v218, v209
    v_mul_f32 v219, v219, v209
    v_accvgpr_write_b32 a104, v212
    v_accvgpr_write_b32 a105, v213
    v_accvgpr_write_b32 a106, v214
    v_accvgpr_write_b32 a107, v215
    v_accvgpr_write_b32 a108, v216
    v_accvgpr_write_b32 a109, v217
    v_accvgpr_write_b32 a110, v218
    v_accvgpr_write_b32 a111, v219
    v_accvgpr_read_b32 v212, a112
    v_accvgpr_read_b32 v213, a113
    v_accvgpr_read_b32 v214, a114
    v_accvgpr_read_b32 v215, a115
    v_accvgpr_read_b32 v216, a116
    v_accvgpr_read_b32 v217, a117
    v_accvgpr_read_b32 v218, a118
    v_accvgpr_read_b32 v219, a119
    v_mul_f32 v212, v212, v210
    v_mul_f32 v213, v213, v210
    v_mul_f32 v214, v214, v210
    v_mul_f32 v215, v215, v210
    v_mul_f32 v216, v216, v211
    v_mul_f32 v217, v217, v211
    v_mul_f32 v218, v218, v211
    v_mul_f32 v219, v219, v211
    v_accvgpr_write_b32 a112, v212
    v_accvgpr_write_b32 a113, v213
    v_accvgpr_write_b32 a114, v214
    v_accvgpr_write_b32 a115, v215
    v_accvgpr_write_b32 a116, v216
    v_accvgpr_write_b32 a117, v217
    v_accvgpr_write_b32 a118, v218
    v_accvgpr_write_b32 a119, v219
    v_accvgpr_read_b32 v212, a120
    v_accvgpr_read_b32 v213, a121
    v_accvgpr_read_b32 v214, a122
    v_accvgpr_read_b32 v215, a123
    v_accvgpr_read_b32 v216, a124
    v_accvgpr_read_b32 v217, a125
    v_accvgpr_read_b32 v218, a126
    v_accvgpr_read_b32 v219, a127
    v_mul_f32 v212, v212, v209
    v_mul_f32 v213, v213, v209
    v_mul_f32 v214, v214, v209
    v_mul_f32 v215, v215, v209
    v_mul_f32 v216, v216, v210
    v_mul_f32 v217, v217, v210
    v_mul_f32 v218, v218, v210
    v_mul_f32 v219, v219, v210
    v_accvgpr_write_b32 a120, v212
    v_accvgpr_write_b32 a121, v213
    v_accvgpr_write_b32 a122, v214
    v_accvgpr_write_b32 a123, v215
    v_accvgpr_write_b32 a124, v216
    v_accvgpr_write_b32 a125, v217
    v_accvgpr_write_b32 a126, v218
    v_accvgpr_write_b32 a127, v219
    v_accvgpr_read_b32 v212, a128
    v_accvgpr_read_b32 v213, a129
    v_accvgpr_read_b32 v214, a130
    v_accvgpr_read_b32 v215, a131
    v_accvgpr_read_b32 v216, a132
    v_accvgpr_read_b32 v217, a133
    v_accvgpr_read_b32 v218, a134
    v_accvgpr_read_b32 v219, a135
    v_mul_f32 v212, v212, v211
    v_mul_f32 v213, v213, v211
    v_mul_f32 v214, v214, v211
    v_mul_f32 v215, v215, v211
    v_mul_f32 v216, v216, v209
    v_mul_f32 v217, v217, v209
    v_mul_f32 v218, v218, v209
    v_mul_f32 v219, v219, v209
    v_accvgpr_write_b32 a128, v212
    v_accvgpr_write_b32 a129, v213
    v_accvgpr_write_b32 a130, v214
    v_accvgpr_write_b32 a131, v215
    v_accvgpr_write_b32 a132, v216
    v_accvgpr_write_b32 a133, v217
    v_accvgpr_write_b32 a134, v218
    v_accvgpr_write_b32 a135, v219
    v_accvgpr_read_b32 v212, a136
    v_accvgpr_read_b32 v213, a137
    v_accvgpr_read_b32 v214, a138
    v_accvgpr_read_b32 v215, a139
    v_accvgpr_read_b32 v216, a140
    v_accvgpr_read_b32 v217, a141
    v_accvgpr_read_b32 v218, a142
    v_accvgpr_read_b32 v219, a143
    v_mul_f32 v212, v212, v210
    v_mul_f32 v213, v213, v210
    v_mul_f32 v214, v214, v210
    v_mul_f32 v215, v215, v210
    v_mul_f32 v216, v216, v211
    v_mul_f32 v217, v217, v211
    v_mul_f32 v218, v218, v211
    v_mul_f32 v219, v219, v211
    v_accvgpr_write_b32 a136, v212
    v_accvgpr_write_b32 a137, v213
    v_accvgpr_write_b32 a138, v214
    v_accvgpr_write_b32 a139, v215
    v_accvgpr_write_b32 a140, v216
    v_accvgpr_write_b32 a141, v217
    v_accvgpr_write_b32 a142, v218
    v_accvgpr_write_b32 a143, v219
    s_mov_b32 s72, 0
    s_nop 1
L_k1_rs_13_skip:
    s_mov_b32 s61, s77
    s_waitcnt vmcnt(18)
    s_barrier
    s_add_u32 s77, s61, 24576
    s_cmp_eq_u32 s77, 147456
    s_cselect_b32 s77, 0, s77
    ds_read_b64_tr_b16 v[160:161], v188 offset:128
    ds_read_b64_tr_b16 v[162:163], v188 offset:6272
    s_waitcnt lgkmcnt(8)
    v_mfma_f32_16x16x32_bf16 a[0:3], v[144:147], v[120:123], a[0:3]
    v_exp_f32 v228, v96
    v_exp_f32 v229, v97
    v_exp_f32 v230, v98
    v_mfma_f32_16x16x32_bf16 a[4:7], v[144:147], v[124:127], a[4:7]
    v_exp_f32 v231, v99
    v_exp_f32 v232, v108
    v_mfma_f32_16x16x32_bf16 a[8:11], v[144:147], v[128:131], a[8:11]
    v_exp_f32 v233, v109
    v_exp_f32 v234, v110
    v_exp_f32 v235, v111
    ds_read_b64_tr_b16 v[164:165], v189 offset:128
    ds_read_b64_tr_b16 v[166:167], v189 offset:6272
    s_waitcnt lgkmcnt(8)
    v_mfma_f32_16x16x32_bf16 a[12:15], v[148:151], v[120:123], a[12:15]
    v_exp_f32 v236, v100
    v_exp_f32 v237, v101
    v_mfma_f32_16x16x32_bf16 a[16:19], v[148:151], v[124:127], a[16:19]
    v_exp_f32 v238, v102
    v_exp_f32 v239, v103
    v_exp_f32 v240, v112
    v_mfma_f32_16x16x32_bf16 a[20:23], v[148:151], v[128:131], a[20:23]
    v_exp_f32 v241, v113
    v_exp_f32 v242, v114
    ds_read_b64_tr_b16 v[144:145], v190 offset:128
    ds_read_b64_tr_b16 v[146:147], v190 offset:6272
    s_waitcnt lgkmcnt(8)
    v_mfma_f32_16x16x32_bf16 a[24:27], v[152:155], v[120:123], a[24:27]
    v_exp_f32 v243, v115
    v_exp_f32 v244, v104
    v_exp_f32 v245, v105
    v_mfma_f32_16x16x32_bf16 a[28:31], v[152:155], v[124:127], a[28:31]
    v_exp_f32 v246, v106
    v_exp_f32 v247, v107
    v_mfma_f32_16x16x32_bf16 a[32:35], v[152:155], v[128:131], a[32:35]
    v_exp_f32 v248, v116
    v_exp_f32 v249, v117
    v_exp_f32 v250, v118
    ds_read_b64_tr_b16 v[148:149], v191 offset:128
    ds_read_b64_tr_b16 v[150:151], v191 offset:6272
    s_waitcnt lgkmcnt(8)
    v_mfma_f32_16x16x32_bf16 a[36:39], v[156:159], v[120:123], a[36:39]
    v_exp_f32 v251, v119
    v_add_f32 v212, v228, v229
    v_mfma_f32_16x16x32_bf16 a[40:43], v[156:159], v[124:127], a[40:43]
    v_add_f32 v213, v236, v237
    v_add_f32 v214, v244, v245
    v_add_f32 v212, v212, v230
    v_mfma_f32_16x16x32_bf16 a[44:47], v[156:159], v[128:131], a[44:47]
    v_add_f32 v213, v213, v238
    v_add_f32 v214, v214, v246
    ds_read_b64_tr_b16 v[152:153], v188 offset:256
    ds_read_b64_tr_b16 v[154:155], v188 offset:6400
    s_waitcnt lgkmcnt(8)
    v_mfma_f32_16x16x32_bf16 a[48:51], v[160:163], v[120:123], a[48:51]
    v_add_f32 v212, v212, v231
    v_add_f32 v213, v213, v239
    v_add_f32 v214, v214, v247
    v_mfma_f32_16x16x32_bf16 a[52:55], v[160:163], v[124:127], a[52:55]
    v_add_f32 v212, v212, v232
    v_add_f32 v213, v213, v240
    v_mfma_f32_16x16x32_bf16 a[56:59], v[160:163], v[128:131], a[56:59]
    v_add_f32 v214, v214, v248
    v_add_f32 v212, v212, v233
    v_add_f32 v213, v213, v241
    ds_read_b64_tr_b16 v[156:157], v189 offset:256
    ds_read_b64_tr_b16 v[158:159], v189 offset:6400
    s_waitcnt lgkmcnt(8)
    v_mfma_f32_16x16x32_bf16 a[60:63], v[164:167], v[120:123], a[60:63]
    v_add_f32 v214, v214, v249
    v_add_f32 v212, v212, v234
    v_mfma_f32_16x16x32_bf16 a[64:67], v[164:167], v[124:127], a[64:67]
    v_add_f32 v213, v213, v242
    v_add_f32 v214, v214, v250
    v_add_f32 v212, v212, v235
    v_mfma_f32_16x16x32_bf16 a[68:71], v[164:167], v[128:131], a[68:71]
    v_add_f32 v213, v213, v243
    v_add_f32 v214, v214, v251
    ds_read_b64_tr_b16 v[160:161], v190 offset:256
    ds_read_b64_tr_b16 v[162:163], v190 offset:6400
    s_waitcnt lgkmcnt(8)
    v_mfma_f32_16x16x32_bf16 a[72:75], v[144:147], v[120:123], a[72:75]
    v_cmp_gt_f32 s[80:81], v212, s71
    v_cmp_gt_f32 s[82:83], v213, s71
    v_cmp_gt_f32 s[84:85], v214, s71
    v_mfma_f32_16x16x32_bf16 a[76:79], v[144:147], v[124:127], a[76:79]
    s_or_b64 s[80:81], s[80:81], s[82:83]
    s_or_b64 s[80:81], s[80:81], s[84:85]
    v_mfma_f32_16x16x32_bf16 a[80:83], v[144:147], v[128:131], a[80:83]
    s_cbranch_scc1 L_k1_sm_14_slow
L_k1_sm_14_ret:
    s_add_u32 m0, s79, 0
    ds_read_b64_tr_b16 v[164:165], v191 offset:256
    ds_read_b64_tr_b16 v[166:167], v191 offset:6400
    s_waitcnt lgkmcnt(8)
    v_mfma_f32_16x16x32_bf16 a[84:87], v[148:151], v[120:123], a[84:87]
    s_nop 0
    buffer_load_dwordx4 v197, s[52:55], s66 offen nt lds
    v_mfma_f32_16x16x32_bf16 a[88:91], v[148:151], v[124:127], a[88:91]
    s_add_u32 m0, s79, 1024
    s_nop 0
    buffer_load_dwordx4 v198, s[52:55], s66 offen nt lds
    v_mfma_f32_16x16x32_bf16 a[92:95], v[148:151], v[128:131], a[92:95]
    s_add_u32 m0, s79, 2048
    s_nop 0
    v_add_u32 v188, s77, v182
    v_add_u32 v189, s77, v183
    v_add_u32 v190, s77, v184
    v_add_u32 v191, s77, v185
    ds_read_b64_tr_b16 v[144:145], v188 offset:0
    ds_read_b64_tr_b16 v[146:147], v188 offset:6144
    s_waitcnt lgkmcnt(8)
    v_mfma_f32_16x16x32_bf16 a[96:99], v[152:155], v[120:123], a[96:99]
    buffer_load_dwordx4 v199, s[52:55], s66 offen nt lds
    s_add_u32 m0, s79, 12288
    s_nop 0
    v_mfma_f32_16x16x32_bf16 a[100:103], v[152:155], v[124:127], a[100:103]
    buffer_load_dwordx4 v197, s[48:51], s65 offen nt lds
    s_add_u32 m0, s79, 13312
    v_mfma_f32_16x16x32_bf16 a[104:107], v[152:155], v[128:131], a[104:107]
    s_nop 0
    buffer_load_dwordx4 v198, s[48:51], s65 offen nt lds
    s_add_u32 m0, s79, 14336
    ds_read_b64_tr_b16 v[148:149], v189 offset:0
    ds_read_b64_tr_b16 v[150:151], v189 offset:6144
    s_waitcnt lgkmcnt(8)
    v_mfma_f32_16x16x32_bf16 a[108:111], v[156:159], v[120:123], a[108:111]
    s_nop 0
    buffer_load_dwordx4 v199, s[48:51], s65 offen nt lds
    v_mfma_f32_16x16x32_bf16 a[112:115], v[156:159], v[124:127], a[112:115]
    s_add_u32 s66, s66, 12288
    s_add_u32 s65, s65, 12288
    s_add_u32 s79, s79, 24576
    v_mfma_f32_16x16x32_bf16 a[116:119], v[156:159], v[128:131], a[116:119]
    s_cmp_ge_u32 s79, 147456
    s_cselect_b32 s79, s67, s79
    ds_read_b64_tr_b16 v[152:153], v190 offset:0
    ds_read_b64_tr_b16 v[154:155], v190 offset:6144
    s_waitcnt lgkmcnt(8)
    v_mfma_f32_16x16x32_bf16 a[120:123], v[160:163], v[120:123], a[120:123]
    v_add_f32 v206, v206, v212
    v_add_f32 v207, v207, v213
    v_add_f32 v208, v208, v214
    v_mfma_f32_16x16x32_bf16 a[124:127], v[160:163], v[124:127], a[124:127]
    v_cvt_pk_bf16_f32 v132, v228, v229
    v_cvt_pk_bf16_f32 v133, v230, v231
    v_mfma_f32_16x16x32_bf16 a[128:131], v[160:163], v[128:131], a[128:131]
    v_cvt_pk_bf16_f32 v134, v232, v233
    v_cvt_pk_bf16_f32 v135, v234, v235
    v_cvt_pk_bf16_f32 v136, v236, v237
    ds_read_b64_tr_b16 v[156:157], v191 offset:0
    ds_read_b64_tr_b16 v[158:159], v191 offset:6144
    s_waitcnt lgkmcnt(8)
    v_mfma_f32_16x16x32_bf16 a[132:135], v[164:167], v[120:123], a[132:135]
    v_cvt_pk_bf16_f32 v137, v238, v239
    v_cvt_pk_bf16_f32 v138, v240, v241
    v_mfma_f32_16x16x32_bf16 a[136:139], v[164:167], v[124:127], a[136:139]
    v_cvt_pk_bf16_f32 v139, v242, v243
    v_cvt_pk_bf16_f32 v140, v244, v245
    v_cvt_pk_bf16_f32 v141, v246, v247
    v_mfma_f32_16x16x32_bf16 a[140:143], v[164:167], v[128:131], a[140:143]
    v_cvt_pk_bf16_f32 v142, v248, v249
    v_cvt_pk_bf16_f32 v143, v250, v251
    s_nop 7
    s_cmp_eq_u32 s72, 0
    s_cbranch_scc1 L_k1_rs_15_skip
    s_nop 7
    v_accvgpr_read_b32 v212, a0
    v_accvgpr_read_b32 v213, a1
    v_accvgpr_read_b32 v214, a2
    v_accvgpr_read_b32 v215, a3
    v_accvgpr_read_b32 v216, a4
    v_accvgpr_read_b32 v217, a5
    v_accvgpr_read_b32 v218, a6
    v_accvgpr_read_b32 v219, a7
    v_mul_f32 v212, v212, v209
    v_mul_f32 v213, v213, v209
    v_mul_f32 v214, v214, v209
    v_mul_f32 v215, v215, v209
    v_mul_f32 v216, v216, v210
    v_mul_f32 v217, v217, v210
    v_mul_f32 v218, v218, v210
    v_mul_f32 v219, v219, v210
    v_accvgpr_write_b32 a0, v212
    v_accvgpr_write_b32 a1, v213
    v_accvgpr_write_b32 a2, v214
    v_accvgpr_write_b32 a3, v215
    v_accvgpr_write_b32 a4, v216
    v_accvgpr_write_b32 a5, v217
    v_accvgpr_write_b32 a6, v218
    v_accvgpr_write_b32 a7, v219
    v_accvgpr_read_b32 v212, a8
    v_accvgpr_read_b32 v213, a9
    v_accvgpr_read_b32 v214, a10
    v_accvgpr_read_b32 v215, a11
    v_accvgpr_read_b32 v216, a12
    v_accvgpr_read_b32 v217, a13
    v_accvgpr_read_b32 v218, a14
    v_accvgpr_read_b32 v219, a15
    v_mul_f32 v212, v212, v211
    v_mul_f32 v213, v213, v211
    v_mul_f32 v214, v214, v211
    v_mul_f32 v215, v215, v211
    v_mul_f32 v216, v216, v209
    v_mul_f32 v217, v217, v209
    v_mul_f32 v218, v218, v209
    v_mul_f32 v219, v219, v209
    v_accvgpr_write_b32 a8, v212
    v_accvgpr_write_b32 a9, v213
    v_accvgpr_write_b32 a10, v214
    v_accvgpr_write_b32 a11, v215
    v_accvgpr_write_b32 a12, v216
    v_accvgpr_write_b32 a13, v217
    v_accvgpr_write_b32 a14, v218
    v_accvgpr_write_b32 a15, v219
    v_accvgpr_read_b32 v212, a16
    v_accvgpr_read_b32 v213, a17
    v_accvgpr_read_b32 v214, a18
    v_accvgpr_read_b32 v215, a19
    v_accvgpr_read_b32 v216, a20
    v_accvgpr_read_b32 v217, a21
    v_accvgpr_read_b32 v218, a22
    v_accvgpr_read_b32 v219, a23
    v_mul_f32 v212, v212, v210
    v_mul_f32 v213, v213, v210
    v_mul_f32 v214, v214, v210
    v_mul_f32 v215, v215, v210
    v_mul_f32 v216, v216, v211
    v_mul_f32 v217, v217, v211
    v_mul_f32 v218, v218, v211
    v_mul_f32 v219, v219, v211
    v_accvgpr_write_b32 a16, v212
    v_accvgpr_write_b32 a17, v213
    v_accvgpr_write_b32 a18, v214
    v_accvgpr_write_b32 a19, v215
    v_accvgpr_write_b32 a20, v216
    v_accvgpr_write_b32 a21, v217
    v_accvgpr_write_b32 a22, v218
    v_accvgpr_write_b32 a23, v219
    v_accvgpr_read_b32 v212, a24
    v_accvgpr_read_b32 v213, a25
    v_accvgpr_read_b32 v214, a26
    v_accvgpr_read_b32 v215, a27
    v_accvgpr_read_b32 v216, a28
    v_accvgpr_read_b32 v217, a29
    v_accvgpr_read_b32 v218, a30
    v_accvgpr_read_b32 v219, a31
    v_mul_f32 v212, v212, v209
    v_mul_f32 v213, v213, v209
    v_mul_f32 v214, v214, v209
    v_mul_f32 v215, v215, v209
    v_mul_f32 v216, v216, v210
    v_mul_f32 v217, v217, v210
    v_mul_f32 v218, v218, v210
    v_mul_f32 v219, v219, v210
    v_accvgpr_write_b32 a24, v212
    v_accvgpr_write_b32 a25, v213
    v_accvgpr_write_b32 a26, v214
    v_accvgpr_write_b32 a27, v215
    v_accvgpr_write_b32 a28, v216
    v_accvgpr_write_b32 a29, v217
    v_accvgpr_write_b32 a30, v218
    v_accvgpr_write_b32 a31, v219
    v_accvgpr_read_b32 v212, a32
    v_accvgpr_read_b32 v213, a33
    v_accvgpr_read_b32 v214, a34
    v_accvgpr_read_b32 v215, a35
    v_accvgpr_read_b32 v216, a36
    v_accvgpr_read_b32 v217, a37
    v_accvgpr_read_b32 v218, a38
    v_accvgpr_read_b32 v219, a39
    v_mul_f32 v212, v212, v211
    v_mul_f32 v213, v213, v211
    v_mul_f32 v214, v214, v211
    v_mul_f32 v215, v215, v211
    v_mul_f32 v216, v216, v209
    v_mul_f32 v217, v217, v209
    v_mul_f32 v218, v218, v209
    v_mul_f32 v219, v219, v209
    v_accvgpr_write_b32 a32, v212
    v_accvgpr_write_b32 a33, v213
    v_accvgpr_write_b32 a34, v214
    v_accvgpr_write_b32 a35, v215
    v_accvgpr_write_b32 a36, v216
    v_accvgpr_write_b32 a37, v217
    v_accvgpr_write_b32 a38, v218
    v_accvgpr_write_b32 a39, v219
    v_accvgpr_read_b32 v212, a40
    v_accvgpr_read_b32 v213, a41
    v_accvgpr_read_b32 v214, a42
    v_accvgpr_read_b32 v215, a43
    v_accvgpr_read_b32 v216, a44
    v_accvgpr_read_b32 v217, a45
    v_accvgpr_read_b32 v218, a46
    v_accvgpr_read_b32 v219, a47
    v_mul_f32 v212, v212, v210
    v_mul_f32 v213, v213, v210
    v_mul_f32 v214, v214, v210
    v_mul_f32 v215, v215, v210
    v_mul_f32 v216, v216, v211
    v_mul_f32 v217, v217, v211
    v_mul_f32 v218, v218, v211
    v_mul_f32 v219, v219, v211
    v_accvgpr_write_b32 a40, v212
    v_accvgpr_write_b32 a41, v213
    v_accvgpr_write_b32 a42, v214
    v_accvgpr_write_b32 a43, v215
    v_accvgpr_write_b32 a44, v216
    v_accvgpr_write_b32 a45, v217
    v_accvgpr_write_b32 a46, v218
    v_accvgpr_write_b32 a47, v219
    v_accvgpr_read_b32 v212, a48
    v_accvgpr_read_b32 v213, a49
    v_accvgpr_read_b32 v214, a50
    v_accvgpr_read_b32 v215, a51
    v_accvgpr_read_b32 v216, a52
    v_accvgpr_read_b32 v217, a53
    v_accvgpr_read_b32 v218, a54
    v_accvgpr_read_b32 v219, a55
    v_mul_f32 v212, v212, v209
    v_mul_f32 v213, v213, v209
    v_mul_f32 v214, v214, v209
    v_mul_f32 v215, v215, v209
    v_mul_f32 v216, v216, v210
    v_mul_f32 v217, v217, v210
    v_mul_f32 v218, v218, v210
    v_mul_f32 v219, v219, v210
    v_accvgpr_write_b32 a48, v212
    v_accvgpr_write_b32 a49, v213
    v_accvgpr_write_b32 a50, v214
    v_accvgpr_write_b32 a51, v215
    v_accvgpr_write_b32 a52, v216
    v_accvgpr_write_b32 a53, v217
    v_accvgpr_write_b32 a54, v218
    v_accvgpr_write_b32 a55, v219
    v_accvgpr_read_b32 v212, a56
    v_accvgpr_read_b32 v213, a57
    v_accvgpr_read_b32 v214, a58
    v_accvgpr_read_b32 v215, a59
    v_accvgpr_read_b32 v216, a60
    v_accvgpr_read_b32 v217, a61
    v_accvgpr_read_b32 v218, a62
    v_accvgpr_read_b32 v219, a63
    v_mul_f32 v212, v212, v211
    v_mul_f32 v213, v213, v211
    v_mul_f32 v214, v214, v211
    v_mul_f32 v215, v215, v211
    v_mul_f32 v216, v216, v209
    v_mul_f32 v217, v217, v209
    v_mul_f32 v218, v218, v209
    v_mul_f32 v219, v219, v209
    v_accvgpr_write_b32 a56, v212
    v_accvgpr_write_b32 a57, v213
    v_accvgpr_write_b32 a58, v214
    v_accvgpr_write_b32 a59, v215
    v_accvgpr_write_b32 a60, v216
    v_accvgpr_write_b32 a61, v217
    v_accvgpr_write_b32 a62, v218
    v_accvgpr_write_b32 a63, v219
    v_accvgpr_read_b32 v212, a64
    v_accvgpr_read_b32 v213, a65
    v_accvgpr_read_b32 v214, a66
    v_accvgpr_read_b32 v215, a67
    v_accvgpr_read_b32 v216, a68
    v_accvgpr_read_b32 v217, a69
    v_accvgpr_read_b32 v218, a70
    v_accvgpr_read_b32 v219, a71
    v_mul_f32 v212, v212, v210
    v_mul_f32 v213, v213, v210
    v_mul_f32 v214, v214, v210
    v_mul_f32 v215, v215, v210
    v_mul_f32 v216, v216, v211
    v_mul_f32 v217, v217, v211
    v_mul_f32 v218, v218, v211
    v_mul_f32 v219, v219, v211
    v_accvgpr_write_b32 a64, v212
    v_accvgpr_write_b32 a65, v213
    v_accvgpr_write_b32 a66, v214
    v_accvgpr_write_b32 a67, v215
    v_accvgpr_write_b32 a68, v216
    v_accvgpr_write_b32 a69, v217
    v_accvgpr_write_b32 a70, v218
    v_accvgpr_write_b32 a71, v219
    v_accvgpr_read_b32 v212, a72
    v_accvgpr_read_b32 v213, a73
    v_accvgpr_read_b32 v214, a74
    v_accvgpr_read_b32 v215, a75
    v_accvgpr_read_b32 v216, a76
    v_accvgpr_read_b32 v217, a77
    v_accvgpr_read_b32 v218, a78
    v_accvgpr_read_b32 v219, a79
    v_mul_f32 v212, v212, v209
    v_mul_f32 v213, v213, v209
    v_mul_f32 v214, v214, v209
    v_mul_f32 v215, v215, v209
    v_mul_f32 v216, v216, v210
    v_mul_f32 v217, v217, v210
    v_mul_f32 v218, v218, v210
    v_mul_f32 v219, v219, v210
    v_accvgpr_write_b32 a72, v212
    v_accvgpr_write_b32 a73, v213
    v_accvgpr_write_b32 a74, v214
    v_accvgpr_write_b32 a75, v215
    v_accvgpr_write_b32 a76, v216
    v_accvgpr_write_b32 a77, v217
    v_accvgpr_write_b32 a78, v218
    v_accvgpr_write_b32 a79, v219
    v_accvgpr_read_b32 v212, a80
    v_accvgpr_read_b32 v213, a81
    v_accvgpr_read_b32 v214, a82
    v_accvgpr_read_b32 v215, a83
    v_accvgpr_read_b32 v216, a84
    v_accvgpr_read_b32 v217, a85
    v_accvgpr_read_b32 v218, a86
    v_accvgpr_read_b32 v219, a87
    v_mul_f32 v212, v212, v211
    v_mul_f32 v213, v213, v211
    v_mul_f32 v214, v214, v211
    v_mul_f32 v215, v215, v211
    v_mul_f32 v216, v216, v209
    v_mul_f32 v217, v217, v209
    v_mul_f32 v218, v218, v209
    v_mul_f32 v219, v219, v209
    v_accvgpr_write_b32 a80, v212
    v_accvgpr_write_b32 a81, v213
    v_accvgpr_write_b32 a82, v214
    v_accvgpr_write_b32 a83, v215
    v_accvgpr_write_b32 a84, v216
    v_accvgpr_write_b32 a85, v217
    v_accvgpr_write_b32 a86, v218
    v_accvgpr_write_b32 a87, v219
    v_accvgpr_read_b32 v212, a88
    v_accvgpr_read_b32 v213, a89
    v_accvgpr_read_b32 v214, a90
    v_accvgpr_read_b32 v215, a91
    v_accvgpr_read_b32 v216, a92
    v_accvgpr_read_b32 v217, a93
    v_accvgpr_read_b32 v218, a94
    v_accvgpr_read_b32 v219, a95
    v_mul_f32 v212, v212, v210
    v_mul_f32 v213, v213, v210
    v_mul_f32 v214, v214, v210
    v_mul_f32 v215, v215, v210
    v_mul_f32 v216, v216, v211
    v_mul_f32 v217, v217, v211
    v_mul_f32 v218, v218, v211
    v_mul_f32 v219, v219, v211
    v_accvgpr_write_b32 a88, v212
    v_accvgpr_write_b32 a89, v213
    v_accvgpr_write_b32 a90, v214
    v_accvgpr_write_b32 a91, v215
    v_accvgpr_write_b32 a92, v216
    v_accvgpr_write_b32 a93, v217
    v_accvgpr_write_b32 a94, v218
    v_accvgpr_write_b32 a95, v219
    v_accvgpr_read_b32 v212, a96
    v_accvgpr_read_b32 v213, a97
    v_accvgpr_read_b32 v214, a98
    v_accvgpr_read_b32 v215, a99
    v_accvgpr_read_b32 v216, a100
    v_accvgpr_read_b32 v217, a101
    v_accvgpr_read_b32 v218, a102
    v_accvgpr_read_b32 v219, a103
    v_mul_f32 v212, v212, v209
    v_mul_f32 v213, v213, v209
    v_mul_f32 v214, v214, v209
    v_mul_f32 v215, v215, v209
    v_mul_f32 v216, v216, v210
    v_mul_f32 v217, v217, v210
    v_mul_f32 v218, v218, v210
    v_mul_f32 v219, v219, v210
    v_accvgpr_write_b32 a96, v212
    v_accvgpr_write_b32 a97, v213
    v_accvgpr_write_b32 a98, v214
    v_accvgpr_write_b32 a99, v215
    v_accvgpr_write_b32 a100, v216
    v_accvgpr_write_b32 a101, v217
    v_accvgpr_write_b32 a102, v218
    v_accvgpr_write_b32 a103, v219
    v_accvgpr_read_b32 v212, a104
    v_accvgpr_read_b32 v213, a105
    v_accvgpr_read_b32 v214, a106
    v_accvgpr_read_b32 v215, a107
    v_accvgpr_read_b32 v216, a108
    v_accvgpr_read_b32 v217, a109
    v_accvgpr_read_b32 v218, a110
    v_accvgpr_read_b32 v219, a111
    v_mul_f32 v212, v212, v211
    v_mul_f32 v213, v213, v211
    v_mul_f32 v214, v214, v211
    v_mul_f32 v215, v215, v211
    v_mul_f32 v216, v216, v209
    v_mul_f32 v217, v217, v209
    v_mul_f32 v218, v218, v209
    v_mul_f32 v219, v219, v209
    v_accvgpr_write_b32 a104, v212
    v_accvgpr_write_b32 a105, v213
    v_accvgpr_write_b32 a106, v214
    v_accvgpr_write_b32 a107, v215
    v_accvgpr_write_b32 a108, v216
    v_accvgpr_write_b32 a109, v217
    v_accvgpr_write_b32 a110, v218
    v_accvgpr_write_b32 a111, v219
    v_accvgpr_read_b32 v212, a112
    v_accvgpr_read_b32 v213, a113
    v_accvgpr_read_b32 v214, a114
    v_accvgpr_read_b32 v215, a115
    v_accvgpr_read_b32 v216, a116
    v_accvgpr_read_b32 v217, a117
    v_accvgpr_read_b32 v218, a118
    v_accvgpr_read_b32 v219, a119
    v_mul_f32 v212, v212, v210
    v_mul_f32 v213, v213, v210
    v_mul_f32 v214, v214, v210
    v_mul_f32 v215, v215, v210
    v_mul_f32 v216, v216, v211
    v_mul_f32 v217, v217, v211
    v_mul_f32 v218, v218, v211
    v_mul_f32 v219, v219, v211
    v_accvgpr_write_b32 a112, v212
    v_accvgpr_write_b32 a113, v213
    v_accvgpr_write_b32 a114, v214
    v_accvgpr_write_b32 a115, v215
    v_accvgpr_write_b32 a116, v216
    v_accvgpr_write_b32 a117, v217
    v_accvgpr_write_b32 a118, v218
    v_accvgpr_write_b32 a119, v219
    v_accvgpr_read_b32 v212, a120
    v_accvgpr_read_b32 v213, a121
    v_accvgpr_read_b32 v214, a122
    v_accvgpr_read_b32 v215, a123
    v_accvgpr_read_b32 v216, a124
    v_accvgpr_read_b32 v217, a125
    v_accvgpr_read_b32 v218, a126
    v_accvgpr_read_b32 v219, a127
    v_mul_f32 v212, v212, v209
    v_mul_f32 v213, v213, v209
    v_mul_f32 v214, v214, v209
    v_mul_f32 v215, v215, v209
    v_mul_f32 v216, v216, v210
    v_mul_f32 v217, v217, v210
    v_mul_f32 v218, v218, v210
    v_mul_f32 v219, v219, v210
    v_accvgpr_write_b32 a120, v212
    v_accvgpr_write_b32 a121, v213
    v_accvgpr_write_b32 a122, v214
    v_accvgpr_write_b32 a123, v215
    v_accvgpr_write_b32 a124, v216
    v_accvgpr_write_b32 a125, v217
    v_accvgpr_write_b32 a126, v218
    v_accvgpr_write_b32 a127, v219
    v_accvgpr_read_b32 v212, a128
    v_accvgpr_read_b32 v213, a129
    v_accvgpr_read_b32 v214, a130
    v_accvgpr_read_b32 v215, a131
    v_accvgpr_read_b32 v216, a132
    v_accvgpr_read_b32 v217, a133
    v_accvgpr_read_b32 v218, a134
    v_accvgpr_read_b32 v219, a135
    v_mul_f32 v212, v212, v211
    v_mul_f32 v213, v213, v211
    v_mul_f32 v214, v214, v211
    v_mul_f32 v215, v215, v211
    v_mul_f32 v216, v216, v209
    v_mul_f32 v217, v217, v209
    v_mul_f32 v218, v218, v209
    v_mul_f32 v219, v219, v209
    v_accvgpr_write_b32 a128, v212
    v_accvgpr_write_b32 a129, v213
    v_accvgpr_write_b32 a130, v214
    v_accvgpr_write_b32 a131, v215
    v_accvgpr_write_b32 a132, v216
    v_accvgpr_write_b32 a133, v217
    v_accvgpr_write_b32 a134, v218
    v_accvgpr_write_b32 a135, v219
    v_accvgpr_read_b32 v212, a136
    v_accvgpr_read_b32 v213, a137
    v_accvgpr_read_b32 v214, a138
    v_accvgpr_read_b32 v215, a139
    v_accvgpr_read_b32 v216, a140
    v_accvgpr_read_b32 v217, a141
    v_accvgpr_read_b32 v218, a142
    v_accvgpr_read_b32 v219, a143
    v_mul_f32 v212, v212, v210
    v_mul_f32 v213, v213, v210
    v_mul_f32 v214, v214, v210
    v_mul_f32 v215, v215, v210
    v_mul_f32 v216, v216, v211
    v_mul_f32 v217, v217, v211
    v_mul_f32 v218, v218, v211
    v_mul_f32 v219, v219, v211
    v_accvgpr_write_b32 a136, v212
    v_accvgpr_write_b32 a137, v213
    v_accvgpr_write_b32 a138, v214
    v_accvgpr_write_b32 a139, v215
    v_accvgpr_write_b32 a140, v216
    v_accvgpr_write_b32 a141, v217
    v_accvgpr_write_b32 a142, v218
    v_accvgpr_write_b32 a143, v219
    s_mov_b32 s72, 0
    s_nop 1
L_k1_rs_15_skip:
    s_mov_b32 s61, s77
    s_waitcnt vmcnt(18)
    s_barrier
    s_add_u32 s77, s61, 24576
    s_cmp_eq_u32 s77, 147456
    s_cselect_b32 s77, 0, s77
    ds_read_b64_tr_b16 v[160:161], v188 offset:128
    ds_read_b64_tr_b16 v[162:163], v188 offset:6272
    s_waitcnt lgkmcnt(8)
    v_mfma_f32_16x16x32_bf16 a[0:3], v[144:147], v[132:135], a[0:3]
    s_add_u32 m0, s79, 0
    v_mfma_f32_16x16x32_bf16 a[4:7], v[144:147], v[136:139], a[4:7]
    s_nop 0
    v_mfma_f32_16x16x32_bf16 a[8:11], v[144:147], v[140:143], a[8:11]
    ds_read_b64_tr_b16 v[164:165], v189 offset:128
    ds_read_b64_tr_b16 v[166:167], v189 offset:6272
    s_waitcnt lgkmcnt(8)
    v_mfma_f32_16x16x32_bf16 a[12:15], v[148:151], v[132:135], a[12:15]
    buffer_load_dwordx4 v197, s[52:55], s66 offen nt lds
    v_mfma_f32_16x16x32_bf16 a[16:19], v[148:151], v[136:139], a[16:19]
    s_add_u32 m0, s79, 1024
    v_mfma_f32_16x16x32_bf16 a[20:23], v[148:151], v[140:143], a[20:23]
    ds_read_b64_tr_b16 v[144:145], v190 offset:128
    ds_read_b64_tr_b16 v[146:147], v190 offset:6272
    s_waitcnt lgkmcnt(8)
    v_mfma_f32_16x16x32_bf16 a[24:27], v[152:155], v[132:135], a[24:27]
    s_nop 0
    v_mfma_f32_16x16x32_bf16 a[28:31], v[152:155], v[136:139], a[28:31]
    buffer_load_dwordx4 v198, s[52:55], s66 offen nt lds
    v_mfma_f32_16x16x32_bf16 a[32:35], v[152:155], v[140:143], a[32:35]
    ds_read_b64_tr_b16 v[148:149], v191 offset:128
    ds_read_b64_tr_b16 v[150:151], v191 offset:6272
    s_waitcnt lgkmcnt(8)
    v_mfma_f32_16x16x32_bf16 a[36:39], v[156:159], v[132:135], a[36:39]
    s_add_u32 m0, s79, 2048
    v_mfma_f32_16x16x32_bf16 a[40:43], v[156:159], v[136:139], a[40:43]
    s_nop 0
    v_mfma_f32_16x16x32_bf16 a[44:47], v[156:159], v[140:143], a[44:47]
    ds_read_b64_tr_b16 v[152:153], v188 offset:256
    ds_read_b64_tr_b16 v[154:155], v188 offset:6400
    s_waitcnt lgkmcnt(8)
    v_mfma_f32_16x16x32_bf16 a[48:51], v[160:163], v[132:135], a[48:51]
    buffer_load_dwordx4 v199, s[52:55], s66 offen nt lds
    v_mfma_f32_16x16x32_bf16 a[52:55], v[160:163], v[136:139], a[52:55]
    v_mfma_f32_16x16x32_bf16 a[56:59], v[160:163], v[140:143], a[56:59]
    s_add_u32 m0, s79, 12288
    ds_read_b64_tr_b16 v[156:157], v189 offset:256
    ds_read_b64_tr_b16 v[158:159], v189 offset:6400
    s_waitcnt lgkmcnt(8)
    v_mfma_f32_16x16x32_bf16 a[60:63], v[164:167], v[132:135], a[60:63]
    s_nop 0
    v_mfma_f32_16x16x32_bf16 a[64:67], v[164:167], v[136:139], a[64:67]
    v_mfma_f32_16x16x32_bf16 a[68:71], v[164:167], v[140:143], a[68:71]
    buffer_load_dwordx4 v197, s[48:51], s65 offen nt lds
    ds_read_b64_tr_b16 v[160:161], v190 offset:256
    ds_read_b64_tr_b16 v[162:163], v190 offset:6400
    s_waitcnt lgkmcnt(8)
    v_mfma_f32_16x16x32_bf16 a[72:75], v[144:147], v[132:135], a[72:75]
    s_add_u32 m0, s79, 13312
    v_mfma_f32_16x16x32_bf16 a[76:79], v[144:147], v[136:139], a[76:79]
    v_mfma_f32_16x16x32_bf16 a[80:83], v[144:147], v[140:143], a[80:83]
    s_nop 0
    ds_read_b64_tr_b16 v[164:165], v191 offset:256
    ds_read_b64_tr_b16 v[166:167], v191 offset:6400
    s_waitcnt lgkmcnt(8)
    v_mfma_f32_16x16x32_bf16 a[84:87], v[148:151], v[132:135], a[84:87]
    buffer_load_dwordx4 v198, s[48:51], s65 offen nt lds
    v_mfma_f32_16x16x32_bf16 a[88:91], v[148:151], v[136:139], a[88:91]
    v_mfma_f32_16x16x32_bf16 a[92:95], v[148:151], v[140:143], a[92:95]
    s_add_u32 m0, s79, 14336
    s_waitcnt lgkmcnt(6)
    v_mfma_f32_16x16x32_bf16 a[96:99], v[152:155], v[132:135], a[96:99]
    v_mfma_f32_16x16x32_bf16 a[100:103], v[152:155], v[136:139], a[100:103]
    s_nop 0
    v_mfma_f32_16x16x32_bf16 a[104:107], v[152:155], v[140:143], a[104:107]
    buffer_load_dwordx4 v199, s[48:51], s65 offen nt lds
    s_waitcnt lgkmcnt(4)
    v_mfma_f32_16x16x32_bf16 a[108:111], v[156:159], v[132:135], a[108:111]
    v_mfma_f32_16x16x32_bf16 a[112:115], v[156:159], v[136:139], a[112:115]
    s_add_u32 s66, s66, 12288
    v_mfma_f32_16x16x32_bf16 a[116:119], v[156:159], v[140:143], a[116:119]
    s_add_u32 s65, s65, 12288
    s_waitcnt lgkmcnt(2)
    v_mfma_f32_16x16x32_bf16 a[120:123], v[160:163], v[132:135], a[120:123]
    v_mfma_f32_16x16x32_bf16 a[124:127], v[160:163], v[136:139], a[124:127]
    s_add_u32 s79, s79, 24576
    v_mfma_f32_16x16x32_bf16 a[128:131], v[160:163], v[140:143], a[128:131]
    s_cmp_ge_u32 s79, 147456
    s_waitcnt lgkmcnt(0)
    v_mfma_f32_16x16x32_bf16 a[132:135], v[164:167], v[132:135], a[132:135]
    v_mfma_f32_16x16x32_bf16 a[136:139], v[164:167], v[136:139], a[136:139]
    s_cselect_b32 s79, s67, s79
    v_mfma_f32_16x16x32_bf16 a[140:143], v[164:167], v[140:143], a[140:143]
    s_mov_b32 s61, s77
    v_mov_b32 v220, v206
    s_nop 1
    v_permlane32_swap_b32 v206, v220
    v_add_f32 v206, v206, v220
    v_mov_b32 v220, v206
    s_nop 1
    v_permlane16_swap_b32 v206, v220
    v_add_f32 v206, v206, v220
    v_rcp_f32 v206, v206
    v_mov_b32 v220, v207
    s_nop 1
    v_permlane32_swap_b32 v207, v220
    v_add_f32 v207, v207, v220
    v_mov_b32 v220, v207
    s_nop 1
    v_permlane16_swap_b32 v207, v220
    v_add_f32 v207, v207, v220
    v_rcp_f32 v207, v207
    v_mov_b32 v220, v208
    s_nop 1
    v_permlane32_swap_b32 v208, v220
    v_add_f32 v208, v208, v220
    v_mov_b32 v220, v208
    s_nop 1
    v_permlane16_swap_b32 v208, v220
    v_add_f32 v208, v208, v220
    v_rcp_f32 v208, v208
    s_nop 7
    v_accvgpr_read_b32 v212, a0
    v_accvgpr_read_b32 v213, a1
    v_accvgpr_read_b32 v214, a2
    v_accvgpr_read_b32 v215, a3
    v_accvgpr_read_b32 v216, a12
    v_accvgpr_read_b32 v217, a13
    v_accvgpr_read_b32 v218, a14
    v_accvgpr_read_b32 v219, a15
    v_mul_f32 v212, v212, v206
    v_mul_f32 v213, v213, v206
    v_mul_f32 v214, v214, v206
    v_mul_f32 v215, v215, v206
    v_mul_f32 v216, v216, v206
    v_mul_f32 v217, v217, v206
    v_mul_f32 v218, v218, v206
    v_mul_f32 v219, v219, v206
    v_cvt_pk_bf16_f32 v0, v212, v213
    v_cvt_pk_bf16_f32 v1, v214, v215
    v_cvt_pk_bf16_f32 v2, v216, v217
    v_cvt_pk_bf16_f32 v3, v218, v219
    s_movk_i32 s3, 0
    buffer_store_dwordx4 v[0:3], v224, s[56:59], s3 offen sc0 sc1
    v_accvgpr_read_b32 v212, a24
    v_accvgpr_read_b32 v213, a25
    v_accvgpr_read_b32 v214, a26
    v_accvgpr_read_b32 v215, a27
    v_accvgpr_read_b32 v216, a36
    v_accvgpr_read_b32 v217, a37
    v_accvgpr_read_b32 v218, a38
    v_accvgpr_read_b32 v219, a39
    v_mul_f32 v212, v212, v206
    v_mul_f32 v213, v213, v206
    v_mul_f32 v214, v214, v206
    v_mul_f32 v215, v215, v206
    v_mul_f32 v216, v216, v206
    v_mul_f32 v217, v217, v206
    v_mul_f32 v218, v218, v206
    v_mul_f32 v219, v219, v206
    v_cvt_pk_bf16_f32 v12, v212, v213
    v_cvt_pk_bf16_f32 v13, v214, v215
    v_cvt_pk_bf16_f32 v14, v216, v217
    v_cvt_pk_bf16_f32 v15, v218, v219
    s_movk_i32 s3, 2048
    buffer_store_dwordx4 v[12:15], v224, s[56:59], s3 offen sc0 sc1
    v_accvgpr_read_b32 v212, a48
    v_accvgpr_read_b32 v213, a49
    v_accvgpr_read_b32 v214, a50
    v_accvgpr_read_b32 v215, a51
    v_accvgpr_read_b32 v216, a60
    v_accvgpr_read_b32 v217, a61
    v_accvgpr_read_b32 v218, a62
    v_accvgpr_read_b32 v219, a63
    v_mul_f32 v212, v212, v206
    v_mul_f32 v213, v213, v206
    v_mul_f32 v214, v214, v206
    v_mul_f32 v215, v215, v206
    v_mul_f32 v216, v216, v206
    v_mul_f32 v217, v217, v206
    v_mul_f32 v218, v218, v206
    v_mul_f32 v219, v219, v206
    v_cvt_pk_bf16_f32 v24, v212, v213
    v_cvt_pk_bf16_f32 v25, v214, v215
    v_cvt_pk_bf16_f32 v26, v216, v217
    v_cvt_pk_bf16_f32 v27, v218, v219
    s_movk_i32 s3, 4096
    buffer_store_dwordx4 v[24:27], v224, s[56:59], s3 offen sc0 sc1
    v_accvgpr_read_b32 v212, a72
    v_accvgpr_read_b32 v213, a73
    v_accvgpr_read_b32 v214, a74
    v_accvgpr_read_b32 v215, a75
    v_accvgpr_read_b32 v216, a84
    v_accvgpr_read_b32 v217, a85
    v_accvgpr_read_b32 v218, a86
    v_accvgpr_read_b32 v219, a87
    v_mul_f32 v212, v212, v206
    v_mul_f32 v213, v213, v206
    v_mul_f32 v214, v214, v206
    v_mul_f32 v215, v215, v206
    v_mul_f32 v216, v216, v206
    v_mul_f32 v217, v217, v206
    v_mul_f32 v218, v218, v206
    v_mul_f32 v219, v219, v206
    v_cvt_pk_bf16_f32 v36, v212, v213
    v_cvt_pk_bf16_f32 v37, v214, v215
    v_cvt_pk_bf16_f32 v38, v216, v217
    v_cvt_pk_bf16_f32 v39, v218, v219
    s_movk_i32 s3, 6144
    buffer_store_dwordx4 v[36:39], v224, s[56:59], s3 offen sc0 sc1
    v_accvgpr_read_b32 v212, a96
    v_accvgpr_read_b32 v213, a97
    v_accvgpr_read_b32 v214, a98
    v_accvgpr_read_b32 v215, a99
    v_accvgpr_read_b32 v216, a108
    v_accvgpr_read_b32 v217, a109
    v_accvgpr_read_b32 v218, a110
    v_accvgpr_read_b32 v219, a111
    v_mul_f32 v212, v212, v206
    v_mul_f32 v213, v213, v206
    v_mul_f32 v214, v214, v206
    v_mul_f32 v215, v215, v206
    v_mul_f32 v216, v216, v206
    v_mul_f32 v217, v217, v206
    v_mul_f32 v218, v218, v206
    v_mul_f32 v219, v219, v206
    v_cvt_pk_bf16_f32 v48, v212, v213
    v_cvt_pk_bf16_f32 v49, v214, v215
    v_cvt_pk_bf16_f32 v50, v216, v217
    v_cvt_pk_bf16_f32 v51, v218, v219
    s_movk_i32 s3, 8192
    buffer_store_dwordx4 v[48:51], v224, s[56:59], s3 offen sc0 sc1
    v_accvgpr_read_b32 v212, a120
    v_accvgpr_read_b32 v213, a121
    v_accvgpr_read_b32 v214, a122
    v_accvgpr_read_b32 v215, a123
    v_accvgpr_read_b32 v216, a132
    v_accvgpr_read_b32 v217, a133
    v_accvgpr_read_b32 v218, a134
    v_accvgpr_read_b32 v219, a135
    v_mul_f32 v212, v212, v206
    v_mul_f32 v213, v213, v206
    v_mul_f32 v214, v214, v206
    v_mul_f32 v215, v215, v206
    v_mul_f32 v216, v216, v206
    v_mul_f32 v217, v217, v206
    v_mul_f32 v218, v218, v206
    v_mul_f32 v219, v219, v206
    v_cvt_pk_bf16_f32 v60, v212, v213
    v_cvt_pk_bf16_f32 v61, v214, v215
    v_cvt_pk_bf16_f32 v62, v216, v217
    v_cvt_pk_bf16_f32 v63, v218, v219
    s_movk_i32 s3, 10240
    buffer_store_dwordx4 v[60:63], v224, s[56:59], s3 offen sc0 sc1
    v_accvgpr_read_b32 v212, a4
    v_accvgpr_read_b32 v213, a5
    v_accvgpr_read_b32 v214, a6
    v_accvgpr_read_b32 v215, a7
    v_accvgpr_read_b32 v216, a16
    v_accvgpr_read_b32 v217, a17
    v_accvgpr_read_b32 v218, a18
    v_accvgpr_read_b32 v219, a19
    v_mul_f32 v212, v212, v207
    v_mul_f32 v213, v213, v207
    v_mul_f32 v214, v214, v207
    v_mul_f32 v215, v215, v207
    v_mul_f32 v216, v216, v207
    v_mul_f32 v217, v217, v207
    v_mul_f32 v218, v218, v207
    v_mul_f32 v219, v219, v207
    v_cvt_pk_bf16_f32 v4, v212, v213
    v_cvt_pk_bf16_f32 v5, v214, v215
    v_cvt_pk_bf16_f32 v6, v216, v217
    v_cvt_pk_bf16_f32 v7, v218, v219
    s_movk_i32 s3, 0
    buffer_store_dwordx4 v[4:7], v225, s[56:59], s3 offen sc0 sc1
    v_accvgpr_read_b32 v212, a28
    v_accvgpr_read_b32 v213, a29
    v_accvgpr_read_b32 v214, a30
    v_accvgpr_read_b32 v215, a31
    v_accvgpr_read_b32 v216, a40
    v_accvgpr_read_b32 v217, a41
    v_accvgpr_read_b32 v218, a42
    v_accvgpr_read_b32 v219, a43
    v_mul_f32 v212, v212, v207
    v_mul_f32 v213, v213, v207
    v_mul_f32 v214, v214, v207
    v_mul_f32 v215, v215, v207
    v_mul_f32 v216, v216, v207
    v_mul_f32 v217, v217, v207
    v_mul_f32 v218, v218, v207
    v_mul_f32 v219, v219, v207
    v_cvt_pk_bf16_f32 v16, v212, v213
    v_cvt_pk_bf16_f32 v17, v214, v215
    v_cvt_pk_bf16_f32 v18, v216, v217
    v_cvt_pk_bf16_f32 v19, v218, v219
    s_movk_i32 s3, 2048
    buffer_store_dwordx4 v[16:19], v225, s[56:59], s3 offen sc0 sc1
    v_accvgpr_read_b32 v212, a52
    v_accvgpr_read_b32 v213, a53
    v_accvgpr_read_b32 v214, a54
    v_accvgpr_read_b32 v215, a55
    v_accvgpr_read_b32 v216, a64
    v_accvgpr_read_b32 v217, a65
    v_accvgpr_read_b32 v218, a66
    v_accvgpr_read_b32 v219, a67
    v_mul_f32 v212, v212, v207
    v_mul_f32 v213, v213, v207
    v_mul_f32 v214, v214, v207
    v_mul_f32 v215, v215, v207
    v_mul_f32 v216, v216, v207
    v_mul_f32 v217, v217, v207
    v_mul_f32 v218, v218, v207
    v_mul_f32 v219, v219, v207
    v_cvt_pk_bf16_f32 v28, v212, v213
    v_cvt_pk_bf16_f32 v29, v214, v215
    v_cvt_pk_bf16_f32 v30, v216, v217
    v_cvt_pk_bf16_f32 v31, v218, v219
    s_movk_i32 s3, 4096
    buffer_store_dwordx4 v[28:31], v225, s[56:59], s3 offen sc0 sc1
    v_accvgpr_read_b32 v212, a76
    v_accvgpr_read_b32 v213, a77
    v_accvgpr_read_b32 v214, a78
    v_accvgpr_read_b32 v215, a79
    v_accvgpr_read_b32 v216, a88
    v_accvgpr_read_b32 v217, a89
    v_accvgpr_read_b32 v218, a90
    v_accvgpr_read_b32 v219, a91
    v_mul_f32 v212, v212, v207
    v_mul_f32 v213, v213, v207
    v_mul_f32 v214, v214, v207
    v_mul_f32 v215, v215, v207
    v_mul_f32 v216, v216, v207
    v_mul_f32 v217, v217, v207
    v_mul_f32 v218, v218, v207
    v_mul_f32 v219, v219, v207
    v_cvt_pk_bf16_f32 v40, v212, v213
    v_cvt_pk_bf16_f32 v41, v214, v215
    v_cvt_pk_bf16_f32 v42, v216, v217
    v_cvt_pk_bf16_f32 v43, v218, v219
    s_movk_i32 s3, 6144
    buffer_store_dwordx4 v[40:43], v225, s[56:59], s3 offen sc0 sc1
    v_accvgpr_read_b32 v212, a100
    v_accvgpr_read_b32 v213, a101
    v_accvgpr_read_b32 v214, a102
    v_accvgpr_read_b32 v215, a103
    v_accvgpr_read_b32 v216, a112
    v_accvgpr_read_b32 v217, a113
    v_accvgpr_read_b32 v218, a114
    v_accvgpr_read_b32 v219, a115
    v_mul_f32 v212, v212, v207
    v_mul_f32 v213, v213, v207
    v_mul_f32 v214, v214, v207
    v_mul_f32 v215, v215, v207
    v_mul_f32 v216, v216, v207
    v_mul_f32 v217, v217, v207
    v_mul_f32 v218, v218, v207
    v_mul_f32 v219, v219, v207
    v_cvt_pk_bf16_f32 v52, v212, v213
    v_cvt_pk_bf16_f32 v53, v214, v215
    v_cvt_pk_bf16_f32 v54, v216, v217
    v_cvt_pk_bf16_f32 v55, v218, v219
    s_movk_i32 s3, 8192
    buffer_store_dwordx4 v[52:55], v225, s[56:59], s3 offen sc0 sc1
    v_accvgpr_read_b32 v212, a124
    v_accvgpr_read_b32 v213, a125
    v_accvgpr_read_b32 v214, a126
    v_accvgpr_read_b32 v215, a127
    v_accvgpr_read_b32 v216, a136
    v_accvgpr_read_b32 v217, a137
    v_accvgpr_read_b32 v218, a138
    v_accvgpr_read_b32 v219, a139
    v_mul_f32 v212, v212, v207
    v_mul_f32 v213, v213, v207
    v_mul_f32 v214, v214, v207
    v_mul_f32 v215, v215, v207
    v_mul_f32 v216, v216, v207
    v_mul_f32 v217, v217, v207
    v_mul_f32 v218, v218, v207
    v_mul_f32 v219, v219, v207
    v_cvt_pk_bf16_f32 v64, v212, v213
    v_cvt_pk_bf16_f32 v65, v214, v215
    v_cvt_pk_bf16_f32 v66, v216, v217
    v_cvt_pk_bf16_f32 v67, v218, v219
    s_movk_i32 s3, 10240
    buffer_store_dwordx4 v[64:67], v225, s[56:59], s3 offen sc0 sc1
    v_accvgpr_read_b32 v212, a8
    v_accvgpr_read_b32 v213, a9
    v_accvgpr_read_b32 v214, a10
    v_accvgpr_read_b32 v215, a11
    v_accvgpr_read_b32 v216, a20
    v_accvgpr_read_b32 v217, a21
    v_accvgpr_read_b32 v218, a22
    v_accvgpr_read_b32 v219, a23
    v_mul_f32 v212, v212, v208
    v_mul_f32 v213, v213, v208
    v_mul_f32 v214, v214, v208
    v_mul_f32 v215, v215, v208
    v_mul_f32 v216, v216, v208
    v_mul_f32 v217, v217, v208
    v_mul_f32 v218, v218, v208
    v_mul_f32 v219, v219, v208
    v_cvt_pk_bf16_f32 v8, v212, v213
    v_cvt_pk_bf16_f32 v9, v214, v215
    v_cvt_pk_bf16_f32 v10, v216, v217
    v_cvt_pk_bf16_f32 v11, v218, v219
    s_movk_i32 s3, 0
    buffer_store_dwordx4 v[8:11], v226, s[56:59], s3 offen sc0 sc1
    v_accvgpr_read_b32 v212, a32
    v_accvgpr_read_b32 v213, a33
    v_accvgpr_read_b32 v214, a34
    v_accvgpr_read_b32 v215, a35
    v_accvgpr_read_b32 v216, a44
    v_accvgpr_read_b32 v217, a45
    v_accvgpr_read_b32 v218, a46
    v_accvgpr_read_b32 v219, a47
    v_mul_f32 v212, v212, v208
    v_mul_f32 v213, v213, v208
    v_mul_f32 v214, v214, v208
    v_mul_f32 v215, v215, v208
    v_mul_f32 v216, v216, v208
    v_mul_f32 v217, v217, v208
    v_mul_f32 v218, v218, v208
    v_mul_f32 v219, v219, v208
    v_cvt_pk_bf16_f32 v20, v212, v213
    v_cvt_pk_bf16_f32 v21, v214, v215
    v_cvt_pk_bf16_f32 v22, v216, v217
    v_cvt_pk_bf16_f32 v23, v218, v219
    s_movk_i32 s3, 2048
    buffer_store_dwordx4 v[20:23], v226, s[56:59], s3 offen sc0 sc1
    v_accvgpr_read_b32 v212, a56
    v_accvgpr_read_b32 v213, a57
    v_accvgpr_read_b32 v214, a58
    v_accvgpr_read_b32 v215, a59
    v_accvgpr_read_b32 v216, a68
    v_accvgpr_read_b32 v217, a69
    v_accvgpr_read_b32 v218, a70
    v_accvgpr_read_b32 v219, a71
    v_mul_f32 v212, v212, v208
    v_mul_f32 v213, v213, v208
    v_mul_f32 v214, v214, v208
    v_mul_f32 v215, v215, v208
    v_mul_f32 v216, v216, v208
    v_mul_f32 v217, v217, v208
    v_mul_f32 v218, v218, v208
    v_mul_f32 v219, v219, v208
    v_cvt_pk_bf16_f32 v32, v212, v213
    v_cvt_pk_bf16_f32 v33, v214, v215
    v_cvt_pk_bf16_f32 v34, v216, v217
    v_cvt_pk_bf16_f32 v35, v218, v219
    s_movk_i32 s3, 4096
    buffer_store_dwordx4 v[32:35], v226, s[56:59], s3 offen sc0 sc1
    v_accvgpr_read_b32 v212, a80
    v_accvgpr_read_b32 v213, a81
    v_accvgpr_read_b32 v214, a82
    v_accvgpr_read_b32 v215, a83
    v_accvgpr_read_b32 v216, a92
    v_accvgpr_read_b32 v217, a93
    v_accvgpr_read_b32 v218, a94
    v_accvgpr_read_b32 v219, a95
    v_mul_f32 v212, v212, v208
    v_mul_f32 v213, v213, v208
    v_mul_f32 v214, v214, v208
    v_mul_f32 v215, v215, v208
    v_mul_f32 v216, v216, v208
    v_mul_f32 v217, v217, v208
    v_mul_f32 v218, v218, v208
    v_mul_f32 v219, v219, v208
    v_cvt_pk_bf16_f32 v44, v212, v213
    v_cvt_pk_bf16_f32 v45, v214, v215
    v_cvt_pk_bf16_f32 v46, v216, v217
    v_cvt_pk_bf16_f32 v47, v218, v219
    s_movk_i32 s3, 6144
    buffer_store_dwordx4 v[44:47], v226, s[56:59], s3 offen sc0 sc1
    v_accvgpr_read_b32 v212, a104
    v_accvgpr_read_b32 v213, a105
    v_accvgpr_read_b32 v214, a106
    v_accvgpr_read_b32 v215, a107
    v_accvgpr_read_b32 v216, a116
    v_accvgpr_read_b32 v217, a117
    v_accvgpr_read_b32 v218, a118
    v_accvgpr_read_b32 v219, a119
    v_mul_f32 v212, v212, v208
    v_mul_f32 v213, v213, v208
    v_mul_f32 v214, v214, v208
    v_mul_f32 v215, v215, v208
    v_mul_f32 v216, v216, v208
    v_mul_f32 v217, v217, v208
    v_mul_f32 v218, v218, v208
    v_mul_f32 v219, v219, v208
    v_cvt_pk_bf16_f32 v56, v212, v213
    v_cvt_pk_bf16_f32 v57, v214, v215
    v_cvt_pk_bf16_f32 v58, v216, v217
    v_cvt_pk_bf16_f32 v59, v218, v219
    s_movk_i32 s3, 8192
    buffer_store_dwordx4 v[56:59], v226, s[56:59], s3 offen sc0 sc1
    v_accvgpr_read_b32 v212, a128
    v_accvgpr_read_b32 v213, a129
    v_accvgpr_read_b32 v214, a130
    v_accvgpr_read_b32 v215, a131
    v_accvgpr_read_b32 v216, a140
    v_accvgpr_read_b32 v217, a141
    v_accvgpr_read_b32 v218, a142
    v_accvgpr_read_b32 v219, a143
    v_mul_f32 v212, v212, v208
    v_mul_f32 v213, v213, v208
    v_mul_f32 v214, v214, v208
    v_mul_f32 v215, v215, v208
    v_mul_f32 v216, v216, v208
    v_mul_f32 v217, v217, v208
    v_mul_f32 v218, v218, v208
    v_mul_f32 v219, v219, v208
    v_cvt_pk_bf16_f32 v68, v212, v213
    v_cvt_pk_bf16_f32 v69, v214, v215
    v_cvt_pk_bf16_f32 v70, v216, v217
    v_cvt_pk_bf16_f32 v71, v218, v219
    s_movk_i32 s3, 10240
    buffer_store_dwordx4 v[68:71], v226, s[56:59], s3 offen sc0 sc1
    v_add_u32 v224, 12288, v224
    v_add_u32 v225, 12288, v225
    v_add_u32 v226, 12288, v226
    s_nop 1
    v_accvgpr_read_b32 v0, a144
    v_accvgpr_read_b32 v1, a145
    v_accvgpr_read_b32 v2, a146
    v_accvgpr_read_b32 v3, a147
    v_accvgpr_read_b32 v4, a148
    v_accvgpr_read_b32 v5, a149
    v_accvgpr_read_b32 v6, a150
    v_accvgpr_read_b32 v7, a151
    v_accvgpr_read_b32 v8, a152
    v_accvgpr_read_b32 v9, a153
    v_accvgpr_read_b32 v10, a154
    v_accvgpr_read_b32 v11, a155
    v_accvgpr_read_b32 v12, a156
    v_accvgpr_read_b32 v13, a157
    v_accvgpr_read_b32 v14, a158
    v_accvgpr_read_b32 v15, a159
    v_accvgpr_read_b32 v16, a160
    v_accvgpr_read_b32 v17, a161
    v_accvgpr_read_b32 v18, a162
    v_accvgpr_read_b32 v19, a163
    v_accvgpr_read_b32 v20, a164
    v_accvgpr_read_b32 v21, a165
    v_accvgpr_read_b32 v22, a166
    v_accvgpr_read_b32 v23, a167
    v_accvgpr_read_b32 v24, a168
    v_accvgpr_read_b32 v25, a169
    v_accvgpr_read_b32 v26, a170
    v_accvgpr_read_b32 v27, a171
    v_accvgpr_read_b32 v28, a172
    v_accvgpr_read_b32 v29, a173
    v_accvgpr_read_b32 v30, a174
    v_accvgpr_read_b32 v31, a175
    v_accvgpr_read_b32 v32, a176
    v_accvgpr_read_b32 v33, a177
    v_accvgpr_read_b32 v34, a178
    v_accvgpr_read_b32 v35, a179
    v_accvgpr_read_b32 v36, a180
    v_accvgpr_read_b32 v37, a181
    v_accvgpr_read_b32 v38, a182
    v_accvgpr_read_b32 v39, a183
    v_accvgpr_read_b32 v40, a184
    v_accvgpr_read_b32 v41, a185
    v_accvgpr_read_b32 v42, a186
    v_accvgpr_read_b32 v43, a187
    v_accvgpr_read_b32 v44, a188
    v_accvgpr_read_b32 v45, a189
    v_accvgpr_read_b32 v46, a190
    v_accvgpr_read_b32 v47, a191
    v_accvgpr_read_b32 v48, a192
    v_accvgpr_read_b32 v49, a193
    v_accvgpr_read_b32 v50, a194
    v_accvgpr_read_b32 v51, a195
    v_accvgpr_read_b32 v52, a196
    v_accvgpr_read_b32 v53, a197
    v_accvgpr_read_b32 v54, a198
    v_accvgpr_read_b32 v55, a199
    v_accvgpr_read_b32 v56, a200
    v_accvgpr_read_b32 v57, a201
    v_accvgpr_read_b32 v58, a202
    v_accvgpr_read_b32 v59, a203
    v_accvgpr_read_b32 v60, a204
    v_accvgpr_read_b32 v61, a205
    v_accvgpr_read_b32 v62, a206
    v_accvgpr_read_b32 v63, a207
    v_accvgpr_read_b32 v64, a208
    v_accvgpr_read_b32 v65, a209
    v_accvgpr_read_b32 v66, a210
    v_accvgpr_read_b32 v67, a211
    v_accvgpr_read_b32 v68, a212
    v_accvgpr_read_b32 v69, a213
    v_accvgpr_read_b32 v70, a214
    v_accvgpr_read_b32 v71, a215
    s_add_u32 s87, s87, 1
    s_cmp_lt_u32 s87, 2
    s_cbranch_scc1 L_k1_head
    s_waitcnt vmcnt(0)
L_k1_end:
    s_endpgm
L_k1_sm_2_slow:
    v_max3_f32 v215, v96, v97, v98
    v_max3_f32 v215, v215, v99, v108
    v_max3_f32 v215, v215, v109, v110
    v_max_f32 v215, v215, v111
    v_mov_b32 v218, v215
    s_nop 1
    v_permlane32_swap_b32 v215, v218
    v_max_f32 v215, v215, v218
    v_mov_b32 v218, v215
    s_nop 1
    v_permlane16_swap_b32 v215, v218
    v_max_f32 v215, v215, v218
    v_max_f32 v215, s86, v215
    v_sub_f32 v218, 0, v215
    v_exp_f32 v209, v218
    v_sub_f32 v168, v168, v215
    v_sub_f32 v169, v169, v215
    v_sub_f32 v170, v170, v215
    v_sub_f32 v171, v171, v215
    v_sub_f32 v96, v96, v215
    v_sub_f32 v97, v97, v215
    v_sub_f32 v98, v98, v215
    v_sub_f32 v99, v99, v215
    v_sub_f32 v108, v108, v215
    v_sub_f32 v109, v109, v215
    v_sub_f32 v110, v110, v215
    v_sub_f32 v111, v111, v215
    v_mul_f32 v206, v206, v209
    v_max3_f32 v216, v100, v101, v102
    v_max3_f32 v216, v216, v103, v112
    v_max3_f32 v216, v216, v113, v114
    v_max_f32 v216, v216, v115
    v_mov_b32 v218, v216
    s_nop 1
    v_permlane32_swap_b32 v216, v218
    v_max_f32 v216, v216, v218
    v_mov_b32 v218, v216
    s_nop 1
    v_permlane16_swap_b32 v216, v218
    v_max_f32 v216, v216, v218
    v_max_f32 v216, s86, v216
    v_sub_f32 v218, 0, v216
    v_exp_f32 v210, v218
    v_sub_f32 v172, v172, v216
    v_sub_f32 v173, v173, v216
    v_sub_f32 v174, v174, v216
    v_sub_f32 v175, v175, v216
    v_sub_f32 v100, v100, v216
    v_sub_f32 v101, v101, v216
    v_sub_f32 v102, v102, v216
    v_sub_f32 v103, v103, v216
    v_sub_f32 v112, v112, v216
    v_sub_f32 v113, v113, v216
    v_sub_f32 v114, v114, v216
    v_sub_f32 v115, v115, v216
    v_mul_f32 v207, v207, v210
    v_max3_f32 v217, v104, v105, v106
    v_max3_f32 v217, v217, v107, v116
    v_max3_f32 v217, v217, v117, v118
    v_max_f32 v217, v217, v119
    v_mov_b32 v218, v217
    s_nop 1
    v_permlane32_swap_b32 v217, v218
    v_max_f32 v217, v217, v218
    v_mov_b32 v218, v217
    s_nop 1
    v_permlane16_swap_b32 v217, v218
    v_max_f32 v217, v217, v218
    v_max_f32 v217, s86, v217
    v_sub_f32 v218, 0, v217
    v_exp_f32 v211, v218
    v_sub_f32 v176, v176, v217
    v_sub_f32 v177, v177, v217
    v_sub_f32 v178, v178, v217
    v_sub_f32 v179, v179, v217
    v_sub_f32 v104, v104, v217
    v_sub_f32 v105, v105, v217
    v_sub_f32 v106, v106, v217
    v_sub_f32 v107, v107, v217
    v_sub_f32 v116, v116, v217
    v_sub_f32 v117, v117, v217
    v_sub_f32 v118, v118, v217
    v_sub_f32 v119, v119, v217
    v_mul_f32 v208, v208, v211
    v_exp_f32 v228, v96
    v_exp_f32 v229, v97
    v_exp_f32 v230, v98
    v_exp_f32 v231, v99
    v_exp_f32 v232, v108
    v_exp_f32 v233, v109
    v_exp_f32 v234, v110
    v_exp_f32 v235, v111
    v_exp_f32 v236, v100
    v_exp_f32 v237, v101
    v_exp_f32 v238, v102
    v_exp_f32 v239, v103
    v_exp_f32 v240, v112
    v_exp_f32 v241, v113
    v_exp_f32 v242, v114
    v_exp_f32 v243, v115
    v_exp_f32 v244, v104
    v_exp_f32 v245, v105
    v_exp_f32 v246, v106
    v_exp_f32 v247, v107
    v_exp_f32 v248, v116
    v_exp_f32 v249, v117
    v_exp_f32 v250, v118
    v_exp_f32 v251, v119
    v_add_f32 v212, v228, v229
    v_add_f32 v213, v236, v237
    v_add_f32 v214, v244, v245
    v_add_f32 v212, v212, v230
    v_add_f32 v213, v213, v238
    v_add_f32 v214, v214, v246
    v_add_f32 v212, v212, v231
    v_add_f32 v213, v213, v239
    v_add_f32 v214, v214, v247
    v_add_f32 v212, v212, v232
    v_add_f32 v213, v213, v240
    v_add_f32 v214, v214, v248
    v_add_f32 v212, v212, v233
    v_add_f32 v213, v213, v241
    v_add_f32 v214, v214, v249
    v_add_f32 v212, v212, v234
    v_add_f32 v213, v213, v242
    v_add_f32 v214, v214, v250
    v_add_f32 v212, v212, v235
    v_add_f32 v213, v213, v243
    v_add_f32 v214, v214, v251
    s_mov_b32 s72, 1
    s_mov_b32 s86, 0
    s_branch L_k1_sm_2_ret
L_k1_sm_4_slow:
    v_max3_f32 v215, v72, v73, v74
    v_max3_f32 v215, v215, v75, v84
    v_max3_f32 v215, v215, v85, v86
    v_max_f32 v215, v215, v87
    v_mov_b32 v218, v215
    s_nop 1
    v_permlane32_swap_b32 v215, v218
    v_max_f32 v215, v215, v218
    v_mov_b32 v218, v215
    s_nop 1
    v_permlane16_swap_b32 v215, v218
    v_max_f32 v215, v215, v218
    v_max_f32 v215, s86, v215
    v_sub_f32 v218, 0, v215
    v_exp_f32 v209, v218
    v_sub_f32 v168, v168, v215
    v_sub_f32 v169, v169, v215
    v_sub_f32 v170, v170, v215
    v_sub_f32 v171, v171, v215
    v_sub_f32 v72, v72, v215
    v_sub_f32 v73, v73, v215
    v_sub_f32 v74, v74, v215
    v_sub_f32 v75, v75, v215
    v_sub_f32 v84, v84, v215
    v_sub_f32 v85, v85, v215
    v_sub_f32 v86, v86, v215
    v_sub_f32 v87, v87, v215
    v_mul_f32 v206, v206, v209
    v_max3_f32 v216, v76, v77, v78
    v_max3_f32 v216, v216, v79, v88
    v_max3_f32 v216, v216, v89, v90
    v_max_f32 v216, v216, v91
    v_mov_b32 v218, v216
    s_nop 1
    v_permlane32_swap_b32 v216, v218
    v_max_f32 v216, v216, v218
    v_mov_b32 v218, v216
    s_nop 1
    v_permlane16_swap_b32 v216, v218
    v_max_f32 v216, v216, v218
    v_max_f32 v216, s86, v216
    v_sub_f32 v218, 0, v216
    v_exp_f32 v210, v218
    v_sub_f32 v172, v172, v216
    v_sub_f32 v173, v173, v216
    v_sub_f32 v174, v174, v216
    v_sub_f32 v175, v175, v216
    v_sub_f32 v76, v76, v216
    v_sub_f32 v77, v77, v216
    v_sub_f32 v78, v78, v216
    v_sub_f32 v79, v79, v216
    v_sub_f32 v88, v88, v216
    v_sub_f32 v89, v89, v216
    v_sub_f32 v90, v90, v216
    v_sub_f32 v91, v91, v216
    v_mul_f32 v207, v207, v210
    v_max3_f32 v217, v80, v81, v82
    v_max3_f32 v217, v217, v83, v92
    v_max3_f32 v217, v217, v93, v94
    v_max_f32 v217, v217, v95
    v_mov_b32 v218, v217
    s_nop 1
    v_permlane32_swap_b32 v217, v218
    v_max_f32 v217, v217, v218
    v_mov_b32 v218, v217
    s_nop 1
    v_permlane16_swap_b32 v217, v218
    v_max_f32 v217, v217, v218
    v_max_f32 v217, s86, v217
    v_sub_f32 v218, 0, v217
    v_exp_f32 v211, v218
    v_sub_f32 v176, v176, v217
    v_sub_f32 v177, v177, v217
    v_sub_f32 v178, v178, v217
    v_sub_f32 v179, v179, v217
    v_sub_f32 v80, v80, v217
    v_sub_f32 v81, v81, v217
    v_sub_f32 v82, v82, v217
    v_sub_f32 v83, v83, v217
    v_sub_f32 v92, v92, v217
    v_sub_f32 v93, v93, v217
    v_sub_f32 v94, v94, v217
    v_sub_f32 v95, v95, v217
    v_mul_f32 v208, v208, v211
    v_exp_f32 v228, v72
    v_exp_f32 v229, v73
    v_exp_f32 v230, v74
    v_exp_f32 v231, v75
    v_exp_f32 v232, v84
    v_exp_f32 v233, v85
    v_exp_f32 v234, v86
    v_exp_f32 v235, v87
    v_exp_f32 v236, v76
    v_exp_f32 v237, v77
    v_exp_f32 v238, v78
    v_exp_f32 v239, v79
    v_exp_f32 v240, v88
    v_exp_f32 v241, v89
    v_exp_f32 v242, v90
    v_exp_f32 v243, v91
    v_exp_f32 v244, v80
    v_exp_f32 v245, v81
    v_exp_f32 v246, v82
    v_exp_f32 v247, v83
    v_exp_f32 v248, v92
    v_exp_f32 v249, v93
    v_exp_f32 v250, v94
    v_exp_f32 v251, v95
    v_add_f32 v212, v228, v229
    v_add_f32 v213, v236, v237
    v_add_f32 v214, v244, v245
    v_add_f32 v212, v212, v230
    v_add_f32 v213, v213, v238
    v_add_f32 v214, v214, v246
    v_add_f32 v212, v212, v231
    v_add_f32 v213, v213, v239
    v_add_f32 v214, v214, v247
    v_add_f32 v212, v212, v232
    v_add_f32 v213, v213, v240
    v_add_f32 v214, v214, v248
    v_add_f32 v212, v212, v233
    v_add_f32 v213, v213, v241
    v_add_f32 v214, v214, v249
    v_add_f32 v212, v212, v234
    v_add_f32 v213, v213, v242
    v_add_f32 v214, v214, v250
    v_add_f32 v212, v212, v235
    v_add_f32 v213, v213, v243
    v_add_f32 v214, v214, v251
    s_mov_b32 s72, 1
    s_mov_b32 s86, 0
    s_branch L_k1_sm_4_ret
L_k1_sm_6_slow:
    v_max3_f32 v215, v96, v97, v98
    v_max3_f32 v215, v215, v99, v108
    v_max3_f32 v215, v215, v109, v110
    v_max_f32 v215, v215, v111
    v_mov_b32 v218, v215
    s_nop 1
    v_permlane32_swap_b32 v215, v218
    v_max_f32 v215, v215, v218
    v_mov_b32 v218, v215
    s_nop 1
    v_permlane16_swap_b32 v215, v218
    v_max_f32 v215, v215, v218
    v_max_f32 v215, s86, v215
    v_sub_f32 v218, 0, v215
    v_exp_f32 v209, v218
    v_sub_f32 v168, v168, v215
    v_sub_f32 v169, v169, v215
    v_sub_f32 v170, v170, v215
    v_sub_f32 v171, v171, v215
    v_sub_f32 v96, v96, v215
    v_sub_f32 v97, v97, v215
    v_sub_f32 v98, v98, v215
    v_sub_f32 v99, v99, v215
    v_sub_f32 v108, v108, v215
    v_sub_f32 v109, v109, v215
    v_sub_f32 v110, v110, v215
    v_sub_f32 v111, v111, v215
    v_mul_f32 v206, v206, v209
    v_max3_f32 v216, v100, v101, v102
    v_max3_f32 v216, v216, v103, v112
    v_max3_f32 v216, v216, v113, v114
    v_max_f32 v216, v216, v115
    v_mov_b32 v218, v216
    s_nop 1
    v_permlane32_swap_b32 v216, v218
    v_max_f32 v216, v216, v218
    v_mov_b32 v218, v216
    s_nop 1
    v_permlane16_swap_b32 v216, v218
    v_max_f32 v216, v216, v218
    v_max_f32 v216, s86, v216
    v_sub_f32 v218, 0, v216
    v_exp_f32 v210, v218
    v_sub_f32 v172, v172, v216
    v_sub_f32 v173, v173, v216
    v_sub_f32 v174, v174, v216
    v_sub_f32 v175, v175, v216
    v_sub_f32 v100, v100, v216
    v_sub_f32 v101, v101, v216
    v_sub_f32 v102, v102, v216
    v_sub_f32 v103, v103, v216
    v_sub_f32 v112, v112, v216
    v_sub_f32 v113, v113, v216
    v_sub_f32 v114, v114, v216
    v_sub_f32 v115, v115, v216
    v_mul_f32 v207, v207, v210
    v_max3_f32 v217, v104, v105, v106
    v_max3_f32 v217, v217, v107, v116
    v_max3_f32 v217, v217, v117, v118
    v_max_f32 v217, v217, v119
    v_mov_b32 v218, v217
    s_nop 1
    v_permlane32_swap_b32 v217, v218
    v_max_f32 v217, v217, v218
    v_mov_b32 v218, v217
    s_nop 1
    v_permlane16_swap_b32 v217, v218
    v_max_f32 v217, v217, v218
    v_max_f32 v217, s86, v217
    v_sub_f32 v218, 0, v217
    v_exp_f32 v211, v218
    v_sub_f32 v176, v176, v217
    v_sub_f32 v177, v177, v217
    v_sub_f32 v178, v178, v217
    v_sub_f32 v179, v179, v217
    v_sub_f32 v104, v104, v217
    v_sub_f32 v105, v105, v217
    v_sub_f32 v106, v106, v217
    v_sub_f32 v107, v107, v217
    v_sub_f32 v116, v116, v217
    v_sub_f32 v117, v117, v217
    v_sub_f32 v118, v118, v217
    v_sub_f32 v119, v119, v217
    v_mul_f32 v208, v208, v211
    v_exp_f32 v228, v96
    v_exp_f32 v229, v97
    v_exp_f32 v230, v98
    v_exp_f32 v231, v99
    v_exp_f32 v232, v108
    v_exp_f32 v233, v109
    v_exp_f32 v234, v110
    v_exp_f32 v235, v111
    v_exp_f32 v236, v100
    v_exp_f32 v237, v101
    v_exp_f32 v238, v102
    v_exp_f32 v239, v103
    v_exp_f32 v240, v112
    v_exp_f32 v241, v113
    v_exp_f32 v242, v114
    v_exp_f32 v243, v115
    v_exp_f32 v244, v104
    v_exp_f32 v245, v105
    v_exp_f32 v246, v106
    v_exp_f32 v247, v107
    v_exp_f32 v248, v116
    v_exp_f32 v249, v117
    v_exp_f32 v250, v118
    v_exp_f32 v251, v119
    v_add_f32 v212, v228, v229
    v_add_f32 v213, v236, v237
    v_add_f32 v214, v244, v245
    v_add_f32 v212, v212, v230
    v_add_f32 v213, v213, v238
    v_add_f32 v214, v214, v246
    v_add_f32 v212, v212, v231
    v_add_f32 v213, v213, v239
    v_add_f32 v214, v214, v247
    v_add_f32 v212, v212, v232
    v_add_f32 v213, v213, v240
    v_add_f32 v214, v214, v248
    v_add_f32 v212, v212, v233
    v_add_f32 v213, v213, v241
    v_add_f32 v214, v214, v249
    v_add_f32 v212, v212, v234
    v_add_f32 v213, v213, v242
    v_add_f32 v214, v214, v250
    v_add_f32 v212, v212, v235
    v_add_f32 v213, v213, v243
    v_add_f32 v214, v214, v251
    s_mov_b32 s72, 1
    s_mov_b32 s86, 0
    s_branch L_k1_sm_6_ret
L_k1_sm_8_slow:
    v_max3_f32 v215, v72, v73, v74
    v_max3_f32 v215, v215, v75, v84
    v_max3_f32 v215, v215, v85, v86
    v_max_f32 v215, v215, v87
    v_mov_b32 v218, v215
    s_nop 1
    v_permlane32_swap_b32 v215, v218
    v_max_f32 v215, v215, v218
    v_mov_b32 v218, v215
    s_nop 1
    v_permlane16_swap_b32 v215, v218
    v_max_f32 v215, v215, v218
    v_max_f32 v215, s86, v215
    v_sub_f32 v218, 0, v215
    v_exp_f32 v209, v218
    v_sub_f32 v168, v168, v215
    v_sub_f32 v169, v169, v215
    v_sub_f32 v170, v170, v215
    v_sub_f32 v171, v171, v215
    v_sub_f32 v72, v72, v215
    v_sub_f32 v73, v73, v215
    v_sub_f32 v74, v74, v215
    v_sub_f32 v75, v75, v215
    v_sub_f32 v84, v84, v215
    v_sub_f32 v85, v85, v215
    v_sub_f32 v86, v86, v215
    v_sub_f32 v87, v87, v215
    v_mul_f32 v206, v206, v209
    v_max3_f32 v216, v76, v77, v78
    v_max3_f32 v216, v216, v79, v88
    v_max3_f32 v216, v216, v89, v90
    v_max_f32 v216, v216, v91
    v_mov_b32 v218, v216
    s_nop 1
    v_permlane32_swap_b32 v216, v218
    v_max_f32 v216, v216, v218
    v_mov_b32 v218, v216
    s_nop 1
    v_permlane16_swap_b32 v216, v218
    v_max_f32 v216, v216, v218
    v_max_f32 v216, s86, v216
    v_sub_f32 v218, 0, v216
    v_exp_f32 v210, v218
    v_sub_f32 v172, v172, v216
    v_sub_f32 v173, v173, v216
    v_sub_f32 v174, v174, v216
    v_sub_f32 v175, v175, v216
    v_sub_f32 v76, v76, v216
    v_sub_f32 v77, v77, v216
    v_sub_f32 v78, v78, v216
    v_sub_f32 v79, v79, v216
    v_sub_f32 v88, v88, v216
    v_sub_f32 v89, v89, v216
    v_sub_f32 v90, v90, v216
    v_sub_f32 v91, v91, v216
    v_mul_f32 v207, v207, v210
    v_max3_f32 v217, v80, v81, v82
    v_max3_f32 v217, v217, v83, v92
    v_max3_f32 v217, v217, v93, v94
    v_max_f32 v217, v217, v95
    v_mov_b32 v218, v217
    s_nop 1
    v_permlane32_swap_b32 v217, v218
    v_max_f32 v217, v217, v218
    v_mov_b32 v218, v217
    s_nop 1
    v_permlane16_swap_b32 v217, v218
    v_max_f32 v217, v217, v218
    v_max_f32 v217, s86, v217
    v_sub_f32 v218, 0, v217
    v_exp_f32 v211, v218
    v_sub_f32 v176, v176, v217
    v_sub_f32 v177, v177, v217
    v_sub_f32 v178, v178, v217
    v_sub_f32 v179, v179, v217
    v_sub_f32 v80, v80, v217
    v_sub_f32 v81, v81, v217
    v_sub_f32 v82, v82, v217
    v_sub_f32 v83, v83, v217
    v_sub_f32 v92, v92, v217
    v_sub_f32 v93, v93, v217
    v_sub_f32 v94, v94, v217
    v_sub_f32 v95, v95, v217
    v_mul_f32 v208, v208, v211
    v_exp_f32 v228, v72
    v_exp_f32 v229, v73
    v_exp_f32 v230, v74
    v_exp_f32 v231, v75
    v_exp_f32 v232, v84
    v_exp_f32 v233, v85
    v_exp_f32 v234, v86
    v_exp_f32 v235, v87
    v_exp_f32 v236, v76
    v_exp_f32 v237, v77
    v_exp_f32 v238, v78
    v_exp_f32 v239, v79
    v_exp_f32 v240, v88
    v_exp_f32 v241, v89
    v_exp_f32 v242, v90
    v_exp_f32 v243, v91
    v_exp_f32 v244, v80
    v_exp_f32 v245, v81
    v_exp_f32 v246, v82
    v_exp_f32 v247, v83
    v_exp_f32 v248, v92
    v_exp_f32 v249, v93
    v_exp_f32 v250, v94
    v_exp_f32 v251, v95
    v_add_f32 v212, v228, v229
    v_add_f32 v213, v236, v237
    v_add_f32 v214, v244, v245
    v_add_f32 v212, v212, v230
    v_add_f32 v213, v213, v238
    v_add_f32 v214, v214, v246
    v_add_f32 v212, v212, v231
    v_add_f32 v213, v213, v239
    v_add_f32 v214, v214, v247
    v_add_f32 v212, v212, v232
    v_add_f32 v213, v213, v240
    v_add_f32 v214, v214, v248
    v_add_f32 v212, v212, v233
    v_add_f32 v213, v213, v241
    v_add_f32 v214, v214, v249
    v_add_f32 v212, v212, v234
    v_add_f32 v213, v213, v242
    v_add_f32 v214, v214, v250
    v_add_f32 v212, v212, v235
    v_add_f32 v213, v213, v243
    v_add_f32 v214, v214, v251
    s_mov_b32 s72, 1
    s_mov_b32 s86, 0
    s_branch L_k1_sm_8_ret
L_k1_sm_10_slow:
    v_max3_f32 v215, v96, v97, v98
    v_max3_f32 v215, v215, v99, v108
    v_max3_f32 v215, v215, v109, v110
    v_max_f32 v215, v215, v111
    v_mov_b32 v218, v215
    s_nop 1
    v_permlane32_swap_b32 v215, v218
    v_max_f32 v215, v215, v218
    v_mov_b32 v218, v215
    s_nop 1
    v_permlane16_swap_b32 v215, v218
    v_max_f32 v215, v215, v218
    v_max_f32 v215, s86, v215
    v_sub_f32 v218, 0, v215
    v_exp_f32 v209, v218
    v_sub_f32 v168, v168, v215
    v_sub_f32 v169, v169, v215
    v_sub_f32 v170, v170, v215
    v_sub_f32 v171, v171, v215
    v_sub_f32 v96, v96, v215
    v_sub_f32 v97, v97, v215
    v_sub_f32 v98, v98, v215
    v_sub_f32 v99, v99, v215
    v_sub_f32 v108, v108, v215
    v_sub_f32 v109, v109, v215
    v_sub_f32 v110, v110, v215
    v_sub_f32 v111, v111, v215
    v_mul_f32 v206, v206, v209
    v_max3_f32 v216, v100, v101, v102
    v_max3_f32 v216, v216, v103, v112
    v_max3_f32 v216, v216, v113, v114
    v_max_f32 v216, v216, v115
    v_mov_b32 v218, v216
    s_nop 1
    v_permlane32_swap_b32 v216, v218
    v_max_f32 v216, v216, v218
    v_mov_b32 v218, v216
    s_nop 1
    v_permlane16_swap_b32 v216, v218
    v_max_f32 v216, v216, v218
    v_max_f32 v216, s86, v216
    v_sub_f32 v218, 0, v216
    v_exp_f32 v210, v218
    v_sub_f32 v172, v172, v216
    v_sub_f32 v173, v173, v216
    v_sub_f32 v174, v174, v216
    v_sub_f32 v175, v175, v216
    v_sub_f32 v100, v100, v216
    v_sub_f32 v101, v101, v216
    v_sub_f32 v102, v102, v216
    v_sub_f32 v103, v103, v216
    v_sub_f32 v112, v112, v216
    v_sub_f32 v113, v113, v216
    v_sub_f32 v114, v114, v216
    v_sub_f32 v115, v115, v216
    v_mul_f32 v207, v207, v210
    v_max3_f32 v217, v104, v105, v106
    v_max3_f32 v217, v217, v107, v116
    v_max3_f32 v217, v217, v117, v118
    v_max_f32 v217, v217, v119
    v_mov_b32 v218, v217
    s_nop 1
    v_permlane32_swap_b32 v217, v218
    v_max_f32 v217, v217, v218
    v_mov_b32 v218, v217
    s_nop 1
    v_permlane16_swap_b32 v217, v218
    v_max_f32 v217, v217, v218
    v_max_f32 v217, s86, v217
    v_sub_f32 v218, 0, v217
    v_exp_f32 v211, v218
    v_sub_f32 v176, v176, v217
    v_sub_f32 v177, v177, v217
    v_sub_f32 v178, v178, v217
    v_sub_f32 v179, v179, v217
    v_sub_f32 v104, v104, v217
    v_sub_f32 v105, v105, v217
    v_sub_f32 v106, v106, v217
    v_sub_f32 v107, v107, v217
    v_sub_f32 v116, v116, v217
    v_sub_f32 v117, v117, v217
    v_sub_f32 v118, v118, v217
    v_sub_f32 v119, v119, v217
    v_mul_f32 v208, v208, v211
    v_exp_f32 v228, v96
    v_exp_f32 v229, v97
    v_exp_f32 v230, v98
    v_exp_f32 v231, v99
    v_exp_f32 v232, v108
    v_exp_f32 v233, v109
    v_exp_f32 v234, v110
    v_exp_f32 v235, v111
    v_exp_f32 v236, v100
    v_exp_f32 v237, v101
    v_exp_f32 v238, v102
    v_exp_f32 v239, v103
    v_exp_f32 v240, v112
    v_exp_f32 v241, v113
    v_exp_f32 v242, v114
    v_exp_f32 v243, v115
    v_exp_f32 v244, v104
    v_exp_f32 v245, v105
    v_exp_f32 v246, v106
    v_exp_f32 v247, v107
    v_exp_f32 v248, v116
    v_exp_f32 v249, v117
    v_exp_f32 v250, v118
    v_exp_f32 v251, v119
    v_add_f32 v212, v228, v229
    v_add_f32 v213, v236, v237
    v_add_f32 v214, v244, v245
    v_add_f32 v212, v212, v230
    v_add_f32 v213, v213, v238
    v_add_f32 v214, v214, v246
    v_add_f32 v212, v212, v231
    v_add_f32 v213, v213, v239
    v_add_f32 v214, v214, v247
    v_add_f32 v212, v212, v232
    v_add_f32 v213, v213, v240
    v_add_f32 v214, v214, v248
    v_add_f32 v212, v212, v233
    v_add_f32 v213, v213, v241
    v_add_f32 v214, v214, v249
    v_add_f32 v212, v212, v234
    v_add_f32 v213, v213, v242
    v_add_f32 v214, v214, v250
    v_add_f32 v212, v212, v235
    v_add_f32 v213, v213, v243
    v_add_f32 v214, v214, v251
    s_mov_b32 s72, 1
    s_mov_b32 s86, 0
    s_branch L_k1_sm_10_ret
L_k1_sm_12_slow:
    v_max3_f32 v215, v72, v73, v74
    v_max3_f32 v215, v215, v75, v84
    v_max3_f32 v215, v215, v85, v86
    v_max_f32 v215, v215, v87
    v_mov_b32 v218, v215
    s_nop 1
    v_permlane32_swap_b32 v215, v218
    v_max_f32 v215, v215, v218
    v_mov_b32 v218, v215
    s_nop 1
    v_permlane16_swap_b32 v215, v218
    v_max_f32 v215, v215, v218
    v_max_f32 v215, s86, v215
    v_sub_f32 v218, 0, v215
    v_exp_f32 v209, v218
    v_sub_f32 v168, v168, v215
    v_sub_f32 v169, v169, v215
    v_sub_f32 v170, v170, v215
    v_sub_f32 v171, v171, v215
    v_sub_f32 v72, v72, v215
    v_sub_f32 v73, v73, v215
    v_sub_f32 v74, v74, v215
    v_sub_f32 v75, v75, v215
    v_sub_f32 v84, v84, v215
    v_sub_f32 v85, v85, v215
    v_sub_f32 v86, v86, v215
    v_sub_f32 v87, v87, v215
    v_mul_f32 v206, v206, v209
    v_max3_f32 v216, v76, v77, v78
    v_max3_f32 v216, v216, v79, v88
    v_max3_f32 v216, v216, v89, v90
    v_max_f32 v216, v216, v91
    v_mov_b32 v218, v216
    s_nop 1
    v_permlane32_swap_b32 v216, v218
    v_max_f32 v216, v216, v218
    v_mov_b32 v218, v216
    s_nop 1
    v_permlane16_swap_b32 v216, v218
    v_max_f32 v216, v216, v218
    v_max_f32 v216, s86, v216
    v_sub_f32 v218, 0, v216
    v_exp_f32 v210, v218
    v_sub_f32 v172, v172, v216
    v_sub_f32 v173, v173, v216
    v_sub_f32 v174, v174, v216
    v_sub_f32 v175, v175, v216
    v_sub_f32 v76, v76, v216
    v_sub_f32 v77, v77, v216
    v_sub_f32 v78, v78, v216
    v_sub_f32 v79, v79, v216
    v_sub_f32 v88, v88, v216
    v_sub_f32 v89, v89, v216
    v_sub_f32 v90, v90, v216
    v_sub_f32 v91, v91, v216
    v_mul_f32 v207, v207, v210
    v_max3_f32 v217, v80, v81, v82
    v_max3_f32 v217, v217, v83, v92
    v_max3_f32 v217, v217, v93, v94
    v_max_f32 v217, v217, v95
    v_mov_b32 v218, v217
    s_nop 1
    v_permlane32_swap_b32 v217, v218
    v_max_f32 v217, v217, v218
    v_mov_b32 v218, v217
    s_nop 1
    v_permlane16_swap_b32 v217, v218
    v_max_f32 v217, v217, v218
    v_max_f32 v217, s86, v217
    v_sub_f32 v218, 0, v217
    v_exp_f32 v211, v218
    v_sub_f32 v176, v176, v217
    v_sub_f32 v177, v177, v217
    v_sub_f32 v178, v178, v217
    v_sub_f32 v179, v179, v217
    v_sub_f32 v80, v80, v217
    v_sub_f32 v81, v81, v217
    v_sub_f32 v82, v82, v217
    v_sub_f32 v83, v83, v217
    v_sub_f32 v92, v92, v217
    v_sub_f32 v93, v93, v217
    v_sub_f32 v94, v94, v217
    v_sub_f32 v95, v95, v217
    v_mul_f32 v208, v208, v211
    v_exp_f32 v228, v72
    v_exp_f32 v229, v73
    v_exp_f32 v230, v74
    v_exp_f32 v231, v75
    v_exp_f32 v232, v84
    v_exp_f32 v233, v85
    v_exp_f32 v234, v86
    v_exp_f32 v235, v87
    v_exp_f32 v236, v76
    v_exp_f32 v237, v77
    v_exp_f32 v238, v78
    v_exp_f32 v239, v79
    v_exp_f32 v240, v88
    v_exp_f32 v241, v89
    v_exp_f32 v242, v90
    v_exp_f32 v243, v91
    v_exp_f32 v244, v80
    v_exp_f32 v245, v81
    v_exp_f32 v246, v82
    v_exp_f32 v247, v83
    v_exp_f32 v248, v92
    v_exp_f32 v249, v93
    v_exp_f32 v250, v94
    v_exp_f32 v251, v95
    v_add_f32 v212, v228, v229
    v_add_f32 v213, v236, v237
    v_add_f32 v214, v244, v245
    v_add_f32 v212, v212, v230
    v_add_f32 v213, v213, v238
    v_add_f32 v214, v214, v246
    v_add_f32 v212, v212, v231
    v_add_f32 v213, v213, v239
    v_add_f32 v214, v214, v247
    v_add_f32 v212, v212, v232
    v_add_f32 v213, v213, v240
    v_add_f32 v214, v214, v248
    v_add_f32 v212, v212, v233
    v_add_f32 v213, v213, v241
    v_add_f32 v214, v214, v249
    v_add_f32 v212, v212, v234
    v_add_f32 v213, v213, v242
    v_add_f32 v214, v214, v250
    v_add_f32 v212, v212, v235
    v_add_f32 v213, v213, v243
    v_add_f32 v214, v214, v251
    s_mov_b32 s72, 1
    s_mov_b32 s86, 0
    s_branch L_k1_sm_12_ret
L_k1_sm_14_slow:
    v_max3_f32 v215, v96, v97, v98
    v_max3_f32 v215, v215, v99, v108
    v_max3_f32 v215, v215, v109, v110
    v_max_f32 v215, v215, v111
    v_mov_b32 v218, v215
    s_nop 1
    v_permlane32_swap_b32 v215, v218
    v_max_f32 v215, v215, v218
    v_mov_b32 v218, v215
    s_nop 1
    v_permlane16_swap_b32 v215, v218
    v_max_f32 v215, v215, v218
    v_max_f32 v215, s86, v215
    v_sub_f32 v218, 0, v215
    v_exp_f32 v209, v218
    v_sub_f32 v168, v168, v215
    v_sub_f32 v169, v169, v215
    v_sub_f32 v170, v170, v215
    v_sub_f32 v171, v171, v215
    v_sub_f32 v96, v96, v215
    v_sub_f32 v97, v97, v215
    v_sub_f32 v98, v98, v215
    v_sub_f32 v99, v99, v215
    v_sub_f32 v108, v108, v215
    v_sub_f32 v109, v109, v215
    v_sub_f32 v110, v110, v215
    v_sub_f32 v111, v111, v215
    v_mul_f32 v206, v206, v209
    v_max3_f32 v216, v100, v101, v102
    v_max3_f32 v216, v216, v103, v112
    v_max3_f32 v216, v216, v113, v114
    v_max_f32 v216, v216, v115
    v_mov_b32 v218, v216
    s_nop 1
    v_permlane32_swap_b32 v216, v218
    v_max_f32 v216, v216, v218
    v_mov_b32 v218, v216
    s_nop 1
    v_permlane16_swap_b32 v216, v218
    v_max_f32 v216, v216, v218
    v_max_f32 v216, s86, v216
    v_sub_f32 v218, 0, v216
    v_exp_f32 v210, v218
    v_sub_f32 v172, v172, v216
    v_sub_f32 v173, v173, v216
    v_sub_f32 v174, v174, v216
    v_sub_f32 v175, v175, v216
    v_sub_f32 v100, v100, v216
    v_sub_f32 v101, v101, v216
    v_sub_f32 v102, v102, v216
    v_sub_f32 v103, v103, v216
    v_sub_f32 v112, v112, v216
    v_sub_f32 v113, v113, v216
    v_sub_f32 v114, v114, v216
    v_sub_f32 v115, v115, v216
    v_mul_f32 v207, v207, v210
    v_max3_f32 v217, v104, v105, v106
    v_max3_f32 v217, v217, v107, v116
    v_max3_f32 v217, v217, v117, v118
    v_max_f32 v217, v217, v119
    v_mov_b32 v218, v217
    s_nop 1
    v_permlane32_swap_b32 v217, v218
    v_max_f32 v217, v217, v218
    v_mov_b32 v218, v217
    s_nop 1
    v_permlane16_swap_b32 v217, v218
    v_max_f32 v217, v217, v218
    v_max_f32 v217, s86, v217
    v_sub_f32 v218, 0, v217
    v_exp_f32 v211, v218
    v_sub_f32 v176, v176, v217
    v_sub_f32 v177, v177, v217
    v_sub_f32 v178, v178, v217
    v_sub_f32 v179, v179, v217
    v_sub_f32 v104, v104, v217
    v_sub_f32 v105, v105, v217
    v_sub_f32 v106, v106, v217
    v_sub_f32 v107, v107, v217
    v_sub_f32 v116, v116, v217
    v_sub_f32 v117, v117, v217
    v_sub_f32 v118, v118, v217
    v_sub_f32 v119, v119, v217
    v_mul_f32 v208, v208, v211
    v_exp_f32 v228, v96
    v_exp_f32 v229, v97
    v_exp_f32 v230, v98
    v_exp_f32 v231, v99
    v_exp_f32 v232, v108
    v_exp_f32 v233, v109
    v_exp_f32 v234, v110
    v_exp_f32 v235, v111
    v_exp_f32 v236, v100
    v_exp_f32 v237, v101
    v_exp_f32 v238, v102
    v_exp_f32 v239, v103
    v_exp_f32 v240, v112
    v_exp_f32 v241, v113
    v_exp_f32 v242, v114
    v_exp_f32 v243, v115
    v_exp_f32 v244, v104
    v_exp_f32 v245, v105
    v_exp_f32 v246, v106
    v_exp_f32 v247, v107
    v_exp_f32 v248, v116
    v_exp_f32 v249, v117
    v_exp_f32 v250, v118
    v_exp_f32 v251, v119
    v_add_f32 v212, v228, v229
    v_add_f32 v213, v236, v237
    v_add_f32 v214, v244, v245
    v_add_f32 v212, v212, v230
    v_add_f32 v213, v213, v238
    v_add_f32 v214, v214, v246
    v_add_f32 v212, v212, v231
    v_add_f32 v213, v213, v239
    v_add_f32 v214, v214, v247
    v_add_f32 v212, v212, v232
    v_add_f32 v213, v213, v240
    v_add_f32 v214, v214, v248
    v_add_f32 v212, v212, v233
    v_add_f32 v213, v213, v241
    v_add_f32 v214, v214, v249
    v_add_f32 v212, v212, v234
    v_add_f32 v213, v213, v242
    v_add_f32 v214, v214, v250
    v_add_f32 v212, v212, v235
    v_add_f32 v213, v213, v243
    v_add_f32 v214, v214, v251
    s_mov_b32 s72, 1
    s_mov_b32 s86, 0
    s_branch L_k1_sm_14_ret
.globl k2_kernel
.p2align 8
.type k2_kernel,@function
k2_kernel:
    s_cmp_ge_u32 s2, 240
    s_cbranch_scc1 L_k2_end
    s_load_dwordx2 s[16:17], s[0:1], 32
    s_load_dwordx2 s[18:19], s[0:1], 72
    s_load_dwordx2 s[36:37], s[0:1], 96
    s_and_b32 s3, s2, 7
    s_lshr_b32 s60, s3, 2
    s_and_b32 s61, s3, 3
    s_lshr_b32 s4, s2, 3
    s_mul_i32 s5, s4, 52
    s_lshr_b32 s62, s5, 8
    s_mul_i32 s5, s62, 5
    s_sub_u32 s63, s4, s5
    v_lshrrev_b32 v65, 6, v0
    s_nop 0
    v_readfirstlane_b32 s64, v65
    s_waitcnt lgkmcnt(0)
    s_lshr_b32 s65, s64, 1
    s_and_b32 s66, s64, 1
    s_cmp_eq_u32 s60, 0
    s_cselect_b32 s4, s16, s18
    s_cselect_b32 s5, s17, s19
    s_mul_i32 s3, s61, 1966080
    s_lshl_b32 s6, s63, 8
    s_add_u32 s3, s3, s6
    s_add_u32 s40, s4, s3
    s_addc_u32 s41, s5, 0
    s_sub_u32 s42, 7864320, s3
    s_mov_b32 s43, 0x00020000
    s_mul_i32 s3, s60, 48
    s_lshl_b32 s6, s62, 3
    s_add_u32 s3, s3, s6
    s_mul_i32 s3, s3, 393216
    s_mul_i32 s6, s61, 98304
    s_add_u32 s3, s3, s6
    s_add_u32 s44, s36, s3
    s_addc_u32 s45, s37, 0
    s_sub_u32 s46, 3145728, s6
    s_mov_b32 s47, 0x00020000
    s_mul_i32 s3, s61, 60
    s_mul_i32 s6, s60, 30
    s_add_u32 s3, s3, s6
    s_mul_i32 s6, s62, 5
    s_add_u32 s3, s3, s6
    s_add_u32 s3, s3, s63
    s_lshl_b32 s3, s3, 17
    s_add_u32 s3, s3, 41943040
    s_add_u32 s48, s36, s3
    s_addc_u32 s49, s37, 0
    s_mov_b32 s50, 131072
    s_mov_b32 s51, 0x00020000
    v_and_b32 v1, 63, v0
    v_lshrrev_b32 v2, 5, v1
    v_bfe_u32 v3, v1, 4, 1
    v_bfe_u32 v4, v1, 2, 2
    v_and_b32 v5, 3, v1
    v_lshrrev_b32 v65, 4, v1
    v_and_b32 v66, 15, v1
    v_lshlrev_b32 v67, 2, v65
    v_xor_b32 v66, v66, v67
    v_lshlrev_b32 v66, 4, v66
    v_mul_u32_u24 v65, 1280, v65
    s_mul_i32 s3, s64, 10240
    v_add3_u32 v56, v65, v66, s3
    s_mul_i32 s3, s64, 786432
    v_lshlrev_b32 v57, 4, v1
    v_add_u32 v57, s3, v57
    v_lshlrev_b32 v65, 2, v2
    v_add_u32 v65, v65, v4
    v_lshlrev_b32 v65, 8, v65
    v_and_b32 v66, 1, v5
    v_lshlrev_b32 v66, 3, v66
    v_add_u32 v65, v65, v66
    v_lshlrev_b32 v67, 2, v4
    s_lshl_b32 s3, s66, 3
    v_lshrrev_b32 v66, 1, v5
    v_lshl_add_u32 v66, v3, 1, v66
    v_add3_u32 v66, v66, s3, 0
    v_xor_b32 v66, v66, v67
    v_lshlrev_b32 v66, 4, v66
    v_add3_u32 v58, v65, v66, 0
    v_add_u32 v58, 16384, v58
    v_lshrrev_b32 v66, 1, v5
    v_lshl_add_u32 v66, v3, 1, v66
    v_add3_u32 v66, v66, s3, 4
    v_xor_b32 v66, v66, v67
    v_lshlrev_b32 v66, 4, v66
    v_add3_u32 v59, v65, v66, 0
    v_add_u32 v59, 16384, v59
    s_lshl_b32 s3, s65, 13
    v_lshlrev_b32 v60, 4, v1
    v_add_u32 v60, s3, v60
    s_lshl_b32 s3, s64, 15
    v_lshlrev_b32 v64, 4, v1
    v_add_u32 v64, s3, v64
    s_lshl_b32 s76, s64, 12
    s_lshl_b32 s77, s64, 11
    s_sub_u32 s77, 16384, s77
    s_mov_b32 s67, s76
    s_add_u32 s78, s67, s77
    s_mov_b32 s69, 0
    s_mov_b32 s68, 0
    s_mov_b32 s70, 0
    s_mov_b32 s72, 0
    s_add_u32 m0, s67, 0
    s_add_u32 s3, s69, 0
    buffer_load_dwordx4 v57, s[44:47], s3 offen lds
    s_add_u32 m0, s67, 1024
    s_add_u32 s3, s69, 1024
    buffer_load_dwordx4 v57, s[44:47], s3 offen lds
    s_add_u32 m0, s67, 2048
    s_add_u32 s3, s69, 393216
    buffer_load_dwordx4 v57, s[44:47], s3 offen lds
    s_add_u32 m0, s67, 3072
    s_add_u32 s3, s69, 394240
    buffer_load_dwordx4 v57, s[44:47], s3 offen lds
    s_add_u32 m0, s78, 0
    s_add_u32 s3, s68, 0
    buffer_load_dwordx4 v56, s[40:43], s3 offen lds
    s_add_u32 m0, s78, 1024
    s_add_u32 s3, s68, 5120
    buffer_load_dwordx4 v56, s[40:43], s3 offen lds
    s_add_u32 s69, s69, 2048
    s_add_u32 s68, s68, 40960
    s_add_u32 s67, s67, 24576
    s_cmp_ge_u32 s67, 147456
    s_cselect_b32 s67, s76, s67
    s_add_u32 s78, s67, s77
    s_add_u32 m0, s67, 0
    s_add_u32 s3, s69, 0
    buffer_load_dwordx4 v57, s[44:47], s3 offen lds
    s_add_u32 m0, s67, 1024
    s_add_u32 s3, s69, 1024
    buffer_load_dwordx4 v57, s[44:47], s3 offen lds
    s_add_u32 m0, s67, 2048
    s_add_u32 s3, s69, 393216
    buffer_load_dwordx4 v57, s[44:47], s3 offen lds
    s_add_u32 m0, s67, 3072
    s_add_u32 s3, s69, 394240
    buffer_load_dwordx4 v57, s[44:47], s3 offen lds
    s_add_u32 m0, s78, 0
    s_add_u32 s3, s68, 0
    buffer_load_dwordx4 v56, s[40:43], s3 offen lds
    s_add_u32 m0, s78, 1024
    s_add_u32 s3, s68, 5120
    buffer_load_dwordx4 v56, s[40:43], s3 offen lds
    s_add_u32 s69, s69, 2048
    s_add_u32 s68, s68, 40960
    s_add_u32 s67, s67, 24576
    s_cmp_ge_u32 s67, 147456
    s_cselect_b32 s67, s76, s67
    s_add_u32 s78, s67, s77
    s_add_u32 m0, s67, 0
    s_add_u32 s3, s69, 0
    buffer_load_dwordx4 v57, s[44:47], s3 offen lds
    s_add_u32 m0, s67, 1024
    s_add_u32 s3, s69, 1024
    buffer_load_dwordx4 v57, s[44:47], s3 offen lds
    s_add_u32 m0, s67, 2048
    s_add_u32 s3, s69, 393216
    buffer_load_dwordx4 v57, s[44:47], s3 offen lds
    s_add_u32 m0, s67, 3072
    s_add_u32 s3, s69, 394240
    buffer_load_dwordx4 v57, s[44:47], s3 offen lds
    s_add_u32 m0, s78, 0
    s_add_u32 s3, s68, 0
    buffer_load_dwordx4 v56, s[40:43], s3 offen lds
    s_add_u32 m0, s78, 1024
    s_add_u32 s3, s68, 5120
    buffer_load_dwordx4 v56, s[40:43], s3 offen lds
    s_add_u32 s69, s69, 2048
    s_add_u32 s68, s68, 40960
    s_add_u32 s67, s67, 24576
    s_cmp_ge_u32 s67, 147456
    s_cselect_b32 s67, s76, s67
    s_add_u32 s78, s67, s77
    s_add_u32 m0, s67, 0
    s_add_u32 s3, s69, 0
    buffer_load_dwordx4 v57, s[44:47], s3 offen lds
    s_add_u32 m0, s67, 1024
    s_add_u32 s3, s69, 1024
    buffer_load_dwordx4 v57, s[44:47], s3 offen lds
    s_add_u32 m0, s67, 2048
    s_add_u32 s3, s69, 393216
    buffer_load_dwordx4 v57, s[44:47], s3 offen lds
    s_add_u32 m0, s67, 3072
    s_add_u32 s3, s69, 394240
    buffer_load_dwordx4 v57, s[44:47], s3 offen lds
    s_add_u32 m0, s78, 0
    s_add_u32 s3, s68, 0
    buffer_load_dwordx4 v56, s[40:43], s3 offen lds
    s_add_u32 m0, s78, 1024
    s_add_u32 s3, s68, 5120
    buffer_load_dwordx4 v56, s[40:43], s3 offen lds
    s_add_u32 s69, s69, 2048
    s_add_u32 s68, s68, 40960
    s_add_u32 s67, s67, 24576
    s_cmp_ge_u32 s67, 147456
    s_cselect_b32 s67, s76, s67
    s_add_u32 s78, s67, s77
    s_add_u32 m0, s67, 0
    s_add_u32 s3, s69, 0
    buffer_load_dwordx4 v57, s[44:47], s3 offen lds
    s_add_u32 m0, s67, 1024
    s_add_u32 s3, s69, 1024
    buffer_load_dwordx4 v57, s[44:47], s3 offen lds
    s_add_u32 m0, s67, 2048
    s_add_u32 s3, s69, 393216
    buffer_load_dwordx4 v57, s[44:47], s3 offen lds
    s_add_u32 m0, s67, 3072
    s_add_u32 s3, s69, 394240
    buffer_load_dwordx4 v57, s[44:47], s3 offen lds
    s_add_u32 m0, s78, 0
    s_add_u32 s3, s68, 0
    buffer_load_dwordx4 v56, s[40:43], s3 offen lds
    s_add_u32 m0, s78, 1024
    s_add_u32 s3, s68, 5120
    buffer_load_dwordx4 v56, s[40:43], s3 offen lds
    s_add_u32 s69, s69, 2048
    s_add_u32 s68, s68, 40960
    s_add_u32 s67, s67, 24576
    s_cmp_ge_u32 s67, 147456
    s_cselect_b32 s67, s76, s67
    s_add_u32 s78, s67, s77
    v_accvgpr_write_b32 a0, 0
    v_accvgpr_write_b32 a1, 0
    v_accvgpr_write_b32 a2, 0
    v_accvgpr_write_b32 a3, 0
    v_accvgpr_write_b32 a4, 0
    v_accvgpr_write_b32 a5, 0
    v_accvgpr_write_b32 a6, 0
    v_accvgpr_write_b32 a7, 0
    v_accvgpr_write_b32 a8, 0
    v_accvgpr_write_b32 a9, 0
    v_accvgpr_write_b32 a10, 0
    v_accvgpr_write_b32 a11, 0
    v_accvgpr_write_b32 a12, 0
    v_accvgpr_write_b32 a13, 0
    v_accvgpr_write_b32 a14, 0
    v_accvgpr_write_b32 a15, 0
    v_accvgpr_write_b32 a16, 0
    v_accvgpr_write_b32 a17, 0
    v_accvgpr_write_b32 a18, 0
    v_accvgpr_write_b32 a19, 0
    v_accvgpr_write_b32 a20, 0
    v_accvgpr_write_b32 a21, 0
    v_accvgpr_write_b32 a22, 0
    v_accvgpr_write_b32 a23, 0
    v_accvgpr_write_b32 a24, 0
    v_accvgpr_write_b32 a25, 0
    v_accvgpr_write_b32 a26, 0
    v_accvgpr_write_b32 a27, 0
    v_accvgpr_write_b32 a28, 0
    v_accvgpr_write_b32 a29, 0
    v_accvgpr_write_b32 a30, 0
    v_accvgpr_write_b32 a31, 0
    v_accvgpr_write_b32 a32, 0
    v_accvgpr_write_b32 a33, 0
    v_accvgpr_write_b32 a34, 0
    v_accvgpr_write_b32 a35, 0
    v_accvgpr_write_b32 a36, 0
    v_accvgpr_write_b32 a37, 0
    v_accvgpr_write_b32 a38, 0
    v_accvgpr_write_b32 a39, 0
    v_accvgpr_write_b32 a40, 0
    v_accvgpr_write_b32 a41, 0
    v_accvgpr_write_b32 a42, 0
    v_accvgpr_write_b32 a43, 0
    v_accvgpr_write_b32 a44, 0
    v_accvgpr_write_b32 a45, 0
    v_accvgpr_write_b32 a46, 0
    v_accvgpr_write_b32 a47, 0
    v_accvgpr_write_b32 a48, 0
    v_accvgpr_write_b32 a49, 0
    v_accvgpr_write_b32 a50, 0
    v_accvgpr_write_b32 a51, 0
    v_accvgpr_write_b32 a52, 0
    v_accvgpr_write_b32 a53, 0
    v_accvgpr_write_b32 a54, 0
    v_accvgpr_write_b32 a55, 0
    v_accvgpr_write_b32 a56, 0
    v_accvgpr_write_b32 a57, 0
    v_accvgpr_write_b32 a58, 0
    v_accvgpr_write_b32 a59, 0
    v_accvgpr_write_b32 a60, 0
    v_accvgpr_write_b32 a61, 0
    v_accvgpr_write_b32 a62, 0
    v_accvgpr_write_b32 a63, 0
    v_accvgpr_write_b32 a64, 0
    v_accvgpr_write_b32 a65, 0
    v_accvgpr_write_b32 a66, 0
    v_accvgpr_write_b32 a67, 0
    v_accvgpr_write_b32 a68, 0
    v_accvgpr_write_b32 a69, 0
    v_accvgpr_write_b32 a70, 0
    v_accvgpr_write_b32 a71, 0
    v_accvgpr_write_b32 a72, 0
    v_accvgpr_write_b32 a73, 0
    v_accvgpr_write_b32 a74, 0
    v_accvgpr_write_b32 a75, 0
    v_accvgpr_write_b32 a76, 0
    v_accvgpr_write_b32 a77, 0
    v_accvgpr_write_b32 a78, 0
    v_accvgpr_write_b32 a79, 0
    v_accvgpr_write_b32 a80, 0
    v_accvgpr_write_b32 a81, 0
    v_accvgpr_write_b32 a82, 0
    v_accvgpr_write_b32 a83, 0
    v_accvgpr_write_b32 a84, 0
    v_accvgpr_write_b32 a85, 0
    v_accvgpr_write_b32 a86, 0
    v_accvgpr_write_b32 a87, 0
    v_accvgpr_write_b32 a88, 0
    v_accvgpr_write_b32 a89, 0
    v_accvgpr_write_b32 a90, 0
    v_accvgpr_write_b32 a91, 0
    v_accvgpr_write_b32 a92, 0
    v_accvgpr_write_b32 a93, 0
    v_accvgpr_write_b32 a94, 0
    v_accvgpr_write_b32 a95, 0
    v_accvgpr_write_b32 a96, 0
    v_accvgpr_write_b32 a97, 0
    v_accvgpr_write_b32 a98, 0
    v_accvgpr_write_b32 a99, 0
    v_accvgpr_write_b32 a100, 0
    v_accvgpr_write_b32 a101, 0
    v_accvgpr_write_b32 a102, 0
    v_accvgpr_write_b32 a103, 0
    v_accvgpr_write_b32 a104, 0
    v_accvgpr_write_b32 a105, 0
    v_accvgpr_write_b32 a106, 0
    v_accvgpr_write_b32 a107, 0
    v_accvgpr_write_b32 a108, 0
    v_accvgpr_write_b32 a109, 0
    v_accvgpr_write_b32 a110, 0
    v_accvgpr_write_b32 a111, 0
    v_accvgpr_write_b32 a112, 0
    v_accvgpr_write_b32 a113, 0
    v_accvgpr_write_b32 a114, 0
    v_accvgpr_write_b32 a115, 0
    v_accvgpr_write_b32 a116, 0
    v_accvgpr_write_b32 a117, 0
    v_accvgpr_write_b32 a118, 0
    v_accvgpr_write_b32 a119, 0
    v_accvgpr_write_b32 a120, 0
    v_accvgpr_write_b32 a121, 0
    v_accvgpr_write_b32 a122, 0
    v_accvgpr_write_b32 a123, 0
    v_accvgpr_write_b32 a124, 0
    v_accvgpr_write_b32 a125, 0
    v_accvgpr_write_b32 a126, 0
    v_accvgpr_write_b32 a127, 0
    s_waitcnt vmcnt(18)
    s_barrier
    s_add_u32 s71, s70, 24576
    s_cmp_eq_u32 s71, 147456
    s_cselect_b32 s71, 0, s71
    v_add_u32 v61, s70, v58
    v_add_u32 v62, s70, v59
    v_add_u32 v63, s70, v60
    ds_read_b64_tr_b16 v[8:9], v61 offset:0
    ds_read_b64_tr_b16 v[10:11], v61 offset:4096
    ds_read_b64_tr_b16 v[12:13], v62 offset:0
    ds_read_b64_tr_b16 v[14:15], v62 offset:4096
    ds_read_b128 v[16:19], v63 offset:0
    ds_read_b128 v[20:23], v63 offset:2048
    ds_read_b128 v[24:27], v63 offset:4096
    ds_read_b128 v[28:31], v63 offset:6144
    s_waitcnt lgkmcnt(0)
    v_mfma_f32_32x32x16_bf16 a[0:15], v[8:11], v[16:19], a[0:15]
    ds_read_b64_tr_b16 v[32:33], v61 offset:2048
    ds_read_b64_tr_b16 v[34:35], v61 offset:6144
    ds_read_b64_tr_b16 v[36:37], v62 offset:2048
    v_mfma_f32_32x32x16_bf16 a[16:31], v[12:15], v[16:19], a[16:31]
    ds_read_b64_tr_b16 v[38:39], v62 offset:6144
    ds_read_b128 v[40:43], v63 offset:1024
    v_mfma_f32_32x32x16_bf16 a[32:47], v[8:11], v[20:23], a[32:47]
    ds_read_b128 v[44:47], v63 offset:3072
    ds_read_b128 v[48:51], v63 offset:5120
    ds_read_b128 v[52:55], v63 offset:7168
    v_mfma_f32_32x32x16_bf16 a[48:63], v[12:15], v[20:23], a[48:63]
    s_add_u32 m0, s67, 0
    s_add_u32 s3, s69, 0
    v_mfma_f32_32x32x16_bf16 a[64:79], v[8:11], v[24:27], a[64:79]
    buffer_load_dwordx4 v57, s[44:47], s3 offen lds
    s_add_u32 m0, s67, 1024
    s_add_u32 s3, s69, 1024
    v_mfma_f32_32x32x16_bf16 a[80:95], v[12:15], v[24:27], a[80:95]
    buffer_load_dwordx4 v57, s[44:47], s3 offen lds
    s_add_u32 m0, s67, 2048
    v_mfma_f32_32x32x16_bf16 a[96:111], v[8:11], v[28:31], a[96:111]
    s_add_u32 s3, s69, 393216
    buffer_load_dwordx4 v57, s[44:47], s3 offen lds
    s_add_u32 m0, s67, 3072
    v_mfma_f32_32x32x16_bf16 a[112:127], v[12:15], v[28:31], a[112:127]
    s_add_u32 s3, s69, 394240
    buffer_load_dwordx4 v57, s[44:47], s3 offen lds
    s_waitcnt lgkmcnt(0)
    v_mfma_f32_32x32x16_bf16 a[0:15], v[32:35], v[40:43], a[0:15]
    v_add_u32 v61, s71, v58
    v_add_u32 v62, s71, v59
    v_add_u32 v63, s71, v60
    v_mfma_f32_32x32x16_bf16 a[16:31], v[36:39], v[40:43], a[16:31]
    ds_read_b64_tr_b16 v[8:9], v61 offset:0
    ds_read_b64_tr_b16 v[10:11], v61 offset:4096
    ds_read_b64_tr_b16 v[12:13], v62 offset:0
    v_mfma_f32_32x32x16_bf16 a[32:47], v[32:35], v[44:47], a[32:47]
    ds_read_b64_tr_b16 v[14:15], v62 offset:4096
    ds_read_b128 v[16:19], v63 offset:0
    ds_read_b128 v[20:23], v63 offset:2048
    v_mfma_f32_32x32x16_bf16 a[48:63], v[36:39], v[44:47], a[48:63]
    ds_read_b128 v[24:27], v63 offset:4096
    ds_read_b128 v[28:31], v63 offset:6144
    s_add_u32 m0, s78, 0
    v_mfma_f32_32x32x16_bf16 a[64:79], v[32:35], v[48:51], a[64:79]
    s_add_u32 s3, s68, 0
    buffer_load_dwordx4 v56, s[40:43], s3 offen lds
    s_add_u32 m0, s78, 1024
    v_mfma_f32_32x32x16_bf16 a[80:95], v[36:39], v[48:51], a[80:95]
    s_add_u32 s3, s68, 5120
    buffer_load_dwordx4 v56, s[40:43], s3 offen lds
    s_add_u32 s69, s69, 2048
    v_mfma_f32_32x32x16_bf16 a[96:111], v[32:35], v[52:55], a[96:111]
    s_add_u32 s68, s68, 40960
    s_add_u32 s67, s67, 24576
    s_cmp_ge_u32 s67, 147456
    v_mfma_f32_32x32x16_bf16 a[112:127], v[36:39], v[52:55], a[112:127]
    s_cselect_b32 s67, s76, s67
    s_add_u32 s78, s67, s77
    s_mov_b32 s70, s71
L_k2_loop:
    s_waitcnt vmcnt(18)
    s_barrier
    s_add_u32 s71, s70, 24576
    s_cmp_eq_u32 s71, 147456
    s_cselect_b32 s71, 0, s71
    s_waitcnt lgkmcnt(0)
    v_mfma_f32_32x32x16_bf16 a[0:15], v[8:11], v[16:19], a[0:15]
    ds_read_b64_tr_b16 v[32:33], v61 offset:2048
    ds_read_b64_tr_b16 v[34:35], v61 offset:6144
    ds_read_b64_tr_b16 v[36:37], v62 offset:2048
    v_mfma_f32_32x32x16_bf16 a[16:31], v[12:15], v[16:19], a[16:31]
    ds_read_b64_tr_b16 v[38:39], v62 offset:6144
    ds_read_b128 v[40:43], v63 offset:1024
    v_mfma_f32_32x32x16_bf16 a[32:47], v[8:11], v[20:23], a[32:47]
    ds_read_b128 v[44:47], v63 offset:3072
    ds_read_b128 v[48:51], v63 offset:5120
    ds_read_b128 v[52:55], v63 offset:7168
    v_mfma_f32_32x32x16_bf16 a[48:63], v[12:15], v[20:23], a[48:63]
    s_add_u32 m0, s67, 0
    s_add_u32 s3, s69, 0
    v_mfma_f32_32x32x16_bf16 a[64:79], v[8:11], v[24:27], a[64:79]
    buffer_load_dwordx4 v57, s[44:47], s3 offen lds
    s_add_u32 m0, s67, 1024
    s_add_u32 s3, s69, 1024
    v_mfma_f32_32x32x16_bf16 a[80:95], v[12:15], v[24:27], a[80:95]
    buffer_load_dwordx4 v57, s[44:47], s3 offen lds
    s_add_u32 m0, s67, 2048
    v_mfma_f32_32x32x16_bf16 a[96:111], v[8:11], v[28:31], a[96:111]
    s_add_u32 s3, s69, 393216
    buffer_load_dwordx4 v57, s[44:47], s3 offen lds
    s_add_u32 m0, s67, 3072
    v_mfma_f32_32x32x16_bf16 a[112:127], v[12:15], v[28:31], a[112:127]
    s_add_u32 s3, s69, 394240
    buffer_load_dwordx4 v57, s[44:47], s3 offen lds
    s_waitcnt lgkmcnt(0)
    v_mfma_f32_32x32x16_bf16 a[0:15], v[32:35], v[40:43], a[0:15]
    v_add_u32 v61, s71, v58
    v_add_u32 v62, s71, v59
    v_add_u32 v63, s71, v60
    v_mfma_f32_32x32x16_bf16 a[16:31], v[36:39], v[40:43], a[16:31]
    ds_read_b64_tr_b16 v[8:9], v61 offset:0
    ds_read_b64_tr_b16 v[10:11], v61 offset:4096
    ds_read_b64_tr_b16 v[12:13], v62 offset:0
    v_mfma_f32_32x32x16_bf16 a[32:47], v[32:35], v[44:47], a[32:47]
    ds_read_b64_tr_b16 v[14:15], v62 offset:4096
    ds_read_b128 v[16:19], v63 offset:0
    ds_read_b128 v[20:23], v63 offset:2048
    v_mfma_f32_32x32x16_bf16 a[48:63], v[36:39], v[44:47], a[48:63]
    ds_read_b128 v[24:27], v63 offset:4096
    ds_read_b128 v[28:31], v63 offset:6144
    s_add_u32 m0, s78, 0
    v_mfma_f32_32x32x16_bf16 a[64:79], v[32:35], v[48:51], a[64:79]
    s_add_u32 s3, s68, 0
    buffer_load_dwordx4 v56, s[40:43], s3 offen lds
    s_add_u32 m0, s78, 1024
    v_mfma_f32_32x32x16_bf16 a[80:95], v[36:39], v[48:51], a[80:95]
    s_add_u32 s3, s68, 5120
    buffer_load_dwordx4 v56, s[40:43], s3 offen lds
    s_add_u32 s69, s69, 2048
    v_mfma_f32_32x32x16_bf16 a[96:111], v[32:35], v[52:55], a[96:111]
    s_add_u32 s68, s68, 40960
    s_add_u32 s67, s67, 24576
    s_cmp_ge_u32 s67, 147456
    v_mfma_f32_32x32x16_bf16 a[112:127], v[36:39], v[52:55], a[112:127]
    s_cselect_b32 s67, s76, s67
    s_add_u32 s78, s67, s77
    s_mov_b32 s70, s71
    s_add_u32 s72, s72, 1
    s_cmp_lt_u32 s72, 46
    s_cbranch_scc1 L_k2_loop
    s_waitcnt vmcnt(18)
    s_barrier
    s_add_u32 s71, s70, 24576
    s_cmp_eq_u32 s71, 147456
    s_cselect_b32 s71, 0, s71
    s_waitcnt lgkmcnt(0)
    v_mfma_f32_32x32x16_bf16 a[0:15], v[8:11], v[16:19], a[0:15]
    ds_read_b64_tr_b16 v[32:33], v61 offset:2048
    ds_read_b64_tr_b16 v[34:35], v61 offset:6144
    ds_read_b64_tr_b16 v[36:37], v62 offset:2048
    v_mfma_f32_32x32x16_bf16 a[16:31], v[12:15], v[16:19], a[16:31]
    ds_read_b64_tr_b16 v[38:39], v62 offset:6144
    ds_read_b128 v[40:43], v63 offset:1024
    v_mfma_f32_32x32x16_bf16 a[32:47], v[8:11], v[20:23], a[32:47]
    ds_read_b128 v[44:47], v63 offset:3072
    ds_read_b128 v[48:51], v63 offset:5120
    ds_read_b128 v[52:55], v63 offset:7168
    v_mfma_f32_32x32x16_bf16 a[48:63], v[12:15], v[20:23], a[48:63]
    s_add_u32 m0, s67, 0
    s_add_u32 s3, s69, 0
    v_mfma_f32_32x32x16_bf16 a[64:79], v[8:11], v[24:27], a[64:79]
    buffer_load_dwordx4 v57, s[44:47], s3 offen lds
    s_add_u32 m0, s67, 1024
    s_add_u32 s3, s69, 1024
    v_mfma_f32_32x32x16_bf16 a[80:95], v[12:15], v[24:27], a[80:95]
    buffer_load_dwordx4 v57, s[44:47], s3 offen lds
    s_add_u32 m0, s67, 2048
    v_mfma_f32_32x32x16_bf16 a[96:111], v[8:11], v[28:31], a[96:111]
    s_add_u32 s3, s69, 393216
    buffer_load_dwordx4 v57, s[44:47], s3 offen lds
    s_add_u32 m0, s67, 3072
    v_mfma_f32_32x32x16_bf16 a[112:127], v[12:15], v[28:31], a[112:127]
    s_add_u32 s3, s69, 394240
    buffer_load_dwordx4 v57, s[44:47], s3 offen lds
    s_waitcnt lgkmcnt(0)
    v_mfma_f32_32x32x16_bf16 a[0:15], v[32:35], v[40:43], a[0:15]
    s_add_u32 m0, s78, 0
    s_add_u32 s3, s68, 0
    v_mfma_f32_32x32x16_bf16 a[16:31], v[36:39], v[40:43], a[16:31]
    buffer_load_dwordx4 v56, s[40:43], s3 offen lds
    v_mfma_f32_32x32x16_bf16 a[32:47], v[32:35], v[44:47], a[32:47]
    s_add_u32 m0, s78, 1024
    s_add_u32 s3, s68, 5120
    v_mfma_f32_32x32x16_bf16 a[48:63], v[36:39], v[44:47], a[48:63]
    buffer_load_dwordx4 v56, s[40:43], s3 offen lds
    v_mfma_f32_32x32x16_bf16 a[64:79], v[32:35], v[48:51], a[64:79]
    s_add_u32 s69, s69, 2048
    s_add_u32 s68, s68, 40960
    v_mfma_f32_32x32x16_bf16 a[80:95], v[36:39], v[48:51], a[80:95]
    s_add_u32 s67, s67, 24576
    v_mfma_f32_32x32x16_bf16 a[96:111], v[32:35], v[52:55], a[96:111]
    s_cmp_ge_u32 s67, 147456
    s_cselect_b32 s67, s76, s67
    v_mfma_f32_32x32x16_bf16 a[112:127], v[36:39], v[52:55], a[112:127]
    s_add_u32 s78, s67, s77
    s_mov_b32 s70, s71
    s_nop 15
    s_movk_i32 s3, 0
    buffer_store_dwordx4 a[0:3], v64, s[48:51], s3 offen sc0 sc1
    s_movk_i32 s3, 1024
    buffer_store_dwordx4 a[4:7], v64, s[48:51], s3 offen sc0 sc1
    s_movk_i32 s3, 2048
    buffer_store_dwordx4 a[8:11], v64, s[48:51], s3 offen sc0 sc1
    s_movk_i32 s3, 3072
    buffer_store_dwordx4 a[12:15], v64, s[48:51], s3 offen sc0 sc1
    s_movk_i32 s3, 4096
    buffer_store_dwordx4 a[16:19], v64, s[48:51], s3 offen sc0 sc1
    s_movk_i32 s3, 5120
    buffer_store_dwordx4 a[20:23], v64, s[48:51], s3 offen sc0 sc1
    s_movk_i32 s3, 6144
    buffer_store_dwordx4 a[24:27], v64, s[48:51], s3 offen sc0 sc1
    s_movk_i32 s3, 7168
    buffer_store_dwordx4 a[28:31], v64, s[48:51], s3 offen sc0 sc1
    s_movk_i32 s3, 8192
    buffer_store_dwordx4 a[32:35], v64, s[48:51], s3 offen sc0 sc1
    s_movk_i32 s3, 9216
    buffer_store_dwordx4 a[36:39], v64, s[48:51], s3 offen sc0 sc1
    s_movk_i32 s3, 10240
    buffer_store_dwordx4 a[40:43], v64, s[48:51], s3 offen sc0 sc1
    s_movk_i32 s3, 11264
    buffer_store_dwordx4 a[44:47], v64, s[48:51], s3 offen sc0 sc1
    s_movk_i32 s3, 12288
    buffer_store_dwordx4 a[48:51], v64, s[48:51], s3 offen sc0 sc1
    s_movk_i32 s3, 13312
    buffer_store_dwordx4 a[52:55], v64, s[48:51], s3 offen sc0 sc1
    s_movk_i32 s3, 14336
    buffer_store_dwordx4 a[56:59], v64, s[48:51], s3 offen sc0 sc1
    s_movk_i32 s3, 15360
    buffer_store_dwordx4 a[60:63], v64, s[48:51], s3 offen sc0 sc1
    s_movk_i32 s3, 16384
    buffer_store_dwordx4 a[64:67], v64, s[48:51], s3 offen sc0 sc1
    s_movk_i32 s3, 17408
    buffer_store_dwordx4 a[68:71], v64, s[48:51], s3 offen sc0 sc1
    s_movk_i32 s3, 18432
    buffer_store_dwordx4 a[72:75], v64, s[48:51], s3 offen sc0 sc1
    s_movk_i32 s3, 19456
    buffer_store_dwordx4 a[76:79], v64, s[48:51], s3 offen sc0 sc1
    s_movk_i32 s3, 20480
    buffer_store_dwordx4 a[80:83], v64, s[48:51], s3 offen sc0 sc1
    s_movk_i32 s3, 21504
    buffer_store_dwordx4 a[84:87], v64, s[48:51], s3 offen sc0 sc1
    s_movk_i32 s3, 22528
    buffer_store_dwordx4 a[88:91], v64, s[48:51], s3 offen sc0 sc1
    s_movk_i32 s3, 23552
    buffer_store_dwordx4 a[92:95], v64, s[48:51], s3 offen sc0 sc1
    s_movk_i32 s3, 24576
    buffer_store_dwordx4 a[96:99], v64, s[48:51], s3 offen sc0 sc1
    s_movk_i32 s3, 25600
    buffer_store_dwordx4 a[100:103], v64, s[48:51], s3 offen sc0 sc1
    s_movk_i32 s3, 26624
    buffer_store_dwordx4 a[104:107], v64, s[48:51], s3 offen sc0 sc1
    s_movk_i32 s3, 27648
    buffer_store_dwordx4 a[108:111], v64, s[48:51], s3 offen sc0 sc1
    s_movk_i32 s3, 28672
    buffer_store_dwordx4 a[112:115], v64, s[48:51], s3 offen sc0 sc1
    s_movk_i32 s3, 29696
    buffer_store_dwordx4 a[116:119], v64, s[48:51], s3 offen sc0 sc1
    s_movk_i32 s3, 30720
    buffer_store_dwordx4 a[120:123], v64, s[48:51], s3 offen sc0 sc1
    s_movk_i32 s3, 31744
    buffer_store_dwordx4 a[124:127], v64, s[48:51], s3 offen sc0 sc1
    s_waitcnt vmcnt(0)
L_k2_end:
    s_endpgm
.globl k3_kernel
.p2align 8
.type k3_kernel,@function
k3_kernel:
    s_cmp_ge_u32 s2, 1920
    s_cbranch_scc1 L_k3_end
    s_load_dwordx2 s[4:5], s[0:1], 80
    s_load_dwordx2 s[6:7], s[0:1], 96
    s_waitcnt lgkmcnt(0)
    s_mov_b32 s8, s4
    s_mov_b32 s9, s5
    s_mov_b32 s10, 3932160
    s_mov_b32 s11, 0x00020000
    s_add_u32 s12, s6, 41943040
    s_addc_u32 s13, s7, 0
    s_mov_b32 s14, 31457280
    s_mov_b32 s15, 0x00020000
    s_lshl_b32 s16, s2, 12
    v_lshlrev_b32 v2, 4, v0
    v_add_u32 v2, s16, v2
    s_mov_b32 s19, 0
    buffer_load_dwordx4 v[8:11], v2, s[12:15], s19 offen
    s_mov_b32 s19, 7864320
    buffer_load_dwordx4 v[12:15], v2, s[12:15], s19 offen
    s_mov_b32 s19, 15728640
    buffer_load_dwordx4 v[16:19], v2, s[12:15], s19 offen
    s_mov_b32 s19, 23592960
    buffer_load_dwordx4 v[20:23], v2, s[12:15], s19 offen
    s_lshr_b32 s17, s2, 5
    s_cmp_ge_u32 s17, 30
    s_cselect_b32 s18, 1, 0
    s_mul_i32 s20, s18, 30
    s_sub_u32 s17, s17, s20
    s_mul_i32 s20, s17, 52
    s_lshr_b32 s20, s20, 8
    s_mul_i32 s21, s20, 5
    s_sub_u32 s21, s17, s21
    s_bfe_u32 s22, s2, 0x20003
    s_and_b32 s23, s2, 7
    s_lshr_b32 s24, s23, 1
    s_and_b32 s25, s23, 1
    s_lshr_b32 s26, s22, 1
    s_and_b32 s27, s22, 1
    s_lshl_b32 s28, s20, 8
    s_lshl_b32 s29, s26, 7
    s_add_u32 s28, s28, s29
    s_lshl_b32 s29, s24, 5
    s_add_u32 s28, s28, s29
    s_mul_i32 s30, s18, 640
    s_lshl_b32 s29, s21, 7
    s_add_u32 s30, s30, s29
    s_lshl_b32 s29, s27, 6
    s_add_u32 s30, s30, s29
    s_lshl_b32 s29, s25, 5
    s_add_u32 s30, s30, s29
    v_and_b32 v3, 31, v0
    v_add_u32 v3, s28, v3
    v_mul_u32_u24 v3, 2560, v3
    v_lshrrev_b32 v4, 6, v0
    v_lshlrev_b32 v4, 3, v4
    v_bfe_u32 v5, v0, 5, 1
    v_lshl_add_u32 v4, v5, 2, v4
    v_add_u32 v4, s30, v4
    v_lshl_add_u32 v3, v4, 1, v3
    s_waitcnt vmcnt(0)
    v_add_f32 v8, v8, v12
    v_add_f32 v16, v16, v20
    v_add_f32 v9, v9, v13
    v_add_f32 v17, v17, v21
    v_add_f32 v10, v10, v14
    v_add_f32 v18, v18, v22
    v_add_f32 v11, v11, v15
    v_add_f32 v19, v19, v23
    v_add_f32 v8, v8, v16
    v_add_f32 v9, v9, v17
    v_add_f32 v10, v10, v18
    v_add_f32 v11, v11, v19
    v_cvt_pk_bf16_f32 v24, v8, v9
    v_cvt_pk_bf16_f32 v25, v10, v11
    buffer_store_dwordx2 v[24:25], v3, s[8:11], 0 offen
    s_waitcnt vmcnt(0)
L_k3_end:
    s_endpgm
.section .rodata,"a"
.p2align 6
.amdhsa_kernel k1_kernel
  .amdhsa_next_free_vgpr 512
  .amdhsa_next_free_sgpr 102
  .amdhsa_accum_offset 256
  .amdhsa_group_segment_fixed_size 0
  .amdhsa_kernarg_size 104
  .amdhsa_user_sgpr_count 2
  .amdhsa_user_sgpr_kernarg_segment_ptr 1
  .amdhsa_system_sgpr_workgroup_id_x 1
.end_amdhsa_kernel
.p2align 6
.amdhsa_kernel k2_kernel
  .amdhsa_next_free_vgpr 200
  .amdhsa_next_free_sgpr 96
  .amdhsa_accum_offset 72
  .amdhsa_group_segment_fixed_size 0
  .amdhsa_kernarg_size 104
  .amdhsa_user_sgpr_count 2
  .amdhsa_user_sgpr_kernarg_segment_ptr 1
  .amdhsa_system_sgpr_workgroup_id_x 1
.end_amdhsa_kernel
.p2align 6
.amdhsa_kernel k3_kernel
  .amdhsa_next_free_vgpr 32
  .amdhsa_next_free_sgpr 96
  .amdhsa_accum_offset 32
  .amdhsa_group_segment_fixed_size 0
  .amdhsa_kernarg_size 104
  .amdhsa_user_sgpr_count 2
  .amdhsa_user_sgpr_kernarg_segment_ptr 1
  .amdhsa_system_sgpr_workgroup_id_x 1
.end_amdhsa_kernel
```
